```python
import torch

def _softmax(x, axis=-1):
    return torch.softmax(x, dim=axis)
def _gelu(x):
    return torch.nn.functional.gelu(x, approximate="tanh")
def _silu(x):
    return torch.nn.functional.silu(x)
def _sigmoid(x):
    return torch.sigmoid(x)
def _layernorm(x, axis=-1, eps=1e-5):
    m = x.mean(dim=axis, keepdim=True)
    v = x.var(dim=axis, keepdim=True, unbiased=False)
    return (x - m) / torch.sqrt(v + eps)
def _scatter_add(tgt, idx, src, axis=0):
    return tgt.clone().index_add_(axis, idx, src)
def _segment_sum(src, seg, n):
    out = torch.zeros((n,) + src.shape[1:], dtype=src.dtype)
    return out.index_add_(0, seg, src)
def _pad(x, pw):
    flat = tuple(v for pair in reversed(pw) for v in pair)
    return torch.nn.functional.pad(x, flat)

kernel_name = 'recurrent_scan__linear_attn_block__glu_gated_swiglu__prompt'

def setup_inputs():

    _w = (lambda a: (lambda t: t.to(torch.bfloat16) if t.is_floating_point() else t)(torch.as_tensor(a)))
    def _A_setup():
        B, S, D = 1, 2048, 1024
        return {
            "x": _w((lambda *s: torch.randn(*s, dtype=torch.bfloat16) * 0.05)(B, S, D)),
            "wqkv": _w((lambda *s: torch.randn(*s, dtype=torch.bfloat16) * 0.8)(D, 3 * D)),
            "wo": _w((lambda *s: torch.randn(*s, dtype=torch.bfloat16) * 0.8)(D, D)),
        }
    _A_in = _A_setup()

    def _B_setup():
        B, S, D, F = 1, 2048, 1024, 3584
        return {
            "x": _w((lambda *s: torch.randn(*s, dtype=torch.bfloat16) * 0.05)(B, S, D)),
            "w1": _w((lambda *s: torch.randn(*s, dtype=torch.bfloat16) * 0.2)(D, F) * (2.0 / D) ** 0.5),
            "w3": _w((lambda *s: torch.randn(*s, dtype=torch.bfloat16) * 0.2)(D, F) * (2.0 / D) ** 0.5),
            "w2": _w((lambda *s: torch.randn(*s, dtype=torch.bfloat16) * 0.2)(F, D) * (2.0 / F) ** 0.5),
        }
    _B_in = _B_setup()

    return {
        "A_x": _A_in["x"],
        "A_wqkv": _A_in["wqkv"],
        "A_wo": _A_in["wo"],
        "B_x": _B_in["x"],
        "B_w1": _B_in["w1"],
        "B_w3": _B_in["w3"],
        "B_w2": _B_in["w2"],
    }

def reference(A_x, A_wqkv, A_wo, B_x, B_w1, B_w3, B_w2):
    def _A_ref(x, wqkv, wo):
        B, S, D = x.shape
        H = 32; Dh = D // H
        qkv = (lambda x, *d: x.permute(*d))((x @ wqkv).reshape(B, S, 3, H, Dh), 2, 0, 3, 1, 4)
        q, k, v = qkv[0], qkv[1], qkv[2]
        phi = lambda t: torch.where(t > 0, t + 1, torch.exp(t)) + 1e-6
        pq, pk = phi(q), phi(k)
        kv = torch.einsum("bhsd,bhse->bhde", pk, v)
        z = torch.einsum("bhsd->bhd", pk)
        num = torch.einsum("bhqd,bhde->bhqe", pq, kv)
        den = torch.einsum("bhqd,bhd->bhq", pq, z)[..., None] + 1e-6
        o = num / den
        return (lambda x, *d: x.permute(*d))(o, 0, 2, 1, 3).reshape(B, S, D) @ wo

    def _B_ref(x, w1, w3, w2):
        gate = torch.einsum("bsd,df->bsf", x, w1)
        up = torch.einsum("bsd,df->bsf", x, w3)
        h = _silu(gate) * up
        out = torch.einsum("bsf,fd->bsd", h, w2)
        return out

    x = A_x
    xn = _layernorm(x, axis=-1)
    s = _A_ref(xn, A_wqkv, A_wo)
    g = _silu(_B_ref(xn, B_w1, B_w3, B_w2))
    return x + s * g
```

```asm
; @launch grid=(256,1,1) block=(256,1,1) lds=163840
.amdgcn_target "amdgcn-amd-amdhsa--gfx950"
.macro MM d, a, b
v_mfma_f32_16x16x32_bf16 \d, \a, \b, \d
.endm
.macro TR d, a, o
ds_read_b64_tr_b16 \d, \a offset:\o
.endm
.text
.globl recurrent_scan__linear_attn_block__glu_gated_swiglu__prompt_kernel
.p2align 8
.type recurrent_scan__linear_attn_block__glu_gated_swiglu__prompt_kernel,@function
recurrent_scan__linear_attn_block__glu_gated_swiglu__prompt_kernel:
s_cmp_ge_u32 s2, 256
s_cbranch_scc1 L_end
s_load_dwordx4 s[4:7], s[0:1], 0
s_load_dwordx2 s[8:9], s[0:1], 16
s_load_dwordx4 s[12:15], s[0:1], 32
s_load_dwordx4 s[16:19], s[0:1], 48
s_load_dwordx4 s[20:23], s[0:1], 64
s_getpc_b64 s[10:11]
Lc1:
s_sub_u32 s10, s10, Lc1-recurrent_scan__linear_attn_block__glu_gated_swiglu__prompt_kernel
s_subb_u32 s11, s11, 0
s_lshr_b32 s30, s2, 3
s_lshl_b32 s30, s30, 12
v_lshl_add_u32 v28, v0, 4, s30
v_min_u32 v28, L_end-recurrent_scan__linear_attn_block__glu_gated_swiglu__prompt_kernel-16, v28
v_mov_b32 v29, s11
v_add_co_u32 v28, vcc, s10, v28
s_nop 1
v_addc_co_u32 v29, vcc, 0, v29, vcc
global_load_dwordx4 v[120:123], v[28:29], off
v_and_b32 v1, 63, v0
v_lshrrev_b32 v2, 6, v0
s_nop 0
v_readfirstlane_b32 s24, v2
s_and_b32 s25, s2, 7
s_bfe_u32 s26, s2, 0x30003
s_lshr_b32 s27, s2, 6
s_and_b32 s29, s27, 1
s_and_b32 s28, s25, 3
s_lshl_b32 s28, s28, 2
s_add_u32 s28, s28, s27
s_lshl_b32 s30, s27, 3
s_add_u32 s30, s30, s25
s_lshl_b32 s30, s30, 3
s_lshl_b32 s31, s26, 8
s_add_u32 s30, s30, s31
v_lshrrev_b32 v21, 5, v0
v_add_u32 v21, s30, v21
v_and_b32 v22, 31, v0
v_lshlrev_b32 v20, 11, v21
v_lshl_add_u32 v20, v22, 4, v20
v_lshlrev_b32 v31, 7, v22
s_lshl_b32 s30, s26, 12
s_add_u32 s30, s30, 51380224
v_add_u32 v31, s30, v31
v_mov_b32 v24, 0
s_or_b32 s3, s25, s27
s_xor_b32 s30, s24, 3
s_or_b32 s3, s3, s30
s_waitcnt lgkmcnt(0)
s_cmp_lg_u32 s3, 0
s_cbranch_scc1 Lz2
global_store_dword v31, v24, s[22:23] sc0 sc1
Lz2:
global_load_dwordx4 v[64:67], v20, s[4:5] offset:0 nt
global_load_dwordx4 v[68:71], v20, s[4:5] offset:512 nt
global_load_dwordx4 v[72:75], v20, s[4:5] offset:1024 nt
global_load_dwordx4 v[76:79], v20, s[4:5] offset:1536 nt
v_lshlrev_b32 v2, 4, v1
v_lshrrev_b32 v24, 3, v1
s_lshl_b32 s30, s24, 3
v_add_u32 v24, s30, v24
v_bfe_u32 v25, v1, 4, 1
s_and_b32 s30, s24, 1
s_lshl_b32 s30, s30, 1
v_or_b32 v25, s30, v25
v_bfe_u32 v26, v1, 1, 2
v_xor_b32 v26, v26, v25
v_lshlrev_b32 v26, 5, v26
v_and_b32 v27, 1, v1
v_lshl_add_u32 v26, v27, 4, v26
v_mul_u32_u24 v16, 6144, v24
v_add_u32 v16, v16, v26
v_mul_u32_u24 v17, 7168, v24
v_add_u32 v17, v17, v26
v_lshrrev_b32 v24, 2, v1
s_and_b32 s30, s24, 1
s_lshl_b32 s30, s30, 4
v_add_u32 v24, s30, v24
v_bfe_u32 v25, v1, 1, 1
v_lshrrev_b32 v26, 5, v1
v_xor_b32 v25, v25, v26
v_lshlrev_b32 v25, 5, v25
v_lshl_add_u32 v25, v27, 4, v25
v_mul_u32_u24 v18, 7168, v24
v_add_u32 v18, v18, v25
v_add_u32 v19, 4096, v2
v_add_u32 v3, 294912, v2
s_mov_b32 s72, 0
s_mov_b32 s74, 0
s_mov_b32 s73, 196608
s_mov_b32 s75, 229376
s_mov_b32 s76, 0
s_lshl_b32 s78, s24, 10
s_lshr_b32 s79, s24, 1
s_lshl_b32 s79, s79, 12
s_and_b32 s30, s24, 1
s_lshl_b32 s30, s30, 10
s_add_u32 s79, s79, s30
s_lshl_b32 s10, s26, 2
s_add_u32 s10, s10, s24
s_lshl_b32 s30, s10, 17
s_add_u32 s52, s22, s30
s_addc_u32 s53, s23, 0
s_mov_b32 s54, 131072
s_mov_b32 s55, 0x20000
s_mul_i32 s30, s10, 589824
s_add_u32 s30, s30, 4194304
s_add_u32 s56, s22, s30
s_addc_u32 s57, s23, 0
s_mov_b32 s58, 589824
s_mov_b32 s59, 0x20000
s_mul_i32 s30, s28, 67584
s_add_u32 s30, s30, 25165824
s_add_u32 s60, s22, s30
s_addc_u32 s61, s23, 0
s_mov_b32 s62, 67584
s_mov_b32 s63, 0x20000
s_add_u32 s64, s16, 0
s_addc_u32 s65, s17, 0
s_mov_b32 s66, 7340032
s_mov_b32 s67, 0x20000
s_add_u32 s68, s8, 0
s_addc_u32 s69, s9, 0
s_mov_b32 s70, 2097152
s_mov_b32 s71, 0x20000
s_lshl_b32 s81, s2, 2
s_add_u32 s81, s81, s24
s_lshl_b32 s81, s81, 10
s_mov_b32 s82, s81
s_mov_b32 s86, 0x3fb8aa3b
s_mov_b32 s87, 0xbfb8aa3b
s_mov_b32 s88, 0x358637bd
s_lshl_b32 s89, s28, 4
s_add_u32 s89, s89, 8
s_lshl_b32 s95, s26, 1
s_bfe_u32 s30, s25, 0x10000
s_add_u32 s95, s95, s30
s_lshl_b32 s95, s95, 3
s_bfe_u32 s30, s25, 0x10001
s_lshl_b32 s30, s30, 2
s_add_u32 s95, s95, s30
s_add_u32 s95, s95, s27
s_bfe_u32 s91, s25, 0x10002
s_lshr_b32 s94, s95, 3
s_lshl_b32 s94, s94, 2
s_add_u32 s94, s94, s24
s_lshl_b32 s94, s94, 16
s_and_b32 s30, s95, 7
s_lshl_b32 s30, s30, 8
s_add_u32 s94, s94, s30
s_lshl_b32 s31, s91, 7
s_add_u32 s94, s94, s31
s_lshl_b32 s92, s26, 11
s_add_u32 s92, s92, 50331648
s_lshl_b32 s93, s95, 8
s_add_u32 s93, s93, 50348032
s_add_u32 s93, s93, s31
s_cmp_lg_u32 s24, 0
s_cbranch_scc1 Lz3
v_mov_b32 v24, 0
v_lshl_add_u32 v25, v1, 8, s92
v_subrev_u32 v25, 256, v25
v_mov_b32 v26, s93
v_cmp_eq_u32 vcc, 0, v1
s_nop 1
v_cndmask_b32 v25, v25, v26, vcc
s_or_b32 s30, s25, s27
s_cmp_eq_u32 s30, 0
s_cselect_b32 s30, 63, 1
s_mov_b32 s31, 0
s_mov_b64 exec, s[30:31]
global_store_dword v25, v24, s[22:23] sc0 sc1
s_mov_b64 exec, -1
Lz3:
v_xor_b32 v24, v21, v22
v_and_b32 v24, 7, v24
v_lshlrev_b32 v24, 4, v24
v_lshl_add_u32 v22, v22, 7, v24
v_readfirstlane_b32 s30, v21
s_nop 0
s_lshr_b32 s31, s30, 6
s_lshl_b32 s31, s31, 17
s_bfe_u32 s3, s30, 0x20004
s_lshl_b32 s3, s3, 10
s_add_u32 s31, s31, s3
s_and_b32 s30, s30, 8
s_lshl_b32 s30, s30, 4
s_add_u32 s31, s31, s30
s_lshl_b32 s30, s24, 15
s_add_u32 s31, s31, s30
v_lshrrev_b32 v23, 5, v1
v_lshlrev_b32 v23, 12, v23
v_bfe_u32 v24, v1, 3, 2
v_lshl_add_u32 v23, v24, 8, v23
v_lshrrev_b32 v24, 3, v1
v_xor_b32 v24, v24, v1
v_and_b32 v24, 7, v24
v_lshl_add_u32 v23, v24, 4, v23
v_add_u32 v23, s31, v23
s_lshr_b32 s30, s24, 1
s_lshl_b32 s30, s30, 15
s_and_b32 s31, s24, 1
s_lshl_b32 s31, s31, 12
s_add_u32 s30, s30, s31
v_add_u32 v21, s30, v2
v_lshrrev_b32 v24, 4, v1
v_bfe_u32 v25, v1, 2, 2
v_and_b32 v26, 3, v1
v_lshl_add_u32 v27, v24, 3, v25
v_lshrrev_b32 v28, 1, v25
v_and_b32 v29, 1, v24
v_lshl_or_b32 v28, v29, 1, v28
v_xor_b32 v30, 0, v28
v_lshlrev_b32 v30, 5, v30
v_lshl_add_u32 v30, v27, 7, v30
v_lshl_add_u32 v4, v26, 3, v30
v_add_u32 v8, 0x10000, v4
v_add_u32 v12, 0x20000, v4
v_xor_b32 v30, 1, v28
v_lshlrev_b32 v30, 5, v30
v_lshl_add_u32 v30, v27, 7, v30
v_lshl_add_u32 v5, v26, 3, v30
v_add_u32 v9, 0x10000, v5
v_add_u32 v13, 0x20000, v5
v_xor_b32 v30, 2, v28
v_lshlrev_b32 v30, 5, v30
v_lshl_add_u32 v30, v27, 7, v30
v_lshl_add_u32 v6, v26, 3, v30
v_add_u32 v10, 0x10000, v6
v_add_u32 v14, 0x20000, v6
v_xor_b32 v30, 3, v28
v_lshlrev_b32 v30, 5, v30
v_lshl_add_u32 v30, v27, 7, v30
v_lshl_add_u32 v7, v26, 3, v30
v_add_u32 v11, 0x10000, v7
v_add_u32 v15, 0x20000, v7
s_lshr_b32 s83, s28, 3
s_mul_i32 s83, s83, 56
s_bfe_u32 s30, s28, 0x20001
s_add_u32 s83, s83, s30
s_lshl_b32 s83, s83, 11
s_lshr_b32 s10, s28, 1
s_mul_i32 s10, s10, 896
s_lshl_b32 s11, s28, 7
s_cmp_ge_u32 s25, 4
s_cbranch_scc1 L1_typeQ
v_xor_b32 v30, 0, v29
v_lshlrev_b32 v30, 5, v30
v_lshl_add_u32 v30, v27, 6, v30
v_lshl_add_u32 v30, v26, 3, v30
v_add_u32 v12, 0x20000, v30
v_xor_b32 v30, 1, v29
v_lshlrev_b32 v30, 5, v30
v_lshl_add_u32 v30, v27, 6, v30
v_lshl_add_u32 v30, v26, 3, v30
v_add_u32 v13, 0x20000, v30
s_add_u32 s30, s11, 2048
s_sub_u32 s31, 6291456, s30
s_add_u32 s32, s6, s30
s_addc_u32 s33, s7, 0
s_mov_b32 s34, s31
s_mov_b32 s35, 0x20000
s_add_u32 s30, s11, 4096
s_sub_u32 s31, 6291456, s30
s_add_u32 s36, s6, s30
s_addc_u32 s37, s7, 0
s_mov_b32 s38, s31
s_mov_b32 s39, 0x20000
s_lshl_b32 s30, s29, 8
s_add_u32 s30, s30, 512
s_add_u32 s30, s30, s10
s_sub_u32 s31, 7340032, s30
s_add_u32 s40, s12, s30
s_addc_u32 s41, s13, 0
s_mov_b32 s42, s31
s_mov_b32 s43, 0x20000
s_sub_u32 s31, 7340032, s30
s_add_u32 s44, s14, s30
s_addc_u32 s45, s15, 0
s_mov_b32 s46, s31
s_mov_b32 s47, 0x20000
s_lshl_b32 s31, s29, 13
s_add_u32 s83, s83, s31
s_lshl_b32 s30, s29, 6
s_add_u32 s30, s30, 640
s_add_u32 s30, s30, s10
s_cmp_ge_u32 s24, 2
s_cselect_b32 s10, s14, s12
s_cselect_b32 s11, s15, s13
s_sub_u32 s31, 7340032, s30
s_add_u32 s48, s10, s30
s_addc_u32 s49, s11, 0
s_mov_b32 s50, s31
s_mov_b32 s51, 0x20000
s_lshl_b32 s30, s26, 5
v_mov_b32 v30, s30
s_or_b32 s30, s25, s27
s_xor_b32 s31, s24, 3
s_or_b32 s30, s30, s31
s_cmp_lg_u32 s30, 0
s_cbranch_scc1 Lm4
s_waitcnt vmcnt(4)
v_mov_b32 v25, 1
s_mov_b64 exec, 1
global_store_dword v30, v25, s[20:21] sc0 sc1
s_mov_b64 exec, -1
Lm4:
s_add_u32 m0, s78, 0
s_nop 0
buffer_load_dwordx4 v16, s[32:35], s72 offen nt lds
s_add_u32 m0, s78, 4096
s_nop 0
buffer_load_dwordx4 v16, s[32:35], s73 offen nt lds
s_add_u32 m0, s78, 32768
s_nop 0
buffer_load_dwordx4 v16, s[36:39], s72 offen nt lds
s_add_u32 m0, s78, 36864
s_nop 0
buffer_load_dwordx4 v16, s[36:39], s73 offen nt lds
s_add_u32 m0, s78, 65536
s_nop 0
buffer_load_dwordx4 v17, s[40:43], s74 offen nt lds
s_add_u32 m0, s78, 69632
s_nop 0
buffer_load_dwordx4 v17, s[40:43], s75 offen nt lds
s_add_u32 m0, s78, 98304
s_nop 0
buffer_load_dwordx4 v17, s[44:47], s74 offen nt lds
s_add_u32 m0, s78, 102400
s_nop 0
buffer_load_dwordx4 v17, s[44:47], s75 offen nt lds
s_add_u32 m0, s79, 131072
s_nop 0
buffer_load_dwordx4 v18, s[48:51], s74 offen nt lds
s_add_u32 m0, s79, 133120
s_nop 0
buffer_load_dwordx4 v18, s[48:51], s75 offen nt lds
s_add_u32 s72, s72, 393216
s_add_u32 s73, s73, 393216
s_add_u32 s74, s74, 458752
s_add_u32 s75, s75, 458752
s_waitcnt vmcnt(10)
s_mov_b32 s3, 0xffff0000
v_lshlrev_b32 v80, 16, v64
v_and_b32 v81, s3, v64
v_lshlrev_b32 v82, 16, v65
v_and_b32 v83, s3, v65
v_lshlrev_b32 v84, 16, v66
v_and_b32 v85, s3, v66
v_lshlrev_b32 v86, 16, v67
v_and_b32 v87, s3, v67
v_lshlrev_b32 v88, 16, v68
v_and_b32 v89, s3, v68
v_lshlrev_b32 v90, 16, v69
v_and_b32 v91, s3, v69
v_lshlrev_b32 v92, 16, v70
v_and_b32 v93, s3, v70
v_lshlrev_b32 v94, 16, v71
v_and_b32 v95, s3, v71
v_lshlrev_b32 v96, 16, v72
v_and_b32 v97, s3, v72
v_lshlrev_b32 v98, 16, v73
v_and_b32 v99, s3, v73
v_lshlrev_b32 v100, 16, v74
v_and_b32 v101, s3, v74
v_lshlrev_b32 v102, 16, v75
v_and_b32 v103, s3, v75
v_lshlrev_b32 v104, 16, v76
v_and_b32 v105, s3, v76
v_lshlrev_b32 v106, 16, v77
v_and_b32 v107, s3, v77
v_lshlrev_b32 v108, 16, v78
v_and_b32 v109, s3, v78
v_lshlrev_b32 v110, 16, v79
v_and_b32 v111, s3, v79
v_pk_add_f32 v[112:113], v[80:81], v[84:85]
v_pk_add_f32 v[114:115], v[82:83], v[86:87]
v_pk_add_f32 v[112:113], v[112:113], v[88:89]
v_pk_add_f32 v[114:115], v[114:115], v[90:91]
v_pk_add_f32 v[112:113], v[112:113], v[92:93]
v_pk_add_f32 v[114:115], v[114:115], v[94:95]
v_pk_add_f32 v[112:113], v[112:113], v[96:97]
v_pk_add_f32 v[114:115], v[114:115], v[98:99]
v_pk_add_f32 v[112:113], v[112:113], v[100:101]
v_pk_add_f32 v[114:115], v[114:115], v[102:103]
v_pk_add_f32 v[112:113], v[112:113], v[104:105]
v_pk_add_f32 v[114:115], v[114:115], v[106:107]
v_pk_add_f32 v[112:113], v[112:113], v[108:109]
v_pk_add_f32 v[114:115], v[114:115], v[110:111]
v_pk_add_f32 v[112:113], v[112:113], v[114:115]
v_add_f32 v112, v112, v113
s_nop 1
v_add_f32_dpp v112, v112, v112 quad_perm:[1,0,3,2] row_mask:0xf bank_mask:0xf
s_nop 1
v_add_f32_dpp v112, v112, v112 quad_perm:[2,3,0,1] row_mask:0xf bank_mask:0xf
s_nop 1
v_add_f32_dpp v112, v112, v112 row_half_mirror row_mask:0xf bank_mask:0xf
s_nop 1
v_add_f32_dpp v112, v112, v112 row_mirror row_mask:0xf bank_mask:0xf
v_mov_b32 v113, v112
s_nop 1
v_permlane16_swap_b32 v113, v112
v_add_f32 v112, v112, v113
v_mul_f32 v112, 0xba800000, v112
v_mov_b32 v113, v112
v_pk_add_f32 v[64:65], v[80:81], v[112:113]
v_pk_mul_f32 v[116:117], v[64:65], v[64:65]
v_pk_add_f32 v[66:67], v[82:83], v[112:113]
v_pk_mul_f32 v[118:119], v[66:67], v[66:67]
v_pk_add_f32 v[68:69], v[84:85], v[112:113]
v_pk_fma_f32 v[116:117], v[68:69], v[68:69], v[116:117]
v_pk_add_f32 v[70:71], v[86:87], v[112:113]
v_pk_fma_f32 v[118:119], v[70:71], v[70:71], v[118:119]
v_pk_add_f32 v[64:65], v[88:89], v[112:113]
v_pk_fma_f32 v[116:117], v[64:65], v[64:65], v[116:117]
v_pk_add_f32 v[66:67], v[90:91], v[112:113]
v_pk_fma_f32 v[118:119], v[66:67], v[66:67], v[118:119]
v_pk_add_f32 v[68:69], v[92:93], v[112:113]
v_pk_fma_f32 v[116:117], v[68:69], v[68:69], v[116:117]
v_pk_add_f32 v[70:71], v[94:95], v[112:113]
v_pk_fma_f32 v[118:119], v[70:71], v[70:71], v[118:119]
v_pk_add_f32 v[64:65], v[96:97], v[112:113]
v_pk_fma_f32 v[116:117], v[64:65], v[64:65], v[116:117]
v_pk_add_f32 v[66:67], v[98:99], v[112:113]
v_pk_fma_f32 v[118:119], v[66:67], v[66:67], v[118:119]
v_pk_add_f32 v[68:69], v[100:101], v[112:113]
v_pk_fma_f32 v[116:117], v[68:69], v[68:69], v[116:117]
v_pk_add_f32 v[70:71], v[102:103], v[112:113]
v_pk_fma_f32 v[118:119], v[70:71], v[70:71], v[118:119]
v_pk_add_f32 v[64:65], v[104:105], v[112:113]
v_pk_fma_f32 v[116:117], v[64:65], v[64:65], v[116:117]
v_pk_add_f32 v[66:67], v[106:107], v[112:113]
v_pk_fma_f32 v[118:119], v[66:67], v[66:67], v[118:119]
v_pk_add_f32 v[68:69], v[108:109], v[112:113]
v_pk_fma_f32 v[116:117], v[68:69], v[68:69], v[116:117]
v_pk_add_f32 v[70:71], v[110:111], v[112:113]
v_pk_fma_f32 v[118:119], v[70:71], v[70:71], v[118:119]
v_pk_add_f32 v[116:117], v[116:117], v[118:119]
v_add_f32 v116, v116, v117
v_cvt_pk_bf16_f32 v112, v112, v112
v_and_b32 v112, s3, v112
v_mov_b32 v113, v112
v_add_f32_dpp v116, v116, v116 quad_perm:[1,0,3,2] row_mask:0xf bank_mask:0xf
s_nop 1
v_add_f32_dpp v116, v116, v116 quad_perm:[2,3,0,1] row_mask:0xf bank_mask:0xf
s_nop 1
v_add_f32_dpp v116, v116, v116 row_half_mirror row_mask:0xf bank_mask:0xf
s_nop 1
v_add_f32_dpp v116, v116, v116 row_mirror row_mask:0xf bank_mask:0xf
v_mov_b32 v117, v116
s_nop 1
v_permlane16_swap_b32 v117, v116
v_add_f32 v116, v116, v117
v_pk_add_f32 v[80:81], v[80:81], v[112:113]
v_mul_f32 v116, 0x3a800000, v116
v_cvt_pk_bf16_f32 v81, v80, v81
v_lshlrev_b32 v80, 16, v81
v_and_b32 v81, s3, v81
v_pk_add_f32 v[82:83], v[82:83], v[112:113]
v_cvt_pk_bf16_f32 v116, v116, v116
v_cvt_pk_bf16_f32 v83, v82, v83
v_lshlrev_b32 v82, 16, v83
v_and_b32 v83, s3, v83
v_pk_add_f32 v[84:85], v[84:85], v[112:113]
v_and_b32 v116, s3, v116
v_cvt_pk_bf16_f32 v85, v84, v85
v_lshlrev_b32 v84, 16, v85
v_and_b32 v85, s3, v85
v_pk_add_f32 v[86:87], v[86:87], v[112:113]
s_add_u32 m0, s78, 8192
v_add_f32 v116, 0x3727c5ac, v116
v_cvt_pk_bf16_f32 v87, v86, v87
buffer_load_dwordx4 v16, s[32:35], s72 offen nt lds
v_lshlrev_b32 v86, 16, v87
v_and_b32 v87, s3, v87
v_pk_add_f32 v[88:89], v[88:89], v[112:113]
v_cvt_pk_bf16_f32 v116, v116, v116
v_cvt_pk_bf16_f32 v89, v88, v89
v_lshlrev_b32 v88, 16, v89
v_and_b32 v89, s3, v89
v_pk_add_f32 v[90:91], v[90:91], v[112:113]
s_add_u32 m0, s78, 12288
v_and_b32 v116, s3, v116
v_cvt_pk_bf16_f32 v91, v90, v91
buffer_load_dwordx4 v16, s[32:35], s73 offen nt lds
v_lshlrev_b32 v90, 16, v91
v_and_b32 v91, s3, v91
v_pk_add_f32 v[92:93], v[92:93], v[112:113]
v_sqrt_f32 v116, v116
v_cvt_pk_bf16_f32 v93, v92, v93
v_lshlrev_b32 v92, 16, v93
v_and_b32 v93, s3, v93
v_pk_add_f32 v[94:95], v[94:95], v[112:113]
s_add_u32 m0, s78, 40960
v_cvt_pk_bf16_f32 v116, v116, v116
v_cvt_pk_bf16_f32 v95, v94, v95
buffer_load_dwordx4 v16, s[36:39], s72 offen nt lds
v_lshlrev_b32 v94, 16, v95
v_and_b32 v95, s3, v95
v_pk_add_f32 v[96:97], v[96:97], v[112:113]
v_and_b32 v116, s3, v116
v_cvt_pk_bf16_f32 v97, v96, v97
v_lshlrev_b32 v96, 16, v97
v_and_b32 v97, s3, v97
v_pk_add_f32 v[98:99], v[98:99], v[112:113]
s_add_u32 m0, s78, 45056
v_rcp_f32 v116, v116
v_cvt_pk_bf16_f32 v99, v98, v99
buffer_load_dwordx4 v16, s[36:39], s73 offen nt lds
v_lshlrev_b32 v98, 16, v99
v_and_b32 v99, s3, v99
v_pk_add_f32 v[100:101], v[100:101], v[112:113]
v_mov_b32 v117, v116
v_cvt_pk_bf16_f32 v101, v100, v101
v_lshlrev_b32 v100, 16, v101
v_and_b32 v101, s3, v101
v_pk_add_f32 v[102:103], v[102:103], v[112:113]
v_cvt_pk_bf16_f32 v103, v102, v103
v_lshlrev_b32 v102, 16, v103
v_and_b32 v103, s3, v103
v_pk_add_f32 v[104:105], v[104:105], v[112:113]
v_cvt_pk_bf16_f32 v105, v104, v105
v_lshlrev_b32 v104, 16, v105
v_and_b32 v105, s3, v105
v_pk_add_f32 v[106:107], v[106:107], v[112:113]
v_cvt_pk_bf16_f32 v107, v106, v107
v_lshlrev_b32 v106, 16, v107
v_and_b32 v107, s3, v107
v_pk_add_f32 v[108:109], v[108:109], v[112:113]
v_cvt_pk_bf16_f32 v109, v108, v109
v_lshlrev_b32 v108, 16, v109
v_and_b32 v109, s3, v109
v_pk_add_f32 v[110:111], v[110:111], v[112:113]
v_cvt_pk_bf16_f32 v111, v110, v111
v_lshlrev_b32 v110, 16, v111
v_and_b32 v111, s3, v111
v_pk_mul_f32 v[80:81], v[80:81], v[116:117]
v_cvt_pk_bf16_f32 v64, v80, v81
v_pk_mul_f32 v[82:83], v[82:83], v[116:117]
v_cvt_pk_bf16_f32 v65, v82, v83
v_pk_mul_f32 v[84:85], v[84:85], v[116:117]
v_cvt_pk_bf16_f32 v66, v84, v85
v_pk_mul_f32 v[86:87], v[86:87], v[116:117]
v_cvt_pk_bf16_f32 v67, v86, v87
v_pk_mul_f32 v[88:89], v[88:89], v[116:117]
v_cvt_pk_bf16_f32 v68, v88, v89
v_pk_mul_f32 v[90:91], v[90:91], v[116:117]
v_cvt_pk_bf16_f32 v69, v90, v91
v_pk_mul_f32 v[92:93], v[92:93], v[116:117]
v_cvt_pk_bf16_f32 v70, v92, v93
v_pk_mul_f32 v[94:95], v[94:95], v[116:117]
v_cvt_pk_bf16_f32 v71, v94, v95
v_pk_mul_f32 v[96:97], v[96:97], v[116:117]
v_cvt_pk_bf16_f32 v72, v96, v97
v_pk_mul_f32 v[98:99], v[98:99], v[116:117]
v_cvt_pk_bf16_f32 v73, v98, v99
v_pk_mul_f32 v[100:101], v[100:101], v[116:117]
v_cvt_pk_bf16_f32 v74, v100, v101
v_pk_mul_f32 v[102:103], v[102:103], v[116:117]
v_cvt_pk_bf16_f32 v75, v102, v103
v_pk_mul_f32 v[104:105], v[104:105], v[116:117]
v_cvt_pk_bf16_f32 v76, v104, v105
v_pk_mul_f32 v[106:107], v[106:107], v[116:117]
v_cvt_pk_bf16_f32 v77, v106, v107
v_pk_mul_f32 v[108:109], v[108:109], v[116:117]
v_cvt_pk_bf16_f32 v78, v108, v109
v_pk_mul_f32 v[110:111], v[110:111], v[116:117]
v_cvt_pk_bf16_f32 v79, v110, v111
global_load_dword v29, v30, s[20:21] sc1
ds_write_b128 v22, v[64:67] offset:24576
ds_write_b128 v22, v[68:71] offset:28672
ds_write_b128 v22, v[72:75] offset:57344
ds_write_b128 v22, v[76:79] offset:61440
s_waitcnt lgkmcnt(0)
s_barrier
ds_read_b128 v[64:67], v21 offset:24576
ds_read_b128 v[68:71], v21 offset:25600
ds_read_b128 v[72:75], v21 offset:26624
ds_read_b128 v[76:79], v21 offset:27648
s_waitcnt lgkmcnt(3)
global_store_dwordx4 v23, v[64:67], s[22:23] sc0 sc1
v_add_u32 v23, 0x2000, v23
s_waitcnt lgkmcnt(2)
global_store_dwordx4 v23, v[68:71], s[22:23] sc0 sc1
v_add_u32 v23, 0x2000, v23
s_waitcnt lgkmcnt(1)
global_store_dwordx4 v23, v[72:75], s[22:23] sc0 sc1
v_add_u32 v23, 0x2000, v23
s_waitcnt lgkmcnt(0)
global_store_dwordx4 v23, v[76:79], s[22:23] sc0 sc1
v_mov_b32 v255, 0
v_mov_b32 v254, 0
v_mov_b32 v253, 0
v_mov_b32 v252, 0
s_add_u32 m0, s78, 73728
v_mov_b32 v251, 0
v_mov_b32 v250, 0
buffer_load_dwordx4 v17, s[40:43], s74 offen nt lds
v_mov_b32 v249, 0
v_mov_b32 v248, 0
v_mov_b32 v247, 0
v_mov_b32 v246, 0
s_add_u32 m0, s78, 77824
v_mov_b32 v245, 0
v_mov_b32 v244, 0
buffer_load_dwordx4 v17, s[40:43], s75 offen nt lds
v_mov_b32 v243, 0
v_mov_b32 v242, 0
v_mov_b32 v241, 0
v_mov_b32 v240, 0
s_add_u32 m0, s78, 106496
v_mov_b32 v239, 0
v_mov_b32 v238, 0
buffer_load_dwordx4 v17, s[44:47], s74 offen nt lds
v_mov_b32 v237, 0
v_mov_b32 v236, 0
v_mov_b32 v235, 0
v_mov_b32 v234, 0
s_add_u32 m0, s78, 110592
v_mov_b32 v233, 0
v_mov_b32 v232, 0
buffer_load_dwordx4 v17, s[44:47], s75 offen nt lds
v_mov_b32 v231, 0
v_mov_b32 v230, 0
v_mov_b32 v229, 0
v_mov_b32 v228, 0
s_add_u32 m0, s79, 139264
v_mov_b32 v227, 0
v_mov_b32 v226, 0
buffer_load_dwordx4 v18, s[48:51], s74 offen nt lds
v_mov_b32 v225, 0
v_mov_b32 v224, 0
v_mov_b32 v223, 0
v_mov_b32 v222, 0
s_add_u32 m0, s79, 141312
v_mov_b32 v221, 0
v_mov_b32 v220, 0
buffer_load_dwordx4 v18, s[48:51], s75 offen nt lds
v_mov_b32 v219, 0
v_mov_b32 v218, 0
v_mov_b32 v217, 0
v_mov_b32 v216, 0
v_mov_b32 v215, 0
v_mov_b32 v214, 0
v_mov_b32 v213, 0
v_mov_b32 v212, 0
v_mov_b32 v211, 0
v_mov_b32 v210, 0
v_mov_b32 v209, 0
v_mov_b32 v208, 0
v_mov_b32 v207, 0
v_mov_b32 v206, 0
v_mov_b32 v205, 0
v_mov_b32 v204, 0
v_mov_b32 v203, 0
v_mov_b32 v202, 0
v_mov_b32 v201, 0
v_mov_b32 v200, 0
v_mov_b32 v199, 0
v_mov_b32 v198, 0
v_mov_b32 v197, 0
v_mov_b32 v196, 0
v_mov_b32 v195, 0
v_mov_b32 v194, 0
v_mov_b32 v193, 0
v_mov_b32 v192, 0
s_waitcnt vmcnt(6)
s_barrier
s_cmp_lg_u32 s24, 0
s_cbranch_scc1 La5
v_readfirstlane_b32 s30, v29
s_nop 0
s_cmp_ge_u32 s30, 1
s_cbranch_scc1 Ld7
s_mov_b32 s31, 262144
Lp6:
global_load_dword v29, v30, s[20:21] offset:0 sc1
s_waitcnt vmcnt(0)
v_readfirstlane_b32 s30, v29
s_nop 0
s_cmp_ge_u32 s30, 1
s_cbranch_scc1 Ld7
s_sleep 1
s_sub_u32 s31, s31, 1
s_cmp_lg_u32 s31, 0
s_cbranch_scc1 Lp6
Ld7:
s_lshl_b32 s30, s27, 3
s_add_u32 s30, s30, s25
s_lshl_b64 exec, 1, s30
v_mov_b32 v25, 1
global_store_dword v31, v25, s[22:23] sc0 sc1
s_mov_b64 exec, -1
La5:
v_accvgpr_write_b32 a127, 0
v_accvgpr_write_b32 a126, 0
v_accvgpr_write_b32 a125, 0
v_accvgpr_write_b32 a124, 0
v_accvgpr_write_b32 a123, 0
v_accvgpr_write_b32 a122, 0
s_add_u32 s72, s72, 393216
s_add_u32 s73, s73, 393216
s_add_u32 s74, s74, 458752
s_add_u32 s75, s75, 458752
s_add_u32 m0, s78, 16384
v_accvgpr_write_b32 a121, 0
v_accvgpr_write_b32 a120, 0
buffer_load_dwordx4 v16, s[32:35], s72 offen nt lds
v_accvgpr_write_b32 a119, 0
v_accvgpr_write_b32 a118, 0
v_accvgpr_write_b32 a117, 0
v_accvgpr_write_b32 a116, 0
v_accvgpr_write_b32 a115, 0
v_accvgpr_write_b32 a114, 0
s_add_u32 m0, s78, 20480
v_accvgpr_write_b32 a113, 0
v_accvgpr_write_b32 a112, 0
buffer_load_dwordx4 v16, s[32:35], s73 offen nt lds
v_accvgpr_write_b32 a111, 0
v_accvgpr_write_b32 a110, 0
v_accvgpr_write_b32 a109, 0
v_accvgpr_write_b32 a108, 0
v_accvgpr_write_b32 a107, 0
v_accvgpr_write_b32 a106, 0
s_add_u32 m0, s78, 49152
v_accvgpr_write_b32 a105, 0
v_accvgpr_write_b32 a104, 0
buffer_load_dwordx4 v16, s[36:39], s72 offen nt lds
v_accvgpr_write_b32 a103, 0
v_accvgpr_write_b32 a102, 0
v_accvgpr_write_b32 a101, 0
v_accvgpr_write_b32 a100, 0
v_accvgpr_write_b32 a99, 0
v_accvgpr_write_b32 a98, 0
s_add_u32 m0, s78, 53248
v_accvgpr_write_b32 a97, 0
v_accvgpr_write_b32 a96, 0
buffer_load_dwordx4 v16, s[36:39], s73 offen nt lds
v_accvgpr_write_b32 a95, 0
v_accvgpr_write_b32 a94, 0
v_accvgpr_write_b32 a93, 0
v_accvgpr_write_b32 a92, 0
v_accvgpr_write_b32 a91, 0
v_accvgpr_write_b32 a90, 0
s_add_u32 m0, s78, 81920
v_accvgpr_write_b32 a89, 0
v_accvgpr_write_b32 a88, 0
buffer_load_dwordx4 v17, s[40:43], s74 offen nt lds
v_accvgpr_write_b32 a87, 0
v_accvgpr_write_b32 a86, 0
v_accvgpr_write_b32 a85, 0
v_accvgpr_write_b32 a84, 0
v_accvgpr_write_b32 a83, 0
v_accvgpr_write_b32 a82, 0
s_add_u32 m0, s78, 86016
v_accvgpr_write_b32 a81, 0
v_accvgpr_write_b32 a80, 0
buffer_load_dwordx4 v17, s[40:43], s75 offen nt lds
v_accvgpr_write_b32 a79, 0
v_accvgpr_write_b32 a78, 0
v_accvgpr_write_b32 a77, 0
v_accvgpr_write_b32 a76, 0
v_accvgpr_write_b32 a75, 0
v_accvgpr_write_b32 a74, 0
s_add_u32 m0, s78, 114688
v_accvgpr_write_b32 a73, 0
v_accvgpr_write_b32 a72, 0
buffer_load_dwordx4 v17, s[44:47], s74 offen nt lds
v_accvgpr_write_b32 a71, 0
v_accvgpr_write_b32 a70, 0
v_accvgpr_write_b32 a69, 0
v_accvgpr_write_b32 a68, 0
v_accvgpr_write_b32 a67, 0
v_accvgpr_write_b32 a66, 0
s_add_u32 m0, s78, 118784
v_accvgpr_write_b32 a65, 0
v_accvgpr_write_b32 a64, 0
buffer_load_dwordx4 v17, s[44:47], s75 offen nt lds
v_mov_b32 v191, 0
v_mov_b32 v190, 0
v_mov_b32 v189, 0
v_mov_b32 v188, 0
v_mov_b32 v187, 0
v_mov_b32 v186, 0
s_add_u32 m0, s79, 147456
v_mov_b32 v185, 0
v_mov_b32 v184, 0
buffer_load_dwordx4 v18, s[48:51], s74 offen nt lds
v_mov_b32 v183, 0
v_mov_b32 v182, 0
v_mov_b32 v181, 0
v_mov_b32 v180, 0
v_mov_b32 v179, 0
v_mov_b32 v178, 0
s_add_u32 m0, s79, 149504
v_mov_b32 v177, 0
v_mov_b32 v176, 0
buffer_load_dwordx4 v18, s[48:51], s75 offen nt lds
v_mov_b32 v175, 0
v_mov_b32 v174, 0
v_mov_b32 v173, 0
v_mov_b32 v172, 0
v_mov_b32 v171, 0
v_mov_b32 v170, 0
v_mov_b32 v169, 0
v_mov_b32 v168, 0
v_mov_b32 v167, 0
v_mov_b32 v166, 0
v_mov_b32 v165, 0
v_mov_b32 v164, 0
v_mov_b32 v163, 0
v_mov_b32 v162, 0
v_mov_b32 v161, 0
v_mov_b32 v160, 0
v_mov_b32 v159, 0
v_mov_b32 v158, 0
v_mov_b32 v157, 0
v_mov_b32 v156, 0
v_mov_b32 v155, 0
v_mov_b32 v154, 0
v_mov_b32 v153, 0
v_mov_b32 v152, 0
v_mov_b32 v151, 0
v_mov_b32 v150, 0
v_mov_b32 v149, 0
v_mov_b32 v148, 0
v_mov_b32 v147, 0
v_mov_b32 v146, 0
v_mov_b32 v145, 0
v_mov_b32 v144, 0
v_mov_b32 v143, 0
v_mov_b32 v142, 0
v_mov_b32 v141, 0
v_mov_b32 v140, 0
v_mov_b32 v139, 0
v_mov_b32 v138, 0
v_mov_b32 v137, 0
v_mov_b32 v136, 0
v_mov_b32 v135, 0
v_mov_b32 v134, 0
v_mov_b32 v133, 0
v_mov_b32 v132, 0
v_mov_b32 v131, 0
v_mov_b32 v130, 0
v_mov_b32 v129, 0
v_mov_b32 v128, 0
v_accvgpr_write_b32 a63, 0
v_accvgpr_write_b32 a62, 0
v_accvgpr_write_b32 a61, 0
v_accvgpr_write_b32 a60, 0
v_accvgpr_write_b32 a59, 0
v_accvgpr_write_b32 a58, 0
v_accvgpr_write_b32 a57, 0
v_accvgpr_write_b32 a56, 0
v_accvgpr_write_b32 a55, 0
v_accvgpr_write_b32 a54, 0
v_accvgpr_write_b32 a53, 0
v_accvgpr_write_b32 a52, 0
v_accvgpr_write_b32 a51, 0
v_accvgpr_write_b32 a50, 0
v_accvgpr_write_b32 a49, 0
v_accvgpr_write_b32 a48, 0
v_accvgpr_write_b32 a47, 0
v_accvgpr_write_b32 a46, 0
v_accvgpr_write_b32 a45, 0
v_accvgpr_write_b32 a44, 0
v_accvgpr_write_b32 a43, 0
v_accvgpr_write_b32 a42, 0
v_accvgpr_write_b32 a41, 0
v_accvgpr_write_b32 a40, 0
v_accvgpr_write_b32 a39, 0
v_accvgpr_write_b32 a38, 0
v_accvgpr_write_b32 a37, 0
v_accvgpr_write_b32 a36, 0
v_accvgpr_write_b32 a35, 0
v_accvgpr_write_b32 a34, 0
v_accvgpr_write_b32 a33, 0
v_accvgpr_write_b32 a32, 0
v_accvgpr_write_b32 a31, 0
v_accvgpr_write_b32 a30, 0
v_accvgpr_write_b32 a29, 0
v_accvgpr_write_b32 a28, 0
v_accvgpr_write_b32 a27, 0
v_accvgpr_write_b32 a26, 0
v_accvgpr_write_b32 a25, 0
v_accvgpr_write_b32 a24, 0
v_accvgpr_write_b32 a23, 0
v_accvgpr_write_b32 a22, 0
v_accvgpr_write_b32 a21, 0
v_accvgpr_write_b32 a20, 0
v_accvgpr_write_b32 a19, 0
v_accvgpr_write_b32 a18, 0
v_accvgpr_write_b32 a17, 0
v_accvgpr_write_b32 a16, 0
v_accvgpr_write_b32 a15, 0
v_accvgpr_write_b32 a14, 0
v_accvgpr_write_b32 a13, 0
v_accvgpr_write_b32 a12, 0
v_accvgpr_write_b32 a11, 0
v_accvgpr_write_b32 a10, 0
v_accvgpr_write_b32 a9, 0
v_accvgpr_write_b32 a8, 0
v_accvgpr_write_b32 a7, 0
v_accvgpr_write_b32 a6, 0
v_accvgpr_write_b32 a5, 0
v_accvgpr_write_b32 a4, 0
v_accvgpr_write_b32 a3, 0
v_accvgpr_write_b32 a2, 0
v_accvgpr_write_b32 a1, 0
v_accvgpr_write_b32 a0, 0
v_mov_b32 v127, 0
v_mov_b32 v126, 0
v_mov_b32 v125, 0
v_mov_b32 v124, 0
v_mov_b32 v123, 0
v_mov_b32 v122, 0
v_mov_b32 v121, 0
v_mov_b32 v120, 0
v_mov_b32 v119, 0
v_mov_b32 v118, 0
v_mov_b32 v117, 0
v_mov_b32 v116, 0
v_mov_b32 v115, 0
v_mov_b32 v114, 0
v_mov_b32 v113, 0
v_mov_b32 v112, 0
v_mov_b32 v111, 0
v_mov_b32 v110, 0
v_mov_b32 v109, 0
v_mov_b32 v108, 0
v_mov_b32 v107, 0
v_mov_b32 v106, 0
v_mov_b32 v105, 0
v_mov_b32 v104, 0
v_mov_b32 v103, 0
v_mov_b32 v102, 0
v_mov_b32 v101, 0
v_mov_b32 v100, 0
v_mov_b32 v99, 0
v_mov_b32 v98, 0
v_mov_b32 v97, 0
v_mov_b32 v96, 0
v_mov_b32 v95, 0
v_mov_b32 v94, 0
v_mov_b32 v93, 0
v_mov_b32 v92, 0
v_mov_b32 v91, 0
v_mov_b32 v90, 0
v_mov_b32 v89, 0
v_mov_b32 v88, 0
v_mov_b32 v87, 0
v_mov_b32 v86, 0
v_mov_b32 v85, 0
v_mov_b32 v84, 0
v_mov_b32 v83, 0
v_mov_b32 v82, 0
v_mov_b32 v81, 0
v_mov_b32 v80, 0
v_mov_b32 v79, 0
v_mov_b32 v78, 0
v_mov_b32 v77, 0
v_mov_b32 v76, 0
v_mov_b32 v75, 0
v_mov_b32 v74, 0
v_mov_b32 v73, 0
v_mov_b32 v72, 0
v_mov_b32 v71, 0
v_mov_b32 v70, 0
v_mov_b32 v69, 0
v_mov_b32 v68, 0
v_mov_b32 v67, 0
v_mov_b32 v66, 0
v_mov_b32 v65, 0
v_mov_b32 v64, 0
s_add_u32 s72, s72, 393216
s_add_u32 s73, s73, 393216
s_add_u32 s74, s74, 458752
s_add_u32 s75, s75, 458752
TR v[32:33],v4,0
TR v[34:35],v4,512
TR v[36:37],v4,4096
TR v[38:39],v4,4608
TR v[40:41],v5,0
TR v[42:43],v5,512
TR v[44:45],v5,4096
TR v[46:47],v5,4608
s_mov_b32 s80, 3
s_getpc_b64 s[10:11]
Lc8:
s_sub_u32 s10, s10, Lc8-recurrent_scan__linear_attn_block__glu_gated_swiglu__prompt_kernel
s_subb_u32 s11, s11, 0
s_lshr_b32 s30, s2, 3
s_lshl_b32 s30, s30, 2
s_add_u32 s30, s30, s24
s_lshl_b32 s30, s30, 10
s_min_u32 s30, s30, L_end-recurrent_scan__linear_attn_block__glu_gated_swiglu__prompt_kernel-1024
v_add_u32 v28, s30, v2
v_mov_b32 v29, s11
v_add_co_u32 v28, vcc, s10, v28
s_nop 1
v_addc_co_u32 v29, vcc, 0, v29, vcc
s_cmp_lg_u32 s24, 0
s_cbranch_scc1 Lw9
s_mov_b32 s31, 262144
Lp10:
global_load_dword v25, v31, s[22:23] sc1
s_waitcnt vmcnt(0)
v_cmp_ne_u32 vcc, 1, v25
s_nop 0
s_cmp_eq_u64 vcc, 0
s_cbranch_scc1 Ld11
s_sleep 2
s_sub_u32 s31, s31, 1
s_cmp_lg_u32 s31, 0
s_cbranch_scc1 Lp10
Ld11:
Lw9:
s_barrier
buffer_load_dwordx4 a[128:131], v2, s[52:55], s76 offen offset:0 sc1
buffer_load_dwordx4 a[132:135], v2, s[52:55], s76 offen offset:1024 sc1
buffer_load_dwordx4 a[136:139], v2, s[52:55], s76 offen offset:2048 sc1
buffer_load_dwordx4 a[140:143], v2, s[52:55], s76 offen offset:3072 sc1
buffer_load_dwordx4 a[144:147], v19, s[52:55], s76 offen offset:0 sc1
buffer_load_dwordx4 a[148:151], v19, s[52:55], s76 offen offset:1024 sc1
buffer_load_dwordx4 a[152:155], v19, s[52:55], s76 offen offset:2048 sc1
buffer_load_dwordx4 a[156:159], v19, s[52:55], s76 offen offset:3072 sc1
s_add_u32 s76, s76, 8192
buffer_load_dwordx4 a[160:163], v2, s[52:55], s76 offen offset:0 sc1
buffer_load_dwordx4 a[164:167], v2, s[52:55], s76 offen offset:1024 sc1
buffer_load_dwordx4 a[168:171], v2, s[52:55], s76 offen offset:2048 sc1
buffer_load_dwordx4 a[172:175], v2, s[52:55], s76 offen offset:3072 sc1
buffer_load_dwordx4 a[176:179], v19, s[52:55], s76 offen offset:0 sc1
buffer_load_dwordx4 a[180:183], v19, s[52:55], s76 offen offset:1024 sc1
buffer_load_dwordx4 a[184:187], v19, s[52:55], s76 offen offset:2048 sc1
buffer_load_dwordx4 a[188:191], v19, s[52:55], s76 offen offset:3072 sc1
s_add_u32 s76, s76, 8192
s_waitcnt vmcnt(8) lgkmcnt(4)
.p2align 6
L1KV_loop:
MM v[64:67],a[128:131],v[32:35]
TR v[48:49],v6,0
MM v[64:67],a[144:147],v[36:39]
buffer_load_dwordx4 v[20:23], v2, s[64:67], s81 offen
s_add_u32 s81, s81, 0x100000
MM v[68:71],a[132:135],v[32:35]
TR v[50:51],v6,512
MM v[68:71],a[148:151],v[36:39]
MM v[72:75],a[136:139],v[32:35]
TR v[52:53],v6,4096
MM v[72:75],a[152:155],v[36:39]
buffer_load_dwordx4 a[192:195], v2, s[52:55], s76 offen offset:0 sc1
MM v[76:79],a[140:143],v[32:35]
TR v[54:55],v6,4608
MM v[76:79],a[156:159],v[36:39]
s_waitcnt lgkmcnt(4)
MM v[80:83],a[128:131],v[40:43]
TR v[56:57],v7,0
MM v[80:83],a[144:147],v[44:47]
MM v[84:87],a[132:135],v[40:43]
TR v[58:59],v7,512
MM v[84:87],a[148:151],v[44:47]
buffer_load_dwordx4 a[196:199], v2, s[52:55], s76 offen offset:1024 sc1
MM v[88:91],a[136:139],v[40:43]
TR v[60:61],v7,4096
MM v[88:91],a[152:155],v[44:47]
MM v[92:95],a[140:143],v[40:43]
TR v[62:63],v7,4608
MM v[92:95],a[156:159],v[44:47]
s_waitcnt lgkmcnt(4)
MM v[96:99],a[128:131],v[48:51]
TR v[32:33],v4,32768
MM v[96:99],a[144:147],v[52:55]
MM v[100:103],a[132:135],v[48:51]
TR v[34:35],v4,33280
MM v[100:103],a[148:151],v[52:55]
buffer_load_dwordx4 a[200:203], v2, s[52:55], s76 offen offset:2048 sc1
MM v[104:107],a[136:139],v[48:51]
TR v[36:37],v4,36864
MM v[104:107],a[152:155],v[52:55]
MM v[108:111],a[140:143],v[48:51]
TR v[38:39],v4,37376
MM v[108:111],a[156:159],v[52:55]
s_waitcnt lgkmcnt(4)
MM v[112:115],a[128:131],v[56:59]
TR v[40:41],v5,32768
MM v[112:115],a[144:147],v[60:63]
MM v[116:119],a[132:135],v[56:59]
TR v[42:43],v5,33280
MM v[116:119],a[148:151],v[60:63]
buffer_load_dwordx4 a[204:207], v2, s[52:55], s76 offen offset:3072 sc1
MM v[120:123],a[136:139],v[56:59]
TR v[44:45],v5,36864
MM v[120:123],a[152:155],v[60:63]
MM v[124:127],a[140:143],v[56:59]
TR v[46:47],v5,37376
MM v[124:127],a[156:159],v[60:63]
s_waitcnt lgkmcnt(4)
MM a[0:3],a[128:131],v[32:35]
TR v[48:49],v6,32768
MM a[0:3],a[144:147],v[36:39]
MM a[4:7],a[132:135],v[32:35]
TR v[50:51],v6,33280
MM a[4:7],a[148:151],v[36:39]
buffer_load_dwordx4 a[208:211], v19, s[52:55], s76 offen offset:0 sc1
MM a[8:11],a[136:139],v[32:35]
TR v[52:53],v6,36864
MM a[8:11],a[152:155],v[36:39]
MM a[12:15],a[140:143],v[32:35]
TR v[54:55],v6,37376
MM a[12:15],a[156:159],v[36:39]
s_waitcnt lgkmcnt(4)
MM a[16:19],a[128:131],v[40:43]
TR v[56:57],v7,32768
MM a[16:19],a[144:147],v[44:47]
MM a[20:23],a[132:135],v[40:43]
TR v[58:59],v7,33280
MM a[20:23],a[148:151],v[44:47]
buffer_load_dwordx4 a[212:215], v19, s[52:55], s76 offen offset:1024 sc1
MM a[24:27],a[136:139],v[40:43]
TR v[60:61],v7,36864
MM a[24:27],a[152:155],v[44:47]
MM a[28:31],a[140:143],v[40:43]
TR v[62:63],v7,37376
MM a[28:31],a[156:159],v[44:47]
s_waitcnt lgkmcnt(4)
MM a[32:35],a[128:131],v[48:51]
TR v[32:33],v8,0
MM a[32:35],a[144:147],v[52:55]
MM a[36:39],a[132:135],v[48:51]
TR v[34:35],v8,512
MM a[36:39],a[148:151],v[52:55]
buffer_load_dwordx4 a[216:219], v19, s[52:55], s76 offen offset:2048 sc1
MM a[40:43],a[136:139],v[48:51]
TR v[36:37],v8,4096
MM a[40:43],a[152:155],v[52:55]
MM a[44:47],a[140:143],v[48:51]
TR v[38:39],v8,4608
MM a[44:47],a[156:159],v[52:55]
s_waitcnt lgkmcnt(4)
MM a[48:51],a[128:131],v[56:59]
TR v[40:41],v9,0
MM a[48:51],a[144:147],v[60:63]
MM a[52:55],a[132:135],v[56:59]
TR v[42:43],v9,512
MM a[52:55],a[148:151],v[60:63]
buffer_load_dwordx4 a[220:223], v19, s[52:55], s76 offen offset:3072 sc1
MM a[56:59],a[136:139],v[56:59]
TR v[44:45],v9,4096
MM a[56:59],a[152:155],v[60:63]
MM a[60:63],a[140:143],v[56:59]
TR v[46:47],v9,4608
MM a[60:63],a[156:159],v[60:63]
s_waitcnt lgkmcnt(4)
MM v[128:131],v[32:35],a[128:131]
TR v[48:49],v10,0
MM v[128:131],v[36:39],a[144:147]
MM v[132:135],v[32:35],a[132:135]
TR v[50:51],v10,512
s_add_u32 m0, s78, 24576
MM v[132:135],v[36:39],a[148:151]
buffer_load_dwordx4 v16, s[32:35], s72 offen nt lds
MM v[136:139],v[32:35],a[136:139]
TR v[52:53],v10,4096
MM v[136:139],v[36:39],a[152:155]
MM v[140:143],v[32:35],a[140:143]
TR v[54:55],v10,4608
MM v[140:143],v[36:39],a[156:159]
s_waitcnt lgkmcnt(4)
MM v[144:147],v[40:43],a[128:131]
TR v[56:57],v11,0
s_add_u32 m0, s78, 28672
MM v[144:147],v[44:47],a[144:147]
buffer_load_dwordx4 v16, s[32:35], s73 offen nt lds
MM v[148:151],v[40:43],a[132:135]
TR v[58:59],v11,512
MM v[148:151],v[44:47],a[148:151]
MM v[152:155],v[40:43],a[136:139]
TR v[60:61],v11,4096
MM v[152:155],v[44:47],a[152:155]
MM v[156:159],v[40:43],a[140:143]
TR v[62:63],v11,4608
MM v[156:159],v[44:47],a[156:159]
s_waitcnt lgkmcnt(4)
MM v[160:163],v[48:51],a[128:131]
TR v[32:33],v8,32768
s_add_u32 m0, s78, 57344
MM v[160:163],v[52:55],a[144:147]
buffer_load_dwordx4 v16, s[36:39], s72 offen nt lds
MM v[164:167],v[48:51],a[132:135]
TR v[34:35],v8,33280
MM v[164:167],v[52:55],a[148:151]
MM v[168:171],v[48:51],a[136:139]
TR v[36:37],v8,36864
MM v[168:171],v[52:55],a[152:155]
MM v[172:175],v[48:51],a[140:143]
TR v[38:39],v8,37376
MM v[172:175],v[52:55],a[156:159]
s_waitcnt lgkmcnt(4)
MM v[176:179],v[56:59],a[128:131]
TR v[40:41],v9,32768
s_add_u32 m0, s78, 61440
MM v[176:179],v[60:63],a[144:147]
buffer_load_dwordx4 v16, s[36:39], s73 offen nt lds
MM v[180:183],v[56:59],a[132:135]
TR v[42:43],v9,33280
MM v[180:183],v[60:63],a[148:151]
MM v[184:187],v[56:59],a[136:139]
TR v[44:45],v9,36864
MM v[184:187],v[60:63],a[152:155]
MM v[188:191],v[56:59],a[140:143]
TR v[46:47],v9,37376
MM v[188:191],v[60:63],a[156:159]
s_waitcnt lgkmcnt(4)
MM a[64:67],v[32:35],a[128:131]
TR v[48:49],v10,32768
s_add_u32 m0, s78, 90112
MM a[64:67],v[36:39],a[144:147]
buffer_load_dwordx4 v17, s[40:43], s74 offen nt lds
MM a[68:71],v[32:35],a[132:135]
TR v[50:51],v10,33280
MM a[68:71],v[36:39],a[148:151]
MM a[72:75],v[32:35],a[136:139]
TR v[52:53],v10,36864
MM a[72:75],v[36:39],a[152:155]
MM a[76:79],v[32:35],a[140:143]
TR v[54:55],v10,37376
MM a[76:79],v[36:39],a[156:159]
s_waitcnt lgkmcnt(4)
MM a[80:83],v[40:43],a[128:131]
TR v[56:57],v11,32768
s_add_u32 m0, s78, 94208
MM a[80:83],v[44:47],a[144:147]
buffer_load_dwordx4 v17, s[40:43], s75 offen nt lds
MM a[84:87],v[40:43],a[132:135]
TR v[58:59],v11,33280
MM a[84:87],v[44:47],a[148:151]
MM a[88:91],v[40:43],a[136:139]
TR v[60:61],v11,36864
MM a[88:91],v[44:47],a[152:155]
MM a[92:95],v[40:43],a[140:143]
TR v[62:63],v11,37376
MM a[92:95],v[44:47],a[156:159]
s_waitcnt lgkmcnt(4)
MM a[96:99],v[48:51],a[128:131]
TR v[32:33],v12,0
s_add_u32 m0, s78, 122880
MM a[96:99],v[52:55],a[144:147]
buffer_load_dwordx4 v17, s[44:47], s74 offen nt lds
MM a[100:103],v[48:51],a[132:135]
TR v[34:35],v12,256
MM a[100:103],v[52:55],a[148:151]
MM a[104:107],v[48:51],a[136:139]
TR v[36:37],v12,2048
MM a[104:107],v[52:55],a[152:155]
MM a[108:111],v[48:51],a[140:143]
TR v[38:39],v12,2304
MM a[108:111],v[52:55],a[156:159]
s_waitcnt lgkmcnt(4)
MM a[112:115],v[56:59],a[128:131]
TR v[40:41],v13,0
s_add_u32 m0, s78, 126976
MM a[112:115],v[60:63],a[144:147]
buffer_load_dwordx4 v17, s[44:47], s75 offen nt lds
MM a[116:119],v[56:59],a[132:135]
TR v[42:43],v13,256
MM a[116:119],v[60:63],a[148:151]
MM a[120:123],v[56:59],a[136:139]
TR v[44:45],v13,2048
MM a[120:123],v[60:63],a[152:155]
MM a[124:127],v[56:59],a[140:143]
TR v[46:47],v13,2304
MM a[124:127],v[60:63],a[156:159]
s_waitcnt lgkmcnt(4)
MM v[192:195],v[32:35],a[128:131]
TR v[48:49],v12,4096
s_add_u32 m0, s79, 155648
MM v[192:195],v[36:39],a[144:147]
buffer_load_dwordx4 v18, s[48:51], s74 offen nt lds
MM v[196:199],v[32:35],a[132:135]
TR v[50:51],v12,4352
MM v[196:199],v[36:39],a[148:151]
MM v[200:203],v[32:35],a[136:139]
TR v[52:53],v12,6144
MM v[200:203],v[36:39],a[152:155]
MM v[204:207],v[32:35],a[140:143]
TR v[54:55],v12,6400
MM v[204:207],v[36:39],a[156:159]
s_waitcnt lgkmcnt(4)
MM v[208:211],v[40:43],a[128:131]
TR v[56:57],v13,4096
s_add_u32 m0, s79, 157696
MM v[208:211],v[44:47],a[144:147]
buffer_load_dwordx4 v18, s[48:51], s75 offen nt lds
MM v[212:215],v[40:43],a[132:135]
TR v[58:59],v13,4352
MM v[212:215],v[44:47],a[148:151]
MM v[216:219],v[40:43],a[136:139]
TR v[60:61],v13,6144
MM v[216:219],v[44:47],a[152:155]
MM v[220:223],v[40:43],a[140:143]
TR v[62:63],v13,6400
MM v[220:223],v[44:47],a[156:159]
s_waitcnt lgkmcnt(4)
MM v[224:227],v[48:51],a[128:131]
MM v[224:227],v[52:55],a[144:147]
s_waitcnt vmcnt(19) lgkmcnt(0)
s_barrier
MM v[228:231],v[48:51],a[132:135]
TR v[32:33],v4,8192
MM v[228:231],v[52:55],a[148:151]
TR v[34:35],v4,8704
MM v[232:235],v[48:51],a[136:139]
TR v[36:37],v4,12288
MM v[232:235],v[52:55],a[152:155]
TR v[38:39],v4,12800
MM v[236:239],v[48:51],a[140:143]
MM v[236:239],v[52:55],a[156:159]
MM v[240:243],v[56:59],a[128:131]
TR v[40:41],v5,8192
MM v[240:243],v[60:63],a[144:147]
s_add_u32 s72, s72, 393216
s_add_u32 s73, s73, 393216
MM v[244:247],v[56:59],a[132:135]
TR v[42:43],v5,8704
MM v[244:247],v[60:63],a[148:151]
s_add_u32 s74, s74, 458752
s_add_u32 s75, s75, 458752
MM v[248:251],v[56:59],a[136:139]
TR v[44:45],v5,12288
MM v[248:251],v[60:63],a[152:155]
s_add_u32 s76, s76, 8192
MM v[252:255],v[56:59],a[140:143]
TR v[46:47],v5,12800
MM v[252:255],v[60:63],a[156:159]
s_waitcnt lgkmcnt(4)
L1KV_s1:
MM v[64:67],a[160:163],v[32:35]
TR v[48:49],v6,8192
MM v[64:67],a[176:179],v[36:39]
buffer_load_dwordx4 v[20:23], v2, s[64:67], s81 offen
s_add_u32 s81, s81, 0x100000
MM v[68:71],a[164:167],v[32:35]
TR v[50:51],v6,8704
MM v[68:71],a[180:183],v[36:39]
global_load_dwordx4 v[24:27], v[28:29], off
MM v[72:75],a[168:171],v[32:35]
TR v[52:53],v6,12288
MM v[72:75],a[184:187],v[36:39]
MM v[76:79],a[172:175],v[32:35]
TR v[54:55],v6,12800
MM v[76:79],a[188:191],v[36:39]
s_waitcnt lgkmcnt(4)
buffer_load_dwordx4 a[224:227], v2, s[52:55], s76 offen offset:0 sc1
MM v[80:83],a[160:163],v[40:43]
TR v[56:57],v7,8192
MM v[80:83],a[176:179],v[44:47]
MM v[84:87],a[164:167],v[40:43]
TR v[58:59],v7,8704
MM v[84:87],a[180:183],v[44:47]
MM v[88:91],a[168:171],v[40:43]
TR v[60:61],v7,12288
MM v[88:91],a[184:187],v[44:47]
buffer_load_dwordx4 a[228:231], v2, s[52:55], s76 offen offset:1024 sc1
MM v[92:95],a[172:175],v[40:43]
TR v[62:63],v7,12800
MM v[92:95],a[188:191],v[44:47]
s_waitcnt lgkmcnt(4)
MM v[96:99],a[160:163],v[48:51]
TR v[32:33],v4,40960
MM v[96:99],a[176:179],v[52:55]
MM v[100:103],a[164:167],v[48:51]
TR v[34:35],v4,41472
MM v[100:103],a[180:183],v[52:55]
MM v[104:107],a[168:171],v[48:51]
TR v[36:37],v4,45056
MM v[104:107],a[184:187],v[52:55]
buffer_load_dwordx4 a[232:235], v2, s[52:55], s76 offen offset:2048 sc1
MM v[108:111],a[172:175],v[48:51]
TR v[38:39],v4,45568
MM v[108:111],a[188:191],v[52:55]
s_waitcnt lgkmcnt(4)
MM v[112:115],a[160:163],v[56:59]
TR v[40:41],v5,40960
MM v[112:115],a[176:179],v[60:63]
MM v[116:119],a[164:167],v[56:59]
TR v[42:43],v5,41472
MM v[116:119],a[180:183],v[60:63]
MM v[120:123],a[168:171],v[56:59]
TR v[44:45],v5,45056
MM v[120:123],a[184:187],v[60:63]
buffer_load_dwordx4 a[236:239], v2, s[52:55], s76 offen offset:3072 sc1
MM v[124:127],a[172:175],v[56:59]
TR v[46:47],v5,45568
MM v[124:127],a[188:191],v[60:63]
s_waitcnt lgkmcnt(4)
MM a[0:3],a[160:163],v[32:35]
TR v[48:49],v6,40960
MM a[0:3],a[176:179],v[36:39]
MM a[4:7],a[164:167],v[32:35]
TR v[50:51],v6,41472
MM a[4:7],a[180:183],v[36:39]
MM a[8:11],a[168:171],v[32:35]
TR v[52:53],v6,45056
MM a[8:11],a[184:187],v[36:39]
buffer_load_dwordx4 a[240:243], v19, s[52:55], s76 offen offset:0 sc1
MM a[12:15],a[172:175],v[32:35]
TR v[54:55],v6,45568
MM a[12:15],a[188:191],v[36:39]
s_waitcnt lgkmcnt(4)
MM a[16:19],a[160:163],v[40:43]
TR v[56:57],v7,40960
MM a[16:19],a[176:179],v[44:47]
MM a[20:23],a[164:167],v[40:43]
TR v[58:59],v7,41472
MM a[20:23],a[180:183],v[44:47]
buffer_load_dwordx4 a[244:247], v19, s[52:55], s76 offen offset:1024 sc1
MM a[24:27],a[168:171],v[40:43]
TR v[60:61],v7,45056
MM a[24:27],a[184:187],v[44:47]
MM a[28:31],a[172:175],v[40:43]
TR v[62:63],v7,45568
MM a[28:31],a[188:191],v[44:47]
s_waitcnt lgkmcnt(4)
MM a[32:35],a[160:163],v[48:51]
TR v[32:33],v8,8192
MM a[32:35],a[176:179],v[52:55]
MM a[36:39],a[164:167],v[48:51]
TR v[34:35],v8,8704
MM a[36:39],a[180:183],v[52:55]
buffer_load_dwordx4 a[248:251], v19, s[52:55], s76 offen offset:2048 sc1
MM a[40:43],a[168:171],v[48:51]
TR v[36:37],v8,12288
MM a[40:43],a[184:187],v[52:55]
MM a[44:47],a[172:175],v[48:51]
TR v[38:39],v8,12800
MM a[44:47],a[188:191],v[52:55]
s_waitcnt lgkmcnt(4)
MM a[48:51],a[160:163],v[56:59]
TR v[40:41],v9,8192
MM a[48:51],a[176:179],v[60:63]
MM a[52:55],a[164:167],v[56:59]
TR v[42:43],v9,8704
MM a[52:55],a[180:183],v[60:63]
buffer_load_dwordx4 a[252:255], v19, s[52:55], s76 offen offset:3072 sc1
MM a[56:59],a[168:171],v[56:59]
TR v[44:45],v9,12288
MM a[56:59],a[184:187],v[60:63]
MM a[60:63],a[172:175],v[56:59]
TR v[46:47],v9,12800
MM a[60:63],a[188:191],v[60:63]
s_waitcnt lgkmcnt(4)
MM v[128:131],v[32:35],a[160:163]
TR v[48:49],v10,8192
MM v[128:131],v[36:39],a[176:179]
MM v[132:135],v[32:35],a[164:167]
TR v[50:51],v10,8704
s_add_u32 m0, s78, 0
MM v[132:135],v[36:39],a[180:183]
buffer_load_dwordx4 v16, s[32:35], s72 offen nt lds
MM v[136:139],v[32:35],a[168:171]
TR v[52:53],v10,12288
MM v[136:139],v[36:39],a[184:187]
MM v[140:143],v[32:35],a[172:175]
TR v[54:55],v10,12800
MM v[140:143],v[36:39],a[188:191]
s_waitcnt lgkmcnt(4)
MM v[144:147],v[40:43],a[160:163]
TR v[56:57],v11,8192
s_add_u32 m0, s78, 4096
MM v[144:147],v[44:47],a[176:179]
buffer_load_dwordx4 v16, s[32:35], s73 offen nt lds
MM v[148:151],v[40:43],a[164:167]
TR v[58:59],v11,8704
MM v[148:151],v[44:47],a[180:183]
MM v[152:155],v[40:43],a[168:171]
TR v[60:61],v11,12288
MM v[152:155],v[44:47],a[184:187]
MM v[156:159],v[40:43],a[172:175]
TR v[62:63],v11,12800
MM v[156:159],v[44:47],a[188:191]
s_waitcnt lgkmcnt(4)
MM v[160:163],v[48:51],a[160:163]
TR v[32:33],v8,40960
s_add_u32 m0, s78, 32768
MM v[160:163],v[52:55],a[176:179]
buffer_load_dwordx4 v16, s[36:39], s72 offen nt lds
MM v[164:167],v[48:51],a[164:167]
TR v[34:35],v8,41472
MM v[164:167],v[52:55],a[180:183]
MM v[168:171],v[48:51],a[168:171]
TR v[36:37],v8,45056
MM v[168:171],v[52:55],a[184:187]
MM v[172:175],v[48:51],a[172:175]
TR v[38:39],v8,45568
MM v[172:175],v[52:55],a[188:191]
s_waitcnt lgkmcnt(4)
MM v[176:179],v[56:59],a[160:163]
TR v[40:41],v9,40960
s_add_u32 m0, s78, 36864
MM v[176:179],v[60:63],a[176:179]
buffer_load_dwordx4 v16, s[36:39], s73 offen nt lds
MM v[180:183],v[56:59],a[164:167]
TR v[42:43],v9,41472
MM v[180:183],v[60:63],a[180:183]
MM v[184:187],v[56:59],a[168:171]
TR v[44:45],v9,45056
MM v[184:187],v[60:63],a[184:187]
MM v[188:191],v[56:59],a[172:175]
TR v[46:47],v9,45568
MM v[188:191],v[60:63],a[188:191]
s_waitcnt lgkmcnt(4)
MM a[64:67],v[32:35],a[160:163]
TR v[48:49],v10,40960
s_add_u32 m0, s78, 65536
MM a[64:67],v[36:39],a[176:179]
buffer_load_dwordx4 v17, s[40:43], s74 offen nt lds
MM a[68:71],v[32:35],a[164:167]
TR v[50:51],v10,41472
MM a[68:71],v[36:39],a[180:183]
MM a[72:75],v[32:35],a[168:171]
TR v[52:53],v10,45056
MM a[72:75],v[36:39],a[184:187]
MM a[76:79],v[32:35],a[172:175]
TR v[54:55],v10,45568
MM a[76:79],v[36:39],a[188:191]
s_waitcnt lgkmcnt(4)
MM a[80:83],v[40:43],a[160:163]
TR v[56:57],v11,40960
s_add_u32 m0, s78, 69632
MM a[80:83],v[44:47],a[176:179]
buffer_load_dwordx4 v17, s[40:43], s75 offen nt lds
MM a[84:87],v[40:43],a[164:167]
TR v[58:59],v11,41472
MM a[84:87],v[44:47],a[180:183]
MM a[88:91],v[40:43],a[168:171]
TR v[60:61],v11,45056
MM a[88:91],v[44:47],a[184:187]
MM a[92:95],v[40:43],a[172:175]
TR v[62:63],v11,45568
MM a[92:95],v[44:47],a[188:191]
s_waitcnt lgkmcnt(4)
MM a[96:99],v[48:51],a[160:163]
TR v[32:33],v12,8192
s_add_u32 m0, s78, 98304
MM a[96:99],v[52:55],a[176:179]
buffer_load_dwordx4 v17, s[44:47], s74 offen nt lds
MM a[100:103],v[48:51],a[164:167]
TR v[34:35],v12,8448
MM a[100:103],v[52:55],a[180:183]
MM a[104:107],v[48:51],a[168:171]
TR v[36:37],v12,10240
MM a[104:107],v[52:55],a[184:187]
MM a[108:111],v[48:51],a[172:175]
TR v[38:39],v12,10496
MM a[108:111],v[52:55],a[188:191]
s_waitcnt lgkmcnt(4)
MM a[112:115],v[56:59],a[160:163]
TR v[40:41],v13,8192
s_add_u32 m0, s78, 102400
MM a[112:115],v[60:63],a[176:179]
buffer_load_dwordx4 v17, s[44:47], s75 offen nt lds
MM a[116:119],v[56:59],a[164:167]
TR v[42:43],v13,8448
MM a[116:119],v[60:63],a[180:183]
MM a[120:123],v[56:59],a[168:171]
TR v[44:45],v13,10240
MM a[120:123],v[60:63],a[184:187]
MM a[124:127],v[56:59],a[172:175]
TR v[46:47],v13,10496
MM a[124:127],v[60:63],a[188:191]
s_waitcnt lgkmcnt(4)
MM v[192:195],v[32:35],a[160:163]
TR v[48:49],v12,12288
s_add_u32 m0, s79, 131072
MM v[192:195],v[36:39],a[176:179]
buffer_load_dwordx4 v18, s[48:51], s74 offen nt lds
MM v[196:199],v[32:35],a[164:167]
TR v[50:51],v12,12544
MM v[196:199],v[36:39],a[180:183]
MM v[200:203],v[32:35],a[168:171]
TR v[52:53],v12,14336
MM v[200:203],v[36:39],a[184:187]
MM v[204:207],v[32:35],a[172:175]
TR v[54:55],v12,14592
MM v[204:207],v[36:39],a[188:191]
s_waitcnt lgkmcnt(4)
MM v[208:211],v[40:43],a[160:163]
TR v[56:57],v13,12288
s_add_u32 m0, s79, 133120
MM v[208:211],v[44:47],a[176:179]
buffer_load_dwordx4 v18, s[48:51], s75 offen nt lds
MM v[212:215],v[40:43],a[164:167]
TR v[58:59],v13,12544
MM v[212:215],v[44:47],a[180:183]
MM v[216:219],v[40:43],a[168:171]
TR v[60:61],v13,14336
MM v[216:219],v[44:47],a[184:187]
MM v[220:223],v[40:43],a[172:175]
TR v[62:63],v13,14592
MM v[220:223],v[44:47],a[188:191]
s_waitcnt lgkmcnt(4)
MM v[224:227],v[48:51],a[160:163]
MM v[224:227],v[52:55],a[176:179]
s_waitcnt vmcnt(20) lgkmcnt(0)
s_barrier
MM v[228:231],v[48:51],a[164:167]
TR v[32:33],v4,16384
MM v[228:231],v[52:55],a[180:183]
TR v[34:35],v4,16896
MM v[232:235],v[48:51],a[168:171]
TR v[36:37],v4,20480
MM v[232:235],v[52:55],a[184:187]
TR v[38:39],v4,20992
MM v[236:239],v[48:51],a[172:175]
MM v[236:239],v[52:55],a[188:191]
MM v[240:243],v[56:59],a[160:163]
TR v[40:41],v5,16384
MM v[240:243],v[60:63],a[176:179]
s_add_u32 s72, s72, 393216
s_add_u32 s73, s73, 393216
MM v[244:247],v[56:59],a[164:167]
TR v[42:43],v5,16896
MM v[244:247],v[60:63],a[180:183]
s_add_u32 s74, s74, 458752
s_add_u32 s75, s75, 458752
MM v[248:251],v[56:59],a[168:171]
TR v[44:45],v5,20480
MM v[248:251],v[60:63],a[184:187]
s_add_u32 s76, s76, 8192
MM v[252:255],v[56:59],a[172:175]
TR v[46:47],v5,20992
MM v[252:255],v[60:63],a[188:191]
s_waitcnt lgkmcnt(4)
MM v[64:67],a[192:195],v[32:35]
TR v[48:49],v6,16384
MM v[64:67],a[208:211],v[36:39]
buffer_load_dwordx4 v[20:23], v2, s[64:67], s81 offen
s_add_u32 s81, s81, 0x100000
MM v[68:71],a[196:199],v[32:35]
TR v[50:51],v6,16896
MM v[68:71],a[212:215],v[36:39]
MM v[72:75],a[200:203],v[32:35]
TR v[52:53],v6,20480
MM v[72:75],a[216:219],v[36:39]
buffer_load_dwordx4 a[128:131], v2, s[52:55], s76 offen offset:0 sc1
MM v[76:79],a[204:207],v[32:35]
TR v[54:55],v6,20992
MM v[76:79],a[220:223],v[36:39]
s_waitcnt lgkmcnt(4)
MM v[80:83],a[192:195],v[40:43]
TR v[56:57],v7,16384
MM v[80:83],a[208:211],v[44:47]
MM v[84:87],a[196:199],v[40:43]
TR v[58:59],v7,16896
MM v[84:87],a[212:215],v[44:47]
buffer_load_dwordx4 a[132:135], v2, s[52:55], s76 offen offset:1024 sc1
MM v[88:91],a[200:203],v[40:43]
TR v[60:61],v7,20480
MM v[88:91],a[216:219],v[44:47]
MM v[92:95],a[204:207],v[40:43]
TR v[62:63],v7,20992
MM v[92:95],a[220:223],v[44:47]
s_waitcnt lgkmcnt(4)
MM v[96:99],a[192:195],v[48:51]
TR v[32:33],v4,49152
MM v[96:99],a[208:211],v[52:55]
MM v[100:103],a[196:199],v[48:51]
TR v[34:35],v4,49664
MM v[100:103],a[212:215],v[52:55]
buffer_load_dwordx4 a[136:139], v2, s[52:55], s76 offen offset:2048 sc1
MM v[104:107],a[200:203],v[48:51]
TR v[36:37],v4,53248
MM v[104:107],a[216:219],v[52:55]
MM v[108:111],a[204:207],v[48:51]
TR v[38:39],v4,53760
MM v[108:111],a[220:223],v[52:55]
s_waitcnt lgkmcnt(4)
MM v[112:115],a[192:195],v[56:59]
TR v[40:41],v5,49152
MM v[112:115],a[208:211],v[60:63]
MM v[116:119],a[196:199],v[56:59]
TR v[42:43],v5,49664
MM v[116:119],a[212:215],v[60:63]
buffer_load_dwordx4 a[140:143], v2, s[52:55], s76 offen offset:3072 sc1
MM v[120:123],a[200:203],v[56:59]
TR v[44:45],v5,53248
MM v[120:123],a[216:219],v[60:63]
MM v[124:127],a[204:207],v[56:59]
TR v[46:47],v5,53760
MM v[124:127],a[220:223],v[60:63]
s_waitcnt lgkmcnt(4)
MM a[0:3],a[192:195],v[32:35]
TR v[48:49],v6,49152
MM a[0:3],a[208:211],v[36:39]
MM a[4:7],a[196:199],v[32:35]
TR v[50:51],v6,49664
MM a[4:7],a[212:215],v[36:39]
buffer_load_dwordx4 a[144:147], v19, s[52:55], s76 offen offset:0 sc1
MM a[8:11],a[200:203],v[32:35]
TR v[52:53],v6,53248
MM a[8:11],a[216:219],v[36:39]
MM a[12:15],a[204:207],v[32:35]
TR v[54:55],v6,53760
MM a[12:15],a[220:223],v[36:39]
s_waitcnt lgkmcnt(4)
MM a[16:19],a[192:195],v[40:43]
TR v[56:57],v7,49152
MM a[16:19],a[208:211],v[44:47]
MM a[20:23],a[196:199],v[40:43]
TR v[58:59],v7,49664
MM a[20:23],a[212:215],v[44:47]
buffer_load_dwordx4 a[148:151], v19, s[52:55], s76 offen offset:1024 sc1
MM a[24:27],a[200:203],v[40:43]
TR v[60:61],v7,53248
MM a[24:27],a[216:219],v[44:47]
MM a[28:31],a[204:207],v[40:43]
TR v[62:63],v7,53760
MM a[28:31],a[220:223],v[44:47]
s_waitcnt lgkmcnt(4)
MM a[32:35],a[192:195],v[48:51]
TR v[32:33],v8,16384
MM a[32:35],a[208:211],v[52:55]
MM a[36:39],a[196:199],v[48:51]
TR v[34:35],v8,16896
MM a[36:39],a[212:215],v[52:55]
buffer_load_dwordx4 a[152:155], v19, s[52:55], s76 offen offset:2048 sc1
MM a[40:43],a[200:203],v[48:51]
TR v[36:37],v8,20480
MM a[40:43],a[216:219],v[52:55]
MM a[44:47],a[204:207],v[48:51]
TR v[38:39],v8,20992
MM a[44:47],a[220:223],v[52:55]
s_waitcnt lgkmcnt(4)
MM a[48:51],a[192:195],v[56:59]
TR v[40:41],v9,16384
MM a[48:51],a[208:211],v[60:63]
MM a[52:55],a[196:199],v[56:59]
TR v[42:43],v9,16896
MM a[52:55],a[212:215],v[60:63]
buffer_load_dwordx4 a[156:159], v19, s[52:55], s76 offen offset:3072 sc1
MM a[56:59],a[200:203],v[56:59]
TR v[44:45],v9,20480
MM a[56:59],a[216:219],v[60:63]
MM a[60:63],a[204:207],v[56:59]
TR v[46:47],v9,20992
MM a[60:63],a[220:223],v[60:63]
s_waitcnt lgkmcnt(4)
MM v[128:131],v[32:35],a[192:195]
TR v[48:49],v10,16384
MM v[128:131],v[36:39],a[208:211]
MM v[132:135],v[32:35],a[196:199]
TR v[50:51],v10,16896
s_add_u32 m0, s78, 8192
MM v[132:135],v[36:39],a[212:215]
buffer_load_dwordx4 v16, s[32:35], s72 offen nt lds
MM v[136:139],v[32:35],a[200:203]
TR v[52:53],v10,20480
MM v[136:139],v[36:39],a[216:219]
MM v[140:143],v[32:35],a[204:207]
TR v[54:55],v10,20992
MM v[140:143],v[36:39],a[220:223]
s_waitcnt lgkmcnt(4)
MM v[144:147],v[40:43],a[192:195]
TR v[56:57],v11,16384
s_add_u32 m0, s78, 12288
MM v[144:147],v[44:47],a[208:211]
buffer_load_dwordx4 v16, s[32:35], s73 offen nt lds
MM v[148:151],v[40:43],a[196:199]
TR v[58:59],v11,16896
MM v[148:151],v[44:47],a[212:215]
MM v[152:155],v[40:43],a[200:203]
TR v[60:61],v11,20480
MM v[152:155],v[44:47],a[216:219]
MM v[156:159],v[40:43],a[204:207]
TR v[62:63],v11,20992
MM v[156:159],v[44:47],a[220:223]
s_waitcnt lgkmcnt(4)
MM v[160:163],v[48:51],a[192:195]
TR v[32:33],v8,49152
s_add_u32 m0, s78, 40960
MM v[160:163],v[52:55],a[208:211]
buffer_load_dwordx4 v16, s[36:39], s72 offen nt lds
MM v[164:167],v[48:51],a[196:199]
TR v[34:35],v8,49664
MM v[164:167],v[52:55],a[212:215]
MM v[168:171],v[48:51],a[200:203]
TR v[36:37],v8,53248
MM v[168:171],v[52:55],a[216:219]
MM v[172:175],v[48:51],a[204:207]
TR v[38:39],v8,53760
MM v[172:175],v[52:55],a[220:223]
s_waitcnt lgkmcnt(4)
MM v[176:179],v[56:59],a[192:195]
TR v[40:41],v9,49152
s_add_u32 m0, s78, 45056
MM v[176:179],v[60:63],a[208:211]
buffer_load_dwordx4 v16, s[36:39], s73 offen nt lds
MM v[180:183],v[56:59],a[196:199]
TR v[42:43],v9,49664
MM v[180:183],v[60:63],a[212:215]
MM v[184:187],v[56:59],a[200:203]
TR v[44:45],v9,53248
MM v[184:187],v[60:63],a[216:219]
MM v[188:191],v[56:59],a[204:207]
TR v[46:47],v9,53760
MM v[188:191],v[60:63],a[220:223]
s_waitcnt lgkmcnt(4)
MM a[64:67],v[32:35],a[192:195]
TR v[48:49],v10,49152
s_add_u32 m0, s78, 73728
MM a[64:67],v[36:39],a[208:211]
buffer_load_dwordx4 v17, s[40:43], s74 offen nt lds
MM a[68:71],v[32:35],a[196:199]
TR v[50:51],v10,49664
MM a[68:71],v[36:39],a[212:215]
MM a[72:75],v[32:35],a[200:203]
TR v[52:53],v10,53248
MM a[72:75],v[36:39],a[216:219]
MM a[76:79],v[32:35],a[204:207]
TR v[54:55],v10,53760
MM a[76:79],v[36:39],a[220:223]
s_waitcnt lgkmcnt(4)
MM a[80:83],v[40:43],a[192:195]
TR v[56:57],v11,49152
s_add_u32 m0, s78, 77824
MM a[80:83],v[44:47],a[208:211]
buffer_load_dwordx4 v17, s[40:43], s75 offen nt lds
MM a[84:87],v[40:43],a[196:199]
TR v[58:59],v11,49664
MM a[84:87],v[44:47],a[212:215]
MM a[88:91],v[40:43],a[200:203]
TR v[60:61],v11,53248
MM a[88:91],v[44:47],a[216:219]
MM a[92:95],v[40:43],a[204:207]
TR v[62:63],v11,53760
MM a[92:95],v[44:47],a[220:223]
s_waitcnt lgkmcnt(4)
MM a[96:99],v[48:51],a[192:195]
TR v[32:33],v12,16384
s_add_u32 m0, s78, 106496
MM a[96:99],v[52:55],a[208:211]
buffer_load_dwordx4 v17, s[44:47], s74 offen nt lds
MM a[100:103],v[48:51],a[196:199]
TR v[34:35],v12,16640
MM a[100:103],v[52:55],a[212:215]
MM a[104:107],v[48:51],a[200:203]
TR v[36:37],v12,18432
MM a[104:107],v[52:55],a[216:219]
MM a[108:111],v[48:51],a[204:207]
TR v[38:39],v12,18688
MM a[108:111],v[52:55],a[220:223]
s_waitcnt lgkmcnt(4)
MM a[112:115],v[56:59],a[192:195]
TR v[40:41],v13,16384
s_add_u32 m0, s78, 110592
MM a[112:115],v[60:63],a[208:211]
buffer_load_dwordx4 v17, s[44:47], s75 offen nt lds
MM a[116:119],v[56:59],a[196:199]
TR v[42:43],v13,16640
MM a[116:119],v[60:63],a[212:215]
MM a[120:123],v[56:59],a[200:203]
TR v[44:45],v13,18432
MM a[120:123],v[60:63],a[216:219]
MM a[124:127],v[56:59],a[204:207]
TR v[46:47],v13,18688
MM a[124:127],v[60:63],a[220:223]
s_waitcnt lgkmcnt(4)
MM v[192:195],v[32:35],a[192:195]
TR v[48:49],v12,20480
s_add_u32 m0, s79, 139264
MM v[192:195],v[36:39],a[208:211]
buffer_load_dwordx4 v18, s[48:51], s74 offen nt lds
MM v[196:199],v[32:35],a[196:199]
TR v[50:51],v12,20736
MM v[196:199],v[36:39],a[212:215]
MM v[200:203],v[32:35],a[200:203]
TR v[52:53],v12,22528
MM v[200:203],v[36:39],a[216:219]
MM v[204:207],v[32:35],a[204:207]
TR v[54:55],v12,22784
MM v[204:207],v[36:39],a[220:223]
s_waitcnt lgkmcnt(4)
MM v[208:211],v[40:43],a[192:195]
TR v[56:57],v13,20480
s_add_u32 m0, s79, 141312
MM v[208:211],v[44:47],a[208:211]
buffer_load_dwordx4 v18, s[48:51], s75 offen nt lds
MM v[212:215],v[40:43],a[196:199]
TR v[58:59],v13,20736
MM v[212:215],v[44:47],a[212:215]
MM v[216:219],v[40:43],a[200:203]
TR v[60:61],v13,22528
MM v[216:219],v[44:47],a[216:219]
MM v[220:223],v[40:43],a[204:207]
TR v[62:63],v13,22784
MM v[220:223],v[44:47],a[220:223]
s_waitcnt lgkmcnt(4)
MM v[224:227],v[48:51],a[192:195]
MM v[224:227],v[52:55],a[208:211]
s_waitcnt vmcnt(19) lgkmcnt(0)
s_barrier
MM v[228:231],v[48:51],a[196:199]
TR v[32:33],v4,24576
MM v[228:231],v[52:55],a[212:215]
TR v[34:35],v4,25088
MM v[232:235],v[48:51],a[200:203]
TR v[36:37],v4,28672
MM v[232:235],v[52:55],a[216:219]
TR v[38:39],v4,29184
MM v[236:239],v[48:51],a[204:207]
MM v[236:239],v[52:55],a[220:223]
MM v[240:243],v[56:59],a[192:195]
TR v[40:41],v5,24576
MM v[240:243],v[60:63],a[208:211]
s_add_u32 s72, s72, 393216
s_add_u32 s73, s73, 393216
MM v[244:247],v[56:59],a[196:199]
TR v[42:43],v5,25088
MM v[244:247],v[60:63],a[212:215]
s_add_u32 s74, s74, 458752
s_add_u32 s75, s75, 458752
MM v[248:251],v[56:59],a[200:203]
TR v[44:45],v5,28672
MM v[248:251],v[60:63],a[216:219]
s_add_u32 s76, s76, 8192
MM v[252:255],v[56:59],a[204:207]
TR v[46:47],v5,29184
MM v[252:255],v[60:63],a[220:223]
s_waitcnt lgkmcnt(4)
MM v[64:67],a[224:227],v[32:35]
TR v[48:49],v6,24576
MM v[64:67],a[240:243],v[36:39]
buffer_load_dwordx4 v[20:23], v2, s[68:71], s82 offen
s_add_u32 s82, s82, 0x100000
MM v[68:71],a[228:231],v[32:35]
TR v[50:51],v6,25088
MM v[68:71],a[244:247],v[36:39]
MM v[72:75],a[232:235],v[32:35]
TR v[52:53],v6,28672
MM v[72:75],a[248:251],v[36:39]
buffer_load_dwordx4 a[160:163], v2, s[52:55], s76 offen offset:0 sc1
MM v[76:79],a[236:239],v[32:35]
TR v[54:55],v6,29184
MM v[76:79],a[252:255],v[36:39]
s_waitcnt lgkmcnt(4)
MM v[80:83],a[224:227],v[40:43]
TR v[56:57],v7,24576
MM v[80:83],a[240:243],v[44:47]
MM v[84:87],a[228:231],v[40:43]
TR v[58:59],v7,25088
MM v[84:87],a[244:247],v[44:47]
buffer_load_dwordx4 a[164:167], v2, s[52:55], s76 offen offset:1024 sc1
MM v[88:91],a[232:235],v[40:43]
TR v[60:61],v7,28672
MM v[88:91],a[248:251],v[44:47]
MM v[92:95],a[236:239],v[40:43]
TR v[62:63],v7,29184
MM v[92:95],a[252:255],v[44:47]
s_waitcnt lgkmcnt(4)
MM v[96:99],a[224:227],v[48:51]
TR v[32:33],v4,57344
MM v[96:99],a[240:243],v[52:55]
MM v[100:103],a[228:231],v[48:51]
TR v[34:35],v4,57856
MM v[100:103],a[244:247],v[52:55]
buffer_load_dwordx4 a[168:171], v2, s[52:55], s76 offen offset:2048 sc1
MM v[104:107],a[232:235],v[48:51]
TR v[36:37],v4,61440
MM v[104:107],a[248:251],v[52:55]
MM v[108:111],a[236:239],v[48:51]
TR v[38:39],v4,61952
MM v[108:111],a[252:255],v[52:55]
s_waitcnt lgkmcnt(4)
MM v[112:115],a[224:227],v[56:59]
TR v[40:41],v5,57344
MM v[112:115],a[240:243],v[60:63]
MM v[116:119],a[228:231],v[56:59]
TR v[42:43],v5,57856
MM v[116:119],a[244:247],v[60:63]
buffer_load_dwordx4 a[172:175], v2, s[52:55], s76 offen offset:3072 sc1
MM v[120:123],a[232:235],v[56:59]
TR v[44:45],v5,61440
MM v[120:123],a[248:251],v[60:63]
MM v[124:127],a[236:239],v[56:59]
TR v[46:47],v5,61952
MM v[124:127],a[252:255],v[60:63]
s_waitcnt lgkmcnt(4)
MM a[0:3],a[224:227],v[32:35]
TR v[48:49],v6,57344
MM a[0:3],a[240:243],v[36:39]
MM a[4:7],a[228:231],v[32:35]
TR v[50:51],v6,57856
MM a[4:7],a[244:247],v[36:39]
buffer_load_dwordx4 a[176:179], v19, s[52:55], s76 offen offset:0 sc1
MM a[8:11],a[232:235],v[32:35]
TR v[52:53],v6,61440
MM a[8:11],a[248:251],v[36:39]
MM a[12:15],a[236:239],v[32:35]
TR v[54:55],v6,61952
MM a[12:15],a[252:255],v[36:39]
s_waitcnt lgkmcnt(4)
MM a[16:19],a[224:227],v[40:43]
TR v[56:57],v7,57344
MM a[16:19],a[240:243],v[44:47]
MM a[20:23],a[228:231],v[40:43]
TR v[58:59],v7,57856
MM a[20:23],a[244:247],v[44:47]
buffer_load_dwordx4 a[180:183], v19, s[52:55], s76 offen offset:1024 sc1
MM a[24:27],a[232:235],v[40:43]
TR v[60:61],v7,61440
MM a[24:27],a[248:251],v[44:47]
MM a[28:31],a[236:239],v[40:43]
TR v[62:63],v7,61952
MM a[28:31],a[252:255],v[44:47]
s_waitcnt lgkmcnt(4)
MM a[32:35],a[224:227],v[48:51]
TR v[32:33],v8,24576
MM a[32:35],a[240:243],v[52:55]
MM a[36:39],a[228:231],v[48:51]
TR v[34:35],v8,25088
MM a[36:39],a[244:247],v[52:55]
buffer_load_dwordx4 a[184:187], v19, s[52:55], s76 offen offset:2048 sc1
MM a[40:43],a[232:235],v[48:51]
TR v[36:37],v8,28672
MM a[40:43],a[248:251],v[52:55]
MM a[44:47],a[236:239],v[48:51]
TR v[38:39],v8,29184
MM a[44:47],a[252:255],v[52:55]
s_waitcnt lgkmcnt(4)
MM a[48:51],a[224:227],v[56:59]
TR v[40:41],v9,24576
MM a[48:51],a[240:243],v[60:63]
MM a[52:55],a[228:231],v[56:59]
TR v[42:43],v9,25088
MM a[52:55],a[244:247],v[60:63]
buffer_load_dwordx4 a[188:191], v19, s[52:55], s76 offen offset:3072 sc1
MM a[56:59],a[232:235],v[56:59]
TR v[44:45],v9,28672
MM a[56:59],a[248:251],v[60:63]
MM a[60:63],a[236:239],v[56:59]
TR v[46:47],v9,29184
MM a[60:63],a[252:255],v[60:63]
s_waitcnt lgkmcnt(4)
MM v[128:131],v[32:35],a[224:227]
TR v[48:49],v10,24576
MM v[128:131],v[36:39],a[240:243]
MM v[132:135],v[32:35],a[228:231]
TR v[50:51],v10,25088
s_add_u32 m0, s78, 16384
MM v[132:135],v[36:39],a[244:247]
buffer_load_dwordx4 v16, s[32:35], s72 offen nt lds
MM v[136:139],v[32:35],a[232:235]
TR v[52:53],v10,28672
MM v[136:139],v[36:39],a[248:251]
MM v[140:143],v[32:35],a[236:239]
TR v[54:55],v10,29184
MM v[140:143],v[36:39],a[252:255]
s_waitcnt lgkmcnt(4)
MM v[144:147],v[40:43],a[224:227]
TR v[56:57],v11,24576
s_add_u32 m0, s78, 20480
MM v[144:147],v[44:47],a[240:243]
buffer_load_dwordx4 v16, s[32:35], s73 offen nt lds
MM v[148:151],v[40:43],a[228:231]
TR v[58:59],v11,25088
MM v[148:151],v[44:47],a[244:247]
MM v[152:155],v[40:43],a[232:235]
TR v[60:61],v11,28672
MM v[152:155],v[44:47],a[248:251]
MM v[156:159],v[40:43],a[236:239]
TR v[62:63],v11,29184
MM v[156:159],v[44:47],a[252:255]
s_waitcnt lgkmcnt(4)
MM v[160:163],v[48:51],a[224:227]
TR v[32:33],v8,57344
s_add_u32 m0, s78, 49152
MM v[160:163],v[52:55],a[240:243]
buffer_load_dwordx4 v16, s[36:39], s72 offen nt lds
MM v[164:167],v[48:51],a[228:231]
TR v[34:35],v8,57856
MM v[164:167],v[52:55],a[244:247]
MM v[168:171],v[48:51],a[232:235]
TR v[36:37],v8,61440
MM v[168:171],v[52:55],a[248:251]
MM v[172:175],v[48:51],a[236:239]
TR v[38:39],v8,61952
MM v[172:175],v[52:55],a[252:255]
s_waitcnt lgkmcnt(4)
MM v[176:179],v[56:59],a[224:227]
TR v[40:41],v9,57344
s_add_u32 m0, s78, 53248
MM v[176:179],v[60:63],a[240:243]
buffer_load_dwordx4 v16, s[36:39], s73 offen nt lds
MM v[180:183],v[56:59],a[228:231]
TR v[42:43],v9,57856
MM v[180:183],v[60:63],a[244:247]
MM v[184:187],v[56:59],a[232:235]
TR v[44:45],v9,61440
MM v[184:187],v[60:63],a[248:251]
MM v[188:191],v[56:59],a[236:239]
TR v[46:47],v9,61952
MM v[188:191],v[60:63],a[252:255]
s_waitcnt lgkmcnt(4)
MM a[64:67],v[32:35],a[224:227]
TR v[48:49],v10,57344
s_add_u32 m0, s78, 81920
MM a[64:67],v[36:39],a[240:243]
buffer_load_dwordx4 v17, s[40:43], s74 offen nt lds
MM a[68:71],v[32:35],a[228:231]
TR v[50:51],v10,57856
MM a[68:71],v[36:39],a[244:247]
MM a[72:75],v[32:35],a[232:235]
TR v[52:53],v10,61440
MM a[72:75],v[36:39],a[248:251]
MM a[76:79],v[32:35],a[236:239]
TR v[54:55],v10,61952
MM a[76:79],v[36:39],a[252:255]
s_waitcnt lgkmcnt(4)
MM a[80:83],v[40:43],a[224:227]
TR v[56:57],v11,57344
s_add_u32 m0, s78, 86016
MM a[80:83],v[44:47],a[240:243]
buffer_load_dwordx4 v17, s[40:43], s75 offen nt lds
MM a[84:87],v[40:43],a[228:231]
TR v[58:59],v11,57856
MM a[84:87],v[44:47],a[244:247]
MM a[88:91],v[40:43],a[232:235]
TR v[60:61],v11,61440
MM a[88:91],v[44:47],a[248:251]
MM a[92:95],v[40:43],a[236:239]
TR v[62:63],v11,61952
MM a[92:95],v[44:47],a[252:255]
s_waitcnt lgkmcnt(4)
MM a[96:99],v[48:51],a[224:227]
TR v[32:33],v12,24576
s_add_u32 m0, s78, 114688
MM a[96:99],v[52:55],a[240:243]
buffer_load_dwordx4 v17, s[44:47], s74 offen nt lds
MM a[100:103],v[48:51],a[228:231]
TR v[34:35],v12,24832
MM a[100:103],v[52:55],a[244:247]
MM a[104:107],v[48:51],a[232:235]
TR v[36:37],v12,26624
MM a[104:107],v[52:55],a[248:251]
MM a[108:111],v[48:51],a[236:239]
TR v[38:39],v12,26880
MM a[108:111],v[52:55],a[252:255]
s_waitcnt lgkmcnt(4)
MM a[112:115],v[56:59],a[224:227]
TR v[40:41],v13,24576
s_add_u32 m0, s78, 118784
MM a[112:115],v[60:63],a[240:243]
buffer_load_dwordx4 v17, s[44:47], s75 offen nt lds
MM a[116:119],v[56:59],a[228:231]
TR v[42:43],v13,24832
MM a[116:119],v[60:63],a[244:247]
MM a[120:123],v[56:59],a[232:235]
TR v[44:45],v13,26624
MM a[120:123],v[60:63],a[248:251]
MM a[124:127],v[56:59],a[236:239]
TR v[46:47],v13,26880
MM a[124:127],v[60:63],a[252:255]
s_waitcnt lgkmcnt(4)
MM v[192:195],v[32:35],a[224:227]
TR v[48:49],v12,28672
s_add_u32 m0, s79, 147456
MM v[192:195],v[36:39],a[240:243]
buffer_load_dwordx4 v18, s[48:51], s74 offen nt lds
MM v[196:199],v[32:35],a[228:231]
TR v[50:51],v12,28928
MM v[196:199],v[36:39],a[244:247]
MM v[200:203],v[32:35],a[232:235]
TR v[52:53],v12,30720
MM v[200:203],v[36:39],a[248:251]
MM v[204:207],v[32:35],a[236:239]
TR v[54:55],v12,30976
MM v[204:207],v[36:39],a[252:255]
s_waitcnt lgkmcnt(4)
MM v[208:211],v[40:43],a[224:227]
TR v[56:57],v13,28672
s_add_u32 m0, s79, 149504
MM v[208:211],v[44:47],a[240:243]
buffer_load_dwordx4 v18, s[48:51], s75 offen nt lds
MM v[212:215],v[40:43],a[228:231]
TR v[58:59],v13,28928
MM v[212:215],v[44:47],a[244:247]
MM v[216:219],v[40:43],a[232:235]
TR v[60:61],v13,30720
MM v[216:219],v[44:47],a[248:251]
MM v[220:223],v[40:43],a[236:239]
TR v[62:63],v13,30976
MM v[220:223],v[44:47],a[252:255]
s_waitcnt lgkmcnt(4)
MM v[224:227],v[48:51],a[224:227]
MM v[224:227],v[52:55],a[240:243]
s_waitcnt vmcnt(19) lgkmcnt(0)
s_barrier
MM v[228:231],v[48:51],a[228:231]
TR v[32:33],v4,0
MM v[228:231],v[52:55],a[244:247]
TR v[34:35],v4,512
MM v[232:235],v[48:51],a[232:235]
TR v[36:37],v4,4096
MM v[232:235],v[52:55],a[248:251]
TR v[38:39],v4,4608
MM v[236:239],v[48:51],a[236:239]
MM v[236:239],v[52:55],a[252:255]
MM v[240:243],v[56:59],a[224:227]
TR v[40:41],v5,0
MM v[240:243],v[60:63],a[240:243]
s_add_u32 s72, s72, 393216
s_add_u32 s73, s73, 393216
MM v[244:247],v[56:59],a[228:231]
TR v[42:43],v5,512
MM v[244:247],v[60:63],a[244:247]
s_add_u32 s74, s74, 458752
s_add_u32 s75, s75, 458752
MM v[248:251],v[56:59],a[232:235]
TR v[44:45],v5,4096
MM v[248:251],v[60:63],a[248:251]
s_add_u32 s76, s76, 8192
MM v[252:255],v[56:59],a[236:239]
TR v[46:47],v5,4608
MM v[252:255],v[60:63],a[252:255]
s_waitcnt lgkmcnt(4)
s_sub_u32 s80, s80, 1
s_cmp_lg_u32 s80, 0
s_cbranch_scc1 L1KV_loop
MM v[64:67],a[128:131],v[32:35]
TR v[48:49],v6,0
MM v[64:67],a[144:147],v[36:39]
MM v[68:71],a[132:135],v[32:35]
TR v[50:51],v6,512
MM v[68:71],a[148:151],v[36:39]
buffer_load_dwordx4 a[192:195], v2, s[52:55], s76 offen offset:0 sc1
MM v[72:75],a[136:139],v[32:35]
TR v[52:53],v6,4096
MM v[72:75],a[152:155],v[36:39]
MM v[76:79],a[140:143],v[32:35]
TR v[54:55],v6,4608
MM v[76:79],a[156:159],v[36:39]
s_waitcnt lgkmcnt(4)
buffer_load_dwordx4 a[196:199], v2, s[52:55], s76 offen offset:1024 sc1
MM v[80:83],a[128:131],v[40:43]
TR v[56:57],v7,0
MM v[80:83],a[144:147],v[44:47]
MM v[84:87],a[132:135],v[40:43]
TR v[58:59],v7,512
MM v[84:87],a[148:151],v[44:47]
buffer_load_dwordx4 a[200:203], v2, s[52:55], s76 offen offset:2048 sc1
MM v[88:91],a[136:139],v[40:43]
TR v[60:61],v7,4096
MM v[88:91],a[152:155],v[44:47]
MM v[92:95],a[140:143],v[40:43]
TR v[62:63],v7,4608
MM v[92:95],a[156:159],v[44:47]
s_waitcnt lgkmcnt(4)
buffer_load_dwordx4 a[204:207], v2, s[52:55], s76 offen offset:3072 sc1
MM v[96:99],a[128:131],v[48:51]
TR v[32:33],v4,32768
MM v[96:99],a[144:147],v[52:55]
MM v[100:103],a[132:135],v[48:51]
TR v[34:35],v4,33280
MM v[100:103],a[148:151],v[52:55]
buffer_load_dwordx4 a[208:211], v19, s[52:55], s76 offen offset:0 sc1
MM v[104:107],a[136:139],v[48:51]
TR v[36:37],v4,36864
MM v[104:107],a[152:155],v[52:55]
MM v[108:111],a[140:143],v[48:51]
TR v[38:39],v4,37376
MM v[108:111],a[156:159],v[52:55]
s_waitcnt lgkmcnt(4)
buffer_load_dwordx4 a[212:215], v19, s[52:55], s76 offen offset:1024 sc1
MM v[112:115],a[128:131],v[56:59]
TR v[40:41],v5,32768
MM v[112:115],a[144:147],v[60:63]
MM v[116:119],a[132:135],v[56:59]
TR v[42:43],v5,33280
MM v[116:119],a[148:151],v[60:63]
buffer_load_dwordx4 a[216:219], v19, s[52:55], s76 offen offset:2048 sc1
MM v[120:123],a[136:139],v[56:59]
TR v[44:45],v5,36864
MM v[120:123],a[152:155],v[60:63]
MM v[124:127],a[140:143],v[56:59]
TR v[46:47],v5,37376
MM v[124:127],a[156:159],v[60:63]
s_waitcnt lgkmcnt(4)
buffer_load_dwordx4 a[220:223], v19, s[52:55], s76 offen offset:3072 sc1
MM a[0:3],a[128:131],v[32:35]
TR v[48:49],v6,32768
MM a[0:3],a[144:147],v[36:39]
MM a[4:7],a[132:135],v[32:35]
TR v[50:51],v6,33280
s_add_u32 s76, s76, 8192
MM a[4:7],a[148:151],v[36:39]
buffer_load_dwordx4 a[224:227], v2, s[52:55], s76 offen offset:0 sc1
MM a[8:11],a[136:139],v[32:35]
TR v[52:53],v6,36864
MM a[8:11],a[152:155],v[36:39]
MM a[12:15],a[140:143],v[32:35]
TR v[54:55],v6,37376
MM a[12:15],a[156:159],v[36:39]
s_waitcnt lgkmcnt(4)
buffer_load_dwordx4 a[228:231], v2, s[52:55], s76 offen offset:1024 sc1
MM a[16:19],a[128:131],v[40:43]
TR v[56:57],v7,32768
MM a[16:19],a[144:147],v[44:47]
MM a[20:23],a[132:135],v[40:43]
TR v[58:59],v7,33280
MM a[20:23],a[148:151],v[44:47]
buffer_load_dwordx4 a[232:235], v2, s[52:55], s76 offen offset:2048 sc1
MM a[24:27],a[136:139],v[40:43]
TR v[60:61],v7,36864
MM a[24:27],a[152:155],v[44:47]
MM a[28:31],a[140:143],v[40:43]
TR v[62:63],v7,37376
MM a[28:31],a[156:159],v[44:47]
s_waitcnt lgkmcnt(4)
buffer_load_dwordx4 a[236:239], v2, s[52:55], s76 offen offset:3072 sc1
MM a[32:35],a[128:131],v[48:51]
TR v[32:33],v8,0
MM a[32:35],a[144:147],v[52:55]
MM a[36:39],a[132:135],v[48:51]
TR v[34:35],v8,512
MM a[36:39],a[148:151],v[52:55]
buffer_load_dwordx4 a[240:243], v19, s[52:55], s76 offen offset:0 sc1
MM a[40:43],a[136:139],v[48:51]
TR v[36:37],v8,4096
MM a[40:43],a[152:155],v[52:55]
MM a[44:47],a[140:143],v[48:51]
TR v[38:39],v8,4608
MM a[44:47],a[156:159],v[52:55]
s_waitcnt lgkmcnt(4)
buffer_load_dwordx4 a[244:247], v19, s[52:55], s76 offen offset:1024 sc1
MM a[48:51],a[128:131],v[56:59]
TR v[40:41],v9,0
MM a[48:51],a[144:147],v[60:63]
MM a[52:55],a[132:135],v[56:59]
TR v[42:43],v9,512
MM a[52:55],a[148:151],v[60:63]
buffer_load_dwordx4 a[248:251], v19, s[52:55], s76 offen offset:2048 sc1
MM a[56:59],a[136:139],v[56:59]
TR v[44:45],v9,4096
MM a[56:59],a[152:155],v[60:63]
MM a[60:63],a[140:143],v[56:59]
TR v[46:47],v9,4608
MM a[60:63],a[156:159],v[60:63]
s_waitcnt lgkmcnt(4)
buffer_load_dwordx4 a[252:255], v19, s[52:55], s76 offen offset:3072 sc1
MM v[128:131],v[32:35],a[128:131]
TR v[48:49],v10,0
MM v[128:131],v[36:39],a[144:147]
MM v[132:135],v[32:35],a[132:135]
TR v[50:51],v10,512
s_add_u32 m0, s78, 24576
MM v[132:135],v[36:39],a[148:151]
buffer_load_dwordx4 v16, s[32:35], s72 offen nt lds
MM v[136:139],v[32:35],a[136:139]
TR v[52:53],v10,4096
MM v[136:139],v[36:39],a[152:155]
MM v[140:143],v[32:35],a[140:143]
TR v[54:55],v10,4608
MM v[140:143],v[36:39],a[156:159]
s_waitcnt lgkmcnt(4)
MM v[144:147],v[40:43],a[128:131]
TR v[56:57],v11,0
s_add_u32 m0, s78, 28672
MM v[144:147],v[44:47],a[144:147]
buffer_load_dwordx4 v16, s[32:35], s73 offen nt lds
MM v[148:151],v[40:43],a[132:135]
TR v[58:59],v11,512
MM v[148:151],v[44:47],a[148:151]
MM v[152:155],v[40:43],a[136:139]
TR v[60:61],v11,4096
MM v[152:155],v[44:47],a[152:155]
MM v[156:159],v[40:43],a[140:143]
TR v[62:63],v11,4608
MM v[156:159],v[44:47],a[156:159]
s_waitcnt lgkmcnt(4)
MM v[160:163],v[48:51],a[128:131]
TR v[32:33],v8,32768
s_add_u32 m0, s78, 57344
MM v[160:163],v[52:55],a[144:147]
buffer_load_dwordx4 v16, s[36:39], s72 offen nt lds
MM v[164:167],v[48:51],a[132:135]
TR v[34:35],v8,33280
MM v[164:167],v[52:55],a[148:151]
MM v[168:171],v[48:51],a[136:139]
TR v[36:37],v8,36864
MM v[168:171],v[52:55],a[152:155]
MM v[172:175],v[48:51],a[140:143]
TR v[38:39],v8,37376
MM v[172:175],v[52:55],a[156:159]
s_waitcnt lgkmcnt(4)
MM v[176:179],v[56:59],a[128:131]
TR v[40:41],v9,32768
s_add_u32 m0, s78, 61440
MM v[176:179],v[60:63],a[144:147]
buffer_load_dwordx4 v16, s[36:39], s73 offen nt lds
MM v[180:183],v[56:59],a[132:135]
TR v[42:43],v9,33280
MM v[180:183],v[60:63],a[148:151]
MM v[184:187],v[56:59],a[136:139]
TR v[44:45],v9,36864
MM v[184:187],v[60:63],a[152:155]
MM v[188:191],v[56:59],a[140:143]
TR v[46:47],v9,37376
MM v[188:191],v[60:63],a[156:159]
s_waitcnt lgkmcnt(4)
MM a[64:67],v[32:35],a[128:131]
TR v[48:49],v10,32768
s_add_u32 m0, s78, 90112
MM a[64:67],v[36:39],a[144:147]
buffer_load_dwordx4 v17, s[40:43], s74 offen nt lds
MM a[68:71],v[32:35],a[132:135]
TR v[50:51],v10,33280
MM a[68:71],v[36:39],a[148:151]
MM a[72:75],v[32:35],a[136:139]
TR v[52:53],v10,36864
MM a[72:75],v[36:39],a[152:155]
MM a[76:79],v[32:35],a[140:143]
TR v[54:55],v10,37376
MM a[76:79],v[36:39],a[156:159]
s_waitcnt lgkmcnt(4)
MM a[80:83],v[40:43],a[128:131]
TR v[56:57],v11,32768
s_add_u32 m0, s78, 94208
MM a[80:83],v[44:47],a[144:147]
buffer_load_dwordx4 v17, s[40:43], s75 offen nt lds
MM a[84:87],v[40:43],a[132:135]
TR v[58:59],v11,33280
MM a[84:87],v[44:47],a[148:151]
MM a[88:91],v[40:43],a[136:139]
TR v[60:61],v11,36864
MM a[88:91],v[44:47],a[152:155]
MM a[92:95],v[40:43],a[140:143]
TR v[62:63],v11,37376
MM a[92:95],v[44:47],a[156:159]
s_waitcnt lgkmcnt(4)
MM a[96:99],v[48:51],a[128:131]
TR v[32:33],v12,0
s_add_u32 m0, s78, 122880
MM a[96:99],v[52:55],a[144:147]
buffer_load_dwordx4 v17, s[44:47], s74 offen nt lds
MM a[100:103],v[48:51],a[132:135]
TR v[34:35],v12,256
MM a[100:103],v[52:55],a[148:151]
MM a[104:107],v[48:51],a[136:139]
TR v[36:37],v12,2048
MM a[104:107],v[52:55],a[152:155]
MM a[108:111],v[48:51],a[140:143]
TR v[38:39],v12,2304
MM a[108:111],v[52:55],a[156:159]
s_waitcnt lgkmcnt(4)
MM a[112:115],v[56:59],a[128:131]
TR v[40:41],v13,0
s_add_u32 m0, s78, 126976
MM a[112:115],v[60:63],a[144:147]
buffer_load_dwordx4 v17, s[44:47], s75 offen nt lds
MM a[116:119],v[56:59],a[132:135]
TR v[42:43],v13,256
MM a[116:119],v[60:63],a[148:151]
MM a[120:123],v[56:59],a[136:139]
TR v[44:45],v13,2048
MM a[120:123],v[60:63],a[152:155]
MM a[124:127],v[56:59],a[140:143]
TR v[46:47],v13,2304
MM a[124:127],v[60:63],a[156:159]
s_waitcnt lgkmcnt(4)
MM v[192:195],v[32:35],a[128:131]
TR v[48:49],v12,4096
s_add_u32 m0, s79, 155648
MM v[192:195],v[36:39],a[144:147]
buffer_load_dwordx4 v18, s[48:51], s74 offen nt lds
MM v[196:199],v[32:35],a[132:135]
TR v[50:51],v12,4352
MM v[196:199],v[36:39],a[148:151]
MM v[200:203],v[32:35],a[136:139]
TR v[52:53],v12,6144
MM v[200:203],v[36:39],a[152:155]
MM v[204:207],v[32:35],a[140:143]
TR v[54:55],v12,6400
MM v[204:207],v[36:39],a[156:159]
s_waitcnt lgkmcnt(4)
MM v[208:211],v[40:43],a[128:131]
TR v[56:57],v13,4096
s_add_u32 m0, s79, 157696
MM v[208:211],v[44:47],a[144:147]
buffer_load_dwordx4 v18, s[48:51], s75 offen nt lds
MM v[212:215],v[40:43],a[132:135]
TR v[58:59],v13,4352
MM v[212:215],v[44:47],a[148:151]
MM v[216:219],v[40:43],a[136:139]
TR v[60:61],v13,6144
MM v[216:219],v[44:47],a[152:155]
MM v[220:223],v[40:43],a[140:143]
TR v[62:63],v13,6400
MM v[220:223],v[44:47],a[156:159]
s_waitcnt lgkmcnt(4)
MM v[224:227],v[48:51],a[128:131]
MM v[224:227],v[52:55],a[144:147]
s_waitcnt vmcnt(18)
s_waitcnt lgkmcnt(0)
s_barrier
MM v[228:231],v[48:51],a[132:135]
TR v[32:33],v4,8192
MM v[228:231],v[52:55],a[148:151]
TR v[34:35],v4,8704
MM v[232:235],v[48:51],a[136:139]
TR v[36:37],v4,12288
MM v[232:235],v[52:55],a[152:155]
TR v[38:39],v4,12800
MM v[236:239],v[48:51],a[140:143]
MM v[236:239],v[52:55],a[156:159]
MM v[240:243],v[56:59],a[128:131]
TR v[40:41],v4,16384
MM v[240:243],v[60:63],a[144:147]
MM v[244:247],v[56:59],a[132:135]
TR v[42:43],v4,16896
MM v[244:247],v[60:63],a[148:151]
MM v[248:251],v[56:59],a[136:139]
TR v[44:45],v4,20480
MM v[248:251],v[60:63],a[152:155]
MM v[252:255],v[56:59],a[140:143]
TR v[46:47],v4,20992
MM v[252:255],v[60:63],a[156:159]
s_waitcnt lgkmcnt(4)
MM v[64:67],a[160:163],v[32:35]
TR v[48:49],v5,8192
v_mov_b32 v28, 0x3f803f80
MM v[64:67],a[176:179],v[36:39]
v_mov_b32 v29, 0x3f803f80
MM v[68:71],a[164:167],v[32:35]
TR v[50:51],v5,8704
v_mov_b32 v30, 0x3f803f80
MM v[68:71],a[180:183],v[36:39]
MM v[72:75],a[168:171],v[32:35]
TR v[52:53],v5,12288
v_mov_b32 v31, 0x3f803f80
MM v[72:75],a[184:187],v[36:39]
s_lshl_b32 s30, s24, 15
v_add_u32 v16, s30, v2
MM v[76:79],a[172:175],v[32:35]
TR v[54:55],v5,12800
MM v[76:79],a[188:191],v[36:39]
s_waitcnt lgkmcnt(4)
MM v[64:67],a[192:195],v[40:43]
TR v[56:57],v5,16384
v_lshrrev_b32 v19, 4, v1
MM v[64:67],a[208:211],v[44:47]
v_lshlrev_b32 v19, 4, v19
MM v[68:71],a[196:199],v[40:43]
TR v[58:59],v5,16896
MM v[68:71],a[212:215],v[44:47]
s_lshl_b32 s30, s24, 8
s_add_u32 s30, s30, 0x20000
v_add_u32 v17, s30, v19
MM v[72:75],a[200:203],v[40:43]
TR v[60:61],v5,20480
MM v[72:75],a[216:219],v[44:47]
MM v[76:79],a[204:207],v[40:43]
TR v[62:63],v5,20992
MM v[76:79],a[220:223],v[44:47]
s_waitcnt lgkmcnt(4)
s_lshl_b32 s30, s24, 11
v_add_u32 v18, s30, v2
MM v[80:83],a[160:163],v[48:51]
TR v[32:33],v6,8192
MM v[80:83],a[176:179],v[52:55]
MM v[84:87],a[164:167],v[48:51]
TR v[34:35],v6,8704
s_lshl_b32 s30, s24, 6
v_add_u32 v19, s30, v19
MM v[84:87],a[180:183],v[52:55]
MM v[88:91],a[168:171],v[48:51]
TR v[36:37],v6,12288
MM v[88:91],a[184:187],v[52:55]
s_mov_b32 s52, 1.0
MM v[92:95],a[172:175],v[48:51]
TR v[38:39],v6,12800
s_mov_b32 s53, 1.0
MM v[92:95],a[188:191],v[52:55]
s_waitcnt lgkmcnt(4)
MM v[80:83],a[192:195],v[56:59]
TR v[40:41],v6,16384
MM v[80:83],a[208:211],v[60:63]
MM v[84:87],a[196:199],v[56:59]
TR v[42:43],v6,16896
MM v[84:87],a[212:215],v[60:63]
MM v[88:91],a[200:203],v[56:59]
TR v[44:45],v6,20480
MM v[88:91],a[216:219],v[60:63]
MM v[92:95],a[204:207],v[56:59]
TR v[46:47],v6,20992
MM v[92:95],a[220:223],v[60:63]
s_waitcnt lgkmcnt(4)
MM v[96:99],a[160:163],v[32:35]
TR v[48:49],v7,8192
MM v[96:99],a[176:179],v[36:39]
MM v[100:103],a[164:167],v[32:35]
TR v[50:51],v7,8704
MM v[100:103],a[180:183],v[36:39]
MM v[104:107],a[168:171],v[32:35]
TR v[52:53],v7,12288
MM v[104:107],a[184:187],v[36:39]
MM v[108:111],a[172:175],v[32:35]
TR v[54:55],v7,12800
MM v[108:111],a[188:191],v[36:39]
s_waitcnt lgkmcnt(4)
MM v[96:99],a[192:195],v[40:43]
TR v[56:57],v7,16384
MM v[96:99],a[208:211],v[44:47]
MM v[100:103],a[196:199],v[40:43]
TR v[58:59],v7,16896
MM v[100:103],a[212:215],v[44:47]
MM v[104:107],a[200:203],v[40:43]
TR v[60:61],v7,20480
MM v[104:107],a[216:219],v[44:47]
MM v[108:111],a[204:207],v[40:43]
TR v[62:63],v7,20992
MM v[108:111],a[220:223],v[44:47]
s_waitcnt vmcnt(0)
s_barrier
s_waitcnt lgkmcnt(4)
MM v[112:115],a[160:163],v[48:51]
TR v[32:33],v4,24576
MM v[112:115],a[176:179],v[52:55]
MM v[116:119],a[164:167],v[48:51]
TR v[34:35],v4,25088
v_and_b32 v24, 15, v1
MM v[116:119],a[180:183],v[52:55]
MM v[120:123],a[168:171],v[48:51]
TR v[36:37],v4,28672
v_lshlrev_b32 v24, 11, v24
MM v[120:123],a[184:187],v[52:55]
MM v[124:127],a[172:175],v[48:51]
TR v[38:39],v4,29184
v_bfe_u32 v25, v1, 4, 1
MM v[124:127],a[188:191],v[52:55]
s_waitcnt lgkmcnt(4)
MM v[112:115],a[192:195],v[56:59]
TR v[40:41],v5,24576
MM v[112:115],a[208:211],v[60:63]
v_lshl_add_u32 v24, v25, 5, v24
MM v[116:119],a[196:199],v[56:59]
TR v[42:43],v5,25088
MM v[116:119],a[212:215],v[60:63]
v_lshrrev_b32 v25, 5, v1
MM v[120:123],a[200:203],v[56:59]
TR v[44:45],v5,28672
MM v[120:123],a[216:219],v[60:63]
v_lshl_add_u32 v24, v25, 4, v24
MM v[124:127],a[204:207],v[56:59]
TR v[46:47],v5,29184
MM v[124:127],a[220:223],v[60:63]
s_waitcnt lgkmcnt(4)
MM v[64:67],a[224:227],v[32:35]
TR v[48:49],v6,24576
v_add_u32 v24, s94, v24
MM v[64:67],a[240:243],v[36:39]
MM v[68:71],a[228:231],v[32:35]
TR v[50:51],v6,25088
v_add_u32 v25, 32768, v24
MM v[68:71],a[244:247],v[36:39]
MM v[72:75],a[232:235],v[32:35]
TR v[52:53],v6,28672
global_load_dwordx4 a[128:131], v24, s[4:5] offset:0 nt
MM v[72:75],a[248:251],v[36:39]
MM v[76:79],a[236:239],v[32:35]
TR v[54:55],v6,29184
MM v[76:79],a[252:255],v[36:39]
s_waitcnt lgkmcnt(4)
global_load_dwordx4 a[136:139], v24, s[4:5] offset:64 nt
MM v[80:83],a[224:227],v[40:43]
TR v[56:57],v7,24576
MM v[80:83],a[240:243],v[44:47]
global_load_dwordx4 a[132:135], v25, s[4:5] offset:0 nt
MM v[84:87],a[228:231],v[40:43]
TR v[58:59],v7,25088
MM v[84:87],a[244:247],v[44:47]
global_load_dwordx4 a[140:143], v25, s[4:5] offset:64 nt
MM v[88:91],a[232:235],v[40:43]
TR v[60:61],v7,28672
MM v[88:91],a[248:251],v[44:47]
MM v[92:95],a[236:239],v[40:43]
TR v[62:63],v7,29184
v_pk_mul_f32 v[20:21], v[64:65], s[86:87] op_sel:[0,0] op_sel_hi:[1,0]
v_pk_mul_f32 v[22:23], v[66:67], s[86:87] op_sel:[0,0] op_sel_hi:[1,0]
v_pk_mul_f32 v[24:25], v[68:69], s[86:87] op_sel:[0,0] op_sel_hi:[1,0]
v_pk_mul_f32 v[26:27], v[70:71], s[86:87] op_sel:[0,0] op_sel_hi:[1,0]
v_exp_f32_e64 v20, v20 clamp
v_max_f32 v64, s88, v64
MM v[92:95],a[252:255],v[44:47]
s_waitcnt lgkmcnt(4)
v_exp_f32_e64 v21, v21 clamp
v_max_f32 v65, s88, v65
MM v[96:99],a[224:227],v[48:51]
TR v[32:33],v4,40960
v_exp_f32_e64 v22, v22 clamp
MM v[96:99],a[240:243],v[52:55]
v_max_f32 v66, s88, v66
v_exp_f32_e64 v23, v23 clamp
MM v[100:103],a[228:231],v[48:51]
TR v[34:35],v4,41472
v_max_f32 v67, s88, v67
MM v[100:103],a[244:247],v[52:55]
v_exp_f32_e64 v24, v24 clamp
v_max_f32 v68, s88, v68
MM v[104:107],a[232:235],v[48:51]
TR v[36:37],v4,45056
v_exp_f32_e64 v25, v25 clamp
MM v[104:107],a[248:251],v[52:55]
v_max_f32 v69, s88, v69
v_exp_f32_e64 v26, v26 clamp
MM v[108:111],a[236:239],v[48:51]
TR v[38:39],v4,45568
v_max_f32 v70, s88, v70
MM v[108:111],a[252:255],v[52:55]
s_waitcnt lgkmcnt(4)
v_exp_f32_e64 v27, v27 clamp
v_max_f32 v71, s88, v71
v_pk_add_f32 v[64:65], v[64:65], v[20:21]
v_pk_add_f32 v[66:67], v[66:67], v[22:23]
v_pk_add_f32 v[68:69], v[68:69], v[24:25]
v_pk_add_f32 v[70:71], v[70:71], v[26:27]
v_pk_mul_f32 v[20:21], v[72:73], s[86:87] op_sel:[0,0] op_sel_hi:[1,0]
v_pk_mul_f32 v[22:23], v[74:75], s[86:87] op_sel:[0,0] op_sel_hi:[1,0]
v_pk_mul_f32 v[24:25], v[76:77], s[86:87] op_sel:[0,0] op_sel_hi:[1,0]
v_pk_mul_f32 v[26:27], v[78:79], s[86:87] op_sel:[0,0] op_sel_hi:[1,0]
MM v[112:115],a[224:227],v[56:59]
TR v[40:41],v4,49152
v_cvt_pk_bf16_f32 v64, v64, v65
MM v[112:115],a[240:243],v[60:63]
v_cvt_pk_bf16_f32 v65, v66, v67
v_cvt_pk_bf16_f32 v66, v68, v69
MM v[116:119],a[228:231],v[56:59]
TR v[42:43],v4,49664
v_cvt_pk_bf16_f32 v67, v70, v71
MM v[116:119],a[244:247],v[60:63]
v_exp_f32_e64 v20, v20 clamp
v_max_f32 v72, s88, v72
MM v[120:123],a[232:235],v[56:59]
TR v[44:45],v4,53248
v_exp_f32_e64 v21, v21 clamp
v_max_f32 v73, s88, v73
MM v[120:123],a[248:251],v[60:63]
v_exp_f32_e64 v22, v22 clamp
MM v[124:127],a[236:239],v[56:59]
TR v[46:47],v4,53760
v_max_f32 v74, s88, v74
v_exp_f32_e64 v23, v23 clamp
MM v[124:127],a[252:255],v[60:63]
s_waitcnt lgkmcnt(4)
v_max_f32 v75, s88, v75
MM a[0:3],a[160:163],v[32:35]
TR v[48:49],v4,57344
v_exp_f32_e64 v24, v24 clamp
v_max_f32 v76, s88, v76
MM a[0:3],a[176:179],v[36:39]
v_exp_f32_e64 v25, v25 clamp
MM a[4:7],a[164:167],v[32:35]
TR v[50:51],v4,57856
v_max_f32 v77, s88, v77
v_exp_f32_e64 v26, v26 clamp
MM a[4:7],a[180:183],v[36:39]
v_max_f32 v78, s88, v78
MM a[8:11],a[168:171],v[32:35]
TR v[52:53],v4,61440
v_exp_f32_e64 v27, v27 clamp
v_max_f32 v79, s88, v79
v_pk_add_f32 v[72:73], v[72:73], v[20:21]
v_pk_add_f32 v[74:75], v[74:75], v[22:23]
v_pk_add_f32 v[76:77], v[76:77], v[24:25]
v_pk_add_f32 v[78:79], v[78:79], v[26:27]
MM a[8:11],a[184:187],v[36:39]
v_cvt_pk_bf16_f32 v72, v72, v73
MM a[12:15],a[172:175],v[32:35]
TR v[54:55],v4,61952
v_cvt_pk_bf16_f32 v73, v74, v75
v_cvt_pk_bf16_f32 v74, v76, v77
MM a[12:15],a[188:191],v[36:39]
s_waitcnt lgkmcnt(4)
v_cvt_pk_bf16_f32 v75, v78, v79
MM a[0:3],a[192:195],v[40:43]
TR v[56:57],v5,40960
v_pk_mul_f32 v[20:21], v[80:81], s[86:87] op_sel:[0,0] op_sel_hi:[1,0]
v_pk_mul_f32 v[22:23], v[82:83], s[86:87] op_sel:[0,0] op_sel_hi:[1,0]
v_pk_mul_f32 v[24:25], v[84:85], s[86:87] op_sel:[0,0] op_sel_hi:[1,0]
v_pk_mul_f32 v[26:27], v[86:87], s[86:87] op_sel:[0,0] op_sel_hi:[1,0]
v_exp_f32_e64 v20, v20 clamp
v_max_f32 v80, s88, v80
MM a[0:3],a[208:211],v[44:47]
v_exp_f32_e64 v21, v21 clamp
v_max_f32 v81, s88, v81
MM a[4:7],a[196:199],v[40:43]
TR v[58:59],v5,41472
v_exp_f32_e64 v22, v22 clamp
MM a[4:7],a[212:215],v[44:47]
v_max_f32 v82, s88, v82
v_exp_f32_e64 v23, v23 clamp
MM a[8:11],a[200:203],v[40:43]
TR v[60:61],v5,45056
v_max_f32 v83, s88, v83
MM a[8:11],a[216:219],v[44:47]
v_exp_f32_e64 v24, v24 clamp
v_max_f32 v84, s88, v84
MM a[12:15],a[204:207],v[40:43]
TR v[62:63],v5,45568
v_exp_f32_e64 v25, v25 clamp
MM a[12:15],a[220:223],v[44:47]
s_waitcnt lgkmcnt(4)
v_max_f32 v85, s88, v85
v_exp_f32_e64 v26, v26 clamp
MM a[0:3],a[224:227],v[48:51]
TR v[32:33],v5,49152
v_max_f32 v86, s88, v86
MM a[0:3],a[240:243],v[52:55]
v_exp_f32_e64 v27, v27 clamp
v_max_f32 v87, s88, v87
v_pk_add_f32 v[80:81], v[80:81], v[20:21]
v_pk_add_f32 v[82:83], v[82:83], v[22:23]
v_pk_add_f32 v[84:85], v[84:85], v[24:25]
v_pk_add_f32 v[86:87], v[86:87], v[26:27]
v_pk_mul_f32 v[20:21], v[88:89], s[86:87] op_sel:[0,0] op_sel_hi:[1,0]
v_pk_mul_f32 v[22:23], v[90:91], s[86:87] op_sel:[0,0] op_sel_hi:[1,0]
v_pk_mul_f32 v[24:25], v[92:93], s[86:87] op_sel:[0,0] op_sel_hi:[1,0]
v_pk_mul_f32 v[26:27], v[94:95], s[86:87] op_sel:[0,0] op_sel_hi:[1,0]
MM a[4:7],a[228:231],v[48:51]
TR v[34:35],v5,49664
v_cvt_pk_bf16_f32 v80, v80, v81
MM a[4:7],a[244:247],v[52:55]
v_cvt_pk_bf16_f32 v81, v82, v83
v_cvt_pk_bf16_f32 v82, v84, v85
MM a[8:11],a[232:235],v[48:51]
TR v[36:37],v5,53248
v_cvt_pk_bf16_f32 v83, v86, v87
MM a[8:11],a[248:251],v[52:55]
v_exp_f32_e64 v20, v20 clamp
v_max_f32 v88, s88, v88
MM a[12:15],a[236:239],v[48:51]
TR v[38:39],v5,53760
v_exp_f32_e64 v21, v21 clamp
v_max_f32 v89, s88, v89
MM a[12:15],a[252:255],v[52:55]
s_waitcnt lgkmcnt(4)
v_exp_f32_e64 v22, v22 clamp
MM a[16:19],a[160:163],v[56:59]
TR v[40:41],v5,57344
v_max_f32 v90, s88, v90
v_exp_f32_e64 v23, v23 clamp
MM a[16:19],a[176:179],v[60:63]
v_max_f32 v91, s88, v91
MM a[20:23],a[164:167],v[56:59]
TR v[42:43],v5,57856
v_exp_f32_e64 v24, v24 clamp
v_max_f32 v92, s88, v92
MM a[20:23],a[180:183],v[60:63]
v_exp_f32_e64 v25, v25 clamp
MM a[24:27],a[168:171],v[56:59]
TR v[44:45],v5,61440
v_max_f32 v93, s88, v93
v_exp_f32_e64 v26, v26 clamp
MM a[24:27],a[184:187],v[60:63]
v_max_f32 v94, s88, v94
MM a[28:31],a[172:175],v[56:59]
TR v[46:47],v5,61952
v_exp_f32_e64 v27, v27 clamp
v_max_f32 v95, s88, v95
v_pk_add_f32 v[88:89], v[88:89], v[20:21]
v_pk_add_f32 v[90:91], v[90:91], v[22:23]
v_pk_add_f32 v[92:93], v[92:93], v[24:25]
v_pk_add_f32 v[94:95], v[94:95], v[26:27]
MM a[28:31],a[188:191],v[60:63]
s_waitcnt lgkmcnt(4)
v_cvt_pk_bf16_f32 v88, v88, v89
MM a[16:19],a[192:195],v[32:35]
TR v[48:49],v6,40960
v_cvt_pk_bf16_f32 v89, v90, v91
v_cvt_pk_bf16_f32 v90, v92, v93
MM a[16:19],a[208:211],v[36:39]
v_cvt_pk_bf16_f32 v91, v94, v95
MM a[20:23],a[196:199],v[32:35]
TR v[50:51],v6,41472
v_pk_mul_f32 v[20:21], v[96:97], s[86:87] op_sel:[0,0] op_sel_hi:[1,0]
v_pk_mul_f32 v[22:23], v[98:99], s[86:87] op_sel:[0,0] op_sel_hi:[1,0]
v_pk_mul_f32 v[24:25], v[100:101], s[86:87] op_sel:[0,0] op_sel_hi:[1,0]
v_pk_mul_f32 v[26:27], v[102:103], s[86:87] op_sel:[0,0] op_sel_hi:[1,0]
v_exp_f32_e64 v20, v20 clamp
v_max_f32 v96, s88, v96
MM a[20:23],a[212:215],v[36:39]
v_exp_f32_e64 v21, v21 clamp
v_max_f32 v97, s88, v97
MM a[24:27],a[200:203],v[32:35]
TR v[52:53],v6,45056
v_exp_f32_e64 v22, v22 clamp
MM a[24:27],a[216:219],v[36:39]
v_max_f32 v98, s88, v98
v_exp_f32_e64 v23, v23 clamp
MM a[28:31],a[204:207],v[32:35]
TR v[54:55],v6,45568
v_max_f32 v99, s88, v99
MM a[28:31],a[220:223],v[36:39]
s_waitcnt lgkmcnt(4)
v_exp_f32_e64 v24, v24 clamp
v_max_f32 v100, s88, v100
MM a[16:19],a[224:227],v[40:43]
TR v[56:57],v6,49152
v_exp_f32_e64 v25, v25 clamp
MM a[16:19],a[240:243],v[44:47]
v_max_f32 v101, s88, v101
v_exp_f32_e64 v26, v26 clamp
MM a[20:23],a[228:231],v[40:43]
TR v[58:59],v6,49664
v_max_f32 v102, s88, v102
MM a[20:23],a[244:247],v[44:47]
v_exp_f32_e64 v27, v27 clamp
v_max_f32 v103, s88, v103
v_pk_add_f32 v[96:97], v[96:97], v[20:21]
v_pk_add_f32 v[98:99], v[98:99], v[22:23]
v_pk_add_f32 v[100:101], v[100:101], v[24:25]
v_pk_add_f32 v[102:103], v[102:103], v[26:27]
v_pk_mul_f32 v[20:21], v[104:105], s[86:87] op_sel:[0,0] op_sel_hi:[1,0]
v_pk_mul_f32 v[22:23], v[106:107], s[86:87] op_sel:[0,0] op_sel_hi:[1,0]
v_pk_mul_f32 v[24:25], v[108:109], s[86:87] op_sel:[0,0] op_sel_hi:[1,0]
v_pk_mul_f32 v[26:27], v[110:111], s[86:87] op_sel:[0,0] op_sel_hi:[1,0]
MM a[24:27],a[232:235],v[40:43]
TR v[60:61],v6,53248
v_cvt_pk_bf16_f32 v96, v96, v97
MM a[24:27],a[248:251],v[44:47]
v_cvt_pk_bf16_f32 v97, v98, v99
v_cvt_pk_bf16_f32 v98, v100, v101
MM a[28:31],a[236:239],v[40:43]
TR v[62:63],v6,53760
v_cvt_pk_bf16_f32 v99, v102, v103
MM a[28:31],a[252:255],v[44:47]
s_waitcnt lgkmcnt(4)
v_exp_f32_e64 v20, v20 clamp
v_max_f32 v104, s88, v104
MM a[32:35],a[160:163],v[48:51]
TR v[32:33],v6,57344
v_exp_f32_e64 v21, v21 clamp
v_max_f32 v105, s88, v105
MM a[32:35],a[176:179],v[52:55]
v_exp_f32_e64 v22, v22 clamp
MM a[36:39],a[164:167],v[48:51]
TR v[34:35],v6,57856
v_max_f32 v106, s88, v106
v_exp_f32_e64 v23, v23 clamp
MM a[36:39],a[180:183],v[52:55]
v_max_f32 v107, s88, v107
MM a[40:43],a[168:171],v[48:51]
TR v[36:37],v6,61440
v_exp_f32_e64 v24, v24 clamp
v_max_f32 v108, s88, v108
MM a[40:43],a[184:187],v[52:55]
v_exp_f32_e64 v25, v25 clamp
MM a[44:47],a[172:175],v[48:51]
TR v[38:39],v6,61952
v_max_f32 v109, s88, v109
v_exp_f32_e64 v26, v26 clamp
MM a[44:47],a[188:191],v[52:55]
s_waitcnt lgkmcnt(4)
v_max_f32 v110, s88, v110
MM a[32:35],a[192:195],v[56:59]
TR v[40:41],v7,40960
v_exp_f32_e64 v27, v27 clamp
v_max_f32 v111, s88, v111
v_pk_add_f32 v[104:105], v[104:105], v[20:21]
v_pk_add_f32 v[106:107], v[106:107], v[22:23]
v_pk_add_f32 v[108:109], v[108:109], v[24:25]
v_pk_add_f32 v[110:111], v[110:111], v[26:27]
MM a[32:35],a[208:211],v[60:63]
v_cvt_pk_bf16_f32 v104, v104, v105
MM a[36:39],a[196:199],v[56:59]
TR v[42:43],v7,41472
v_cvt_pk_bf16_f32 v105, v106, v107
v_cvt_pk_bf16_f32 v106, v108, v109
MM a[36:39],a[212:215],v[60:63]
v_cvt_pk_bf16_f32 v107, v110, v111
MM a[40:43],a[200:203],v[56:59]
TR v[44:45],v7,45056
v_accvgpr_read_b32 v24, a0
v_accvgpr_read_b32 v25, a1
v_accvgpr_read_b32 v26, a2
v_accvgpr_read_b32 v27, a3
MM a[40:43],a[216:219],v[60:63]
v_cvt_pk_bf16_f32 v68, v24, v25
v_cvt_pk_bf16_f32 v69, v26, v27
v_accvgpr_read_b32 v24, a4
v_accvgpr_read_b32 v25, a5
MM a[44:47],a[204:207],v[56:59]
TR v[46:47],v7,45568
v_accvgpr_read_b32 v26, a6
v_accvgpr_read_b32 v27, a7
v_cvt_pk_bf16_f32 v70, v24, v25
v_cvt_pk_bf16_f32 v71, v26, v27
MM a[44:47],a[220:223],v[60:63]
s_waitcnt lgkmcnt(4)
v_accvgpr_read_b32 v24, a8
v_accvgpr_read_b32 v25, a9
v_accvgpr_read_b32 v26, a10
v_accvgpr_read_b32 v27, a11
MM a[32:35],a[224:227],v[32:35]
TR v[48:49],v7,49152
v_cvt_pk_bf16_f32 v76, v24, v25
v_cvt_pk_bf16_f32 v77, v26, v27
v_accvgpr_read_b32 v24, a12
v_accvgpr_read_b32 v25, a13
MM a[32:35],a[240:243],v[36:39]
v_accvgpr_read_b32 v26, a14
v_accvgpr_read_b32 v27, a15
v_cvt_pk_bf16_f32 v78, v24, v25
v_cvt_pk_bf16_f32 v79, v26, v27
MM a[36:39],a[228:231],v[32:35]
TR v[50:51],v7,49664
v_pk_mul_f32 v[20:21], v[112:113], s[86:87] op_sel:[0,0] op_sel_hi:[1,0]
v_pk_mul_f32 v[22:23], v[114:115], s[86:87] op_sel:[0,0] op_sel_hi:[1,0]
v_pk_mul_f32 v[24:25], v[116:117], s[86:87] op_sel:[0,0] op_sel_hi:[1,0]
v_pk_mul_f32 v[26:27], v[118:119], s[86:87] op_sel:[0,0] op_sel_hi:[1,0]
v_exp_f32_e64 v20, v20 clamp
v_max_f32 v112, s88, v112
MM a[36:39],a[244:247],v[36:39]
v_exp_f32_e64 v21, v21 clamp
v_max_f32 v113, s88, v113
MM a[40:43],a[232:235],v[32:35]
TR v[52:53],v7,53248
v_exp_f32_e64 v22, v22 clamp
MM a[40:43],a[248:251],v[36:39]
v_max_f32 v114, s88, v114
v_exp_f32_e64 v23, v23 clamp
MM a[44:47],a[236:239],v[32:35]
TR v[54:55],v7,53760
v_max_f32 v115, s88, v115
v_exp_f32_e64 v24, v24 clamp
MM a[44:47],a[252:255],v[36:39]
s_waitcnt lgkmcnt(4)
v_max_f32 v116, s88, v116
MM a[48:51],a[160:163],v[40:43]
TR v[56:57],v7,57344
v_exp_f32_e64 v25, v25 clamp
v_max_f32 v117, s88, v117
MM a[48:51],a[176:179],v[44:47]
v_exp_f32_e64 v26, v26 clamp
v_max_f32 v118, s88, v118
MM a[52:55],a[164:167],v[40:43]
TR v[58:59],v7,57856
v_exp_f32_e64 v27, v27 clamp
MM a[52:55],a[180:183],v[44:47]
v_max_f32 v119, s88, v119
v_pk_add_f32 v[112:113], v[112:113], v[20:21]
v_pk_add_f32 v[114:115], v[114:115], v[22:23]
v_pk_add_f32 v[116:117], v[116:117], v[24:25]
v_pk_add_f32 v[118:119], v[118:119], v[26:27]
v_pk_mul_f32 v[20:21], v[120:121], s[86:87] op_sel:[0,0] op_sel_hi:[1,0]
v_pk_mul_f32 v[22:23], v[122:123], s[86:87] op_sel:[0,0] op_sel_hi:[1,0]
v_pk_mul_f32 v[24:25], v[124:125], s[86:87] op_sel:[0,0] op_sel_hi:[1,0]
v_pk_mul_f32 v[26:27], v[126:127], s[86:87] op_sel:[0,0] op_sel_hi:[1,0]
v_cvt_pk_bf16_f32 v112, v112, v113
MM a[56:59],a[168:171],v[40:43]
TR v[60:61],v7,61440
v_cvt_pk_bf16_f32 v113, v114, v115
v_cvt_pk_bf16_f32 v114, v116, v117
MM a[56:59],a[184:187],v[44:47]
v_cvt_pk_bf16_f32 v115, v118, v119
MM a[60:63],a[172:175],v[40:43]
TR v[62:63],v7,61952
v_exp_f32_e64 v20, v20 clamp
v_max_f32 v120, s88, v120
MM a[60:63],a[188:191],v[44:47]
s_waitcnt lgkmcnt(4)
v_exp_f32_e64 v21, v21 clamp
v_max_f32 v121, s88, v121
MM a[48:51],a[192:195],v[48:51]
TR v[32:33],v8,8192
v_exp_f32_e64 v22, v22 clamp
MM a[48:51],a[208:211],v[52:55]
v_max_f32 v122, s88, v122
v_exp_f32_e64 v23, v23 clamp
MM a[52:55],a[196:199],v[48:51]
TR v[34:35],v8,8704
v_max_f32 v123, s88, v123
v_exp_f32_e64 v24, v24 clamp
MM a[52:55],a[212:215],v[52:55]
v_max_f32 v124, s88, v124
MM a[56:59],a[200:203],v[48:51]
TR v[36:37],v8,12288
v_exp_f32_e64 v25, v25 clamp
v_max_f32 v125, s88, v125
MM a[56:59],a[216:219],v[52:55]
v_exp_f32_e64 v26, v26 clamp
v_max_f32 v126, s88, v126
MM a[60:63],a[204:207],v[48:51]
TR v[38:39],v8,12800
v_exp_f32_e64 v27, v27 clamp
MM a[60:63],a[220:223],v[52:55]
s_waitcnt lgkmcnt(4)
v_max_f32 v127, s88, v127
v_pk_add_f32 v[120:121], v[120:121], v[20:21]
v_pk_add_f32 v[122:123], v[122:123], v[22:23]
v_pk_add_f32 v[124:125], v[124:125], v[24:25]
v_pk_add_f32 v[126:127], v[126:127], v[26:27]
v_cvt_pk_bf16_f32 v120, v120, v121
MM a[48:51],a[224:227],v[56:59]
TR v[40:41],v8,16384
v_cvt_pk_bf16_f32 v121, v122, v123
v_cvt_pk_bf16_f32 v122, v124, v125
MM a[48:51],a[240:243],v[60:63]
v_cvt_pk_bf16_f32 v123, v126, v127
MM a[52:55],a[228:231],v[56:59]
TR v[42:43],v8,16896
v_accvgpr_read_b32 v24, a16
v_accvgpr_read_b32 v25, a17
v_accvgpr_read_b32 v26, a18
v_accvgpr_read_b32 v27, a19
v_cvt_pk_bf16_f32 v84, v24, v25
MM a[52:55],a[244:247],v[60:63]
v_cvt_pk_bf16_f32 v85, v26, v27
v_accvgpr_read_b32 v24, a20
v_accvgpr_read_b32 v25, a21
v_accvgpr_read_b32 v26, a22
v_accvgpr_read_b32 v27, a23
MM a[56:59],a[232:235],v[56:59]
TR v[44:45],v8,20480
v_cvt_pk_bf16_f32 v86, v24, v25
v_cvt_pk_bf16_f32 v87, v26, v27
v_accvgpr_read_b32 v24, a24
v_accvgpr_read_b32 v25, a25
v_accvgpr_read_b32 v26, a26
MM a[56:59],a[248:251],v[60:63]
v_accvgpr_read_b32 v27, a27
v_cvt_pk_bf16_f32 v92, v24, v25
v_cvt_pk_bf16_f32 v93, v26, v27
v_accvgpr_read_b32 v24, a28
v_accvgpr_read_b32 v25, a29
MM a[60:63],a[236:239],v[56:59]
TR v[46:47],v8,20992
v_accvgpr_read_b32 v26, a30
v_accvgpr_read_b32 v27, a31
v_cvt_pk_bf16_f32 v94, v24, v25
v_cvt_pk_bf16_f32 v95, v26, v27
MM a[60:63],a[252:255],v[60:63]
s_waitcnt lgkmcnt(4)
v_accvgpr_read_b32 v24, a32
v_accvgpr_read_b32 v25, a33
v_accvgpr_read_b32 v26, a34
v_accvgpr_read_b32 v27, a35
v_cvt_pk_bf16_f32 v100, v24, v25
MM v[128:131],v[32:35],a[160:163]
TR v[48:49],v8,24576
v_cvt_pk_bf16_f32 v101, v26, v27
v_accvgpr_read_b32 v24, a36
v_accvgpr_read_b32 v25, a37
v_accvgpr_read_b32 v26, a38
v_accvgpr_read_b32 v27, a39
MM v[128:131],v[36:39],a[176:179]
v_cvt_pk_bf16_f32 v102, v24, v25
v_cvt_pk_bf16_f32 v103, v26, v27
v_accvgpr_read_b32 v24, a40
v_accvgpr_read_b32 v25, a41
v_accvgpr_read_b32 v26, a42
MM v[132:135],v[32:35],a[164:167]
TR v[50:51],v8,25088
v_accvgpr_read_b32 v27, a43
v_cvt_pk_bf16_f32 v108, v24, v25
v_cvt_pk_bf16_f32 v109, v26, v27
v_accvgpr_read_b32 v24, a44
v_accvgpr_read_b32 v25, a45
MM v[132:135],v[36:39],a[180:183]
v_accvgpr_read_b32 v26, a46
v_accvgpr_read_b32 v27, a47
v_cvt_pk_bf16_f32 v110, v24, v25
v_cvt_pk_bf16_f32 v111, v26, v27
MM v[136:139],v[32:35],a[168:171]
TR v[52:53],v8,28672
MM v[136:139],v[36:39],a[184:187]
MM v[140:143],v[32:35],a[172:175]
TR v[54:55],v8,29184
v_accvgpr_read_b32 v24, a48
v_accvgpr_read_b32 v25, a49
v_accvgpr_read_b32 v26, a50
v_accvgpr_read_b32 v27, a51
MM v[140:143],v[36:39],a[188:191]
s_waitcnt lgkmcnt(4)
v_cvt_pk_bf16_f32 v116, v24, v25
v_cvt_pk_bf16_f32 v117, v26, v27
v_accvgpr_read_b32 v24, a52
v_accvgpr_read_b32 v25, a53
MM v[128:131],v[40:43],a[192:195]
TR v[56:57],v9,8192
v_accvgpr_read_b32 v26, a54
v_accvgpr_read_b32 v27, a55
v_cvt_pk_bf16_f32 v118, v24, v25
v_cvt_pk_bf16_f32 v119, v26, v27
MM v[128:131],v[44:47],a[208:211]
v_accvgpr_read_b32 v24, a56
v_accvgpr_read_b32 v25, a57
v_accvgpr_read_b32 v26, a58
v_accvgpr_read_b32 v27, a59
MM v[132:135],v[40:43],a[196:199]
TR v[58:59],v9,8704
v_cvt_pk_bf16_f32 v124, v24, v25
v_cvt_pk_bf16_f32 v125, v26, v27
v_accvgpr_read_b32 v24, a60
v_accvgpr_read_b32 v25, a61
MM v[132:135],v[44:47],a[212:215]
v_accvgpr_read_b32 v26, a62
v_accvgpr_read_b32 v27, a63
v_cvt_pk_bf16_f32 v126, v24, v25
v_cvt_pk_bf16_f32 v127, v26, v27
MM v[136:139],v[40:43],a[200:203]
TR v[60:61],v9,12288
MM v[136:139],v[44:47],a[216:219]
v_mfma_f32_16x16x32_bf16 a[0:3], v[64:67], v[68:71], 0
v_mfma_f32_16x16x32_bf16 a[8:11], v[64:67], v[84:87], 0
v_mfma_f32_16x16x32_bf16 a[32:35], v[64:67], v[28:31], 0
MM v[140:143],v[40:43],a[204:207]
TR v[62:63],v9,12800
v_mfma_f32_16x16x32_bf16 a[4:7], v[80:83], v[68:71], 0
v_mfma_f32_16x16x32_bf16 a[12:15], v[80:83], v[84:87], 0
MM v[140:143],v[44:47],a[220:223]
s_waitcnt lgkmcnt(4)
v_mfma_f32_16x16x32_bf16 a[36:39], v[80:83], v[28:31], 0
v_mfma_f32_16x16x32_bf16 a[16:19], v[96:99], v[100:103], 0
v_mfma_f32_16x16x32_bf16 a[24:27], v[96:99], v[116:119], 0
MM v[128:131],v[48:51],a[224:227]
TR v[32:33],v9,16384
v_mfma_f32_16x16x32_bf16 a[40:43], v[96:99], v[28:31], 0
v_mfma_f32_16x16x32_bf16 a[20:23], v[112:115], v[100:103], 0
MM v[128:131],v[52:55],a[240:243]
v_mfma_f32_16x16x32_bf16 a[28:31], v[112:115], v[116:119], 0
v_mfma_f32_16x16x32_bf16 a[44:47], v[112:115], v[28:31], 0
MM v[132:135],v[48:51],a[228:231]
TR v[34:35],v9,16896
MM a[0:3],v[72:75],v[76:79]
MM a[8:11],v[72:75],v[92:95]
MM a[32:35],v[72:75],v[28:31]
MM v[132:135],v[52:55],a[244:247]
MM a[4:7],v[88:91],v[76:79]
MM a[12:15],v[88:91],v[92:95]
MM v[136:139],v[48:51],a[232:235]
TR v[36:37],v9,20480
MM a[36:39],v[88:91],v[28:31]
MM a[16:19],v[104:107],v[108:111]
MM a[24:27],v[104:107],v[124:127]
MM v[136:139],v[52:55],a[248:251]
MM a[40:43],v[104:107],v[28:31]
MM a[20:23],v[120:123],v[108:111]
MM v[140:143],v[48:51],a[236:239]
TR v[38:39],v9,20992
MM a[28:31],v[120:123],v[124:127]
MM a[44:47],v[120:123],v[28:31]
MM v[140:143],v[52:55],a[252:255]
s_waitcnt lgkmcnt(4)
MM v[144:147],v[56:59],a[160:163]
TR v[40:41],v9,24576
MM v[144:147],v[60:63],a[176:179]
MM v[148:151],v[56:59],a[164:167]
TR v[42:43],v9,25088
MM v[148:151],v[60:63],a[180:183]
ds_write_b128 v16, a[0:3] offset:0
ds_write_b128 v16, a[4:7] offset:1024
ds_write_b128 v16, a[8:11] offset:2048
MM v[152:155],v[56:59],a[168:171]
TR v[44:45],v9,28672
ds_write_b128 v16, a[12:15] offset:3072
ds_write_b128 v16, a[16:19] offset:4096
MM v[152:155],v[60:63],a[184:187]
ds_write_b128 v16, a[20:23] offset:5120
ds_write_b128 v16, a[24:27] offset:6144
MM v[156:159],v[56:59],a[172:175]
TR v[46:47],v9,29184
ds_write_b128 v16, a[28:31] offset:7168
s_mov_b32 s30, 0x00010001
s_mov_b32 s31, 0x00010001
s_mov_b64 exec, s[30:31]
ds_write_b128 v17, a[32:35] offset:0
ds_write_b128 v17, a[36:39] offset:64
ds_write_b128 v17, a[40:43] offset:128
ds_write_b128 v17, a[44:47] offset:192
s_mov_b64 exec, -1
MM v[156:159],v[60:63],a[188:191]
s_waitcnt lgkmcnt(15)
MM v[144:147],v[32:35],a[192:195]
TR v[48:49],v8,40960
MM v[144:147],v[36:39],a[208:211]
MM v[148:151],v[32:35],a[196:199]
TR v[50:51],v8,41472
MM v[148:151],v[36:39],a[212:215]
MM v[152:155],v[32:35],a[200:203]
TR v[52:53],v8,45056
MM v[152:155],v[36:39],a[216:219]
MM v[156:159],v[32:35],a[204:207]
TR v[54:55],v8,45568
s_waitcnt lgkmcnt(4)
s_barrier
v_add_u32 v16, 0x10000, v18
MM v[156:159],v[36:39],a[220:223]
s_waitcnt lgkmcnt(9)
v_add_u32 v17, 0x20000, v19
ds_read_b128 v[64:67], v18 offset:0
MM v[144:147],v[40:43],a[224:227]
TR v[56:57],v8,49152
ds_read_b128 v[68:71], v18 offset:1024
ds_read_b128 v[72:75], v17 offset:0
MM v[144:147],v[44:47],a[240:243]
ds_read_b128 v[76:79], v18 offset:32768
ds_read_b128 v[80:83], v18 offset:33792
ds_read_b128 v[84:87], v17 offset:256
MM v[148:151],v[40:43],a[228:231]
TR v[58:59],v8,49664
ds_read_b128 v[88:91], v16 offset:0
ds_read_b128 v[92:95], v16 offset:1024
MM v[148:151],v[44:47],a[244:247]
ds_read_b128 v[96:99], v17 offset:512
ds_read_b128 v[100:103], v16 offset:32768
MM v[152:155],v[40:43],a[232:235]
TR v[60:61],v8,53248
ds_read_b128 v[104:107], v16 offset:33792
ds_read_b128 v[108:111], v17 offset:768
MM v[152:155],v[44:47],a[248:251]
MM v[156:159],v[40:43],a[236:239]
TR v[62:63],v8,53760
MM v[156:159],v[44:47],a[252:255]
s_waitcnt lgkmcnt(15)
MM a[64:67],v[48:51],a[160:163]
TR v[32:33],v8,57344
MM a[64:67],v[52:55],a[176:179]
MM a[68:71],v[48:51],a[164:167]
TR v[34:35],v8,57856
MM a[68:71],v[52:55],a[180:183]
s_waitcnt lgkmcnt(3)
v_add_f32 v64, v64, v76
v_add_f32 v88, v88, v100
v_add_f32 v65, v65, v77
v_add_f32 v89, v89, v101
MM a[72:75],v[48:51],a[168:171]
TR v[36:37],v8,61440
v_add_f32 v66, v66, v78
v_add_f32 v90, v90, v102
v_add_f32 v67, v67, v79
v_add_f32 v91, v91, v103
MM a[72:75],v[52:55],a[184:187]
v_add_f32 v68, v68, v80
v_add_f32 v92, v92, v104
v_add_f32 v69, v69, v81
v_add_f32 v93, v93, v105
MM a[76:79],v[48:51],a[172:175]
TR v[38:39],v8,61952
v_add_f32 v70, v70, v82
v_add_f32 v94, v94, v106
v_add_f32 v71, v71, v83
v_add_f32 v95, v95, v107
MM a[76:79],v[52:55],a[188:191]
s_waitcnt lgkmcnt(4)
v_add_f32 v72, v72, v84
v_add_f32 v96, v96, v108
v_add_f32 v73, v73, v85
v_add_f32 v97, v97, v109
MM a[64:67],v[56:59],a[192:195]
TR v[40:41],v9,40960
v_add_f32 v74, v74, v86
v_add_f32 v98, v98, v110
v_add_f32 v75, v75, v87
v_add_f32 v99, v99, v111
v_add_f32 v64, v64, v88
MM a[64:67],v[60:63],a[208:211]
v_add_f32 v65, v65, v89
v_add_f32 v66, v66, v90
v_add_f32 v67, v67, v91
v_add_f32 v68, v68, v92
MM a[68:71],v[56:59],a[196:199]
TR v[42:43],v9,41472
v_add_f32 v69, v69, v93
v_add_f32 v70, v70, v94
v_add_f32 v71, v71, v95
v_add_f32 v72, v72, v96
MM a[68:71],v[60:63],a[212:215]
v_add_f32 v73, v73, v97
v_add_f32 v74, v74, v98
v_add_f32 v75, v75, v99
s_mul_i32 s10, s26, 8448
MM a[72:75],v[56:59],a[200:203]
TR v[44:45],v9,45056
s_add_u32 s11, s10, 8192
buffer_store_dwordx4 v[64:67], v18, s[60:63], s10 offen sc0 sc1
buffer_store_dwordx4 v[68:71], v18, s[60:63], s10 offen offset:1024 sc0 sc1
s_mov_b32 s30, 0x00010001
s_mov_b32 s31, 0x00010001
s_mov_b64 exec, s[30:31]
buffer_store_dwordx4 v[72:75], v19, s[60:63], s11 offen sc0 sc1
s_mov_b64 exec, -1
MM a[72:75],v[60:63],a[216:219]
MM a[76:79],v[56:59],a[204:207]
TR v[46:47],v9,45568
MM a[76:79],v[60:63],a[220:223]
s_waitcnt lgkmcnt(4)
MM a[64:67],v[32:35],a[224:227]
TR v[48:49],v9,49152
v_lshrrev_b32 v29, 4, v1
v_bfe_u32 v28, v1, 1, 2
MM a[64:67],v[36:39],a[240:243]
v_xor_b32 v28, v28, v29
v_lshlrev_b32 v28, 5, v28
MM a[68:71],v[32:35],a[228:231]
TR v[50:51],v9,49664
v_and_b32 v29, 1, v1
v_lshl_add_u32 v28, v29, 4, v28
MM a[68:71],v[36:39],a[244:247]
v_lshrrev_b32 v29, 3, v1
v_lshl_add_u32 v28, v29, 11, v28
MM a[72:75],v[32:35],a[232:235]
TR v[52:53],v9,53248
s_lshl_b32 s78, s24, 12
s_and_b32 s79, s94, 0x7ff
MM a[72:75],v[36:39],a[248:251]
s_sub_u32 s31, 7340032, s79
s_add_u32 s32, s16, s79
s_addc_u32 s33, s17, 0
s_mov_b32 s34, s31
s_mov_b32 s35, 0x20000
MM a[76:79],v[32:35],a[236:239]
TR v[54:55],v9,53760
MM a[76:79],v[36:39],a[252:255]
s_waitcnt lgkmcnt(4)
s_xor_b32 s30, s79, 128
s_sub_u32 s31, 7340032, s30
s_add_u32 s44, s16, s30
s_addc_u32 s45, s17, 0
s_mov_b32 s46, s31
s_mov_b32 s47, 0x20000
MM a[80:83],v[40:43],a[160:163]
TR v[56:57],v9,57344
MM a[80:83],v[44:47],a[176:179]
MM a[84:87],v[40:43],a[164:167]
TR v[58:59],v9,57856
s_lshr_b32 s30, s95, 3
s_lshl_b32 s30, s30, 2
s_add_u32 s30, s30, s24
s_mul_i32 s30, s30, 294912
s_add_u32 s30, s30, 4194304
s_add_u32 s36, s22, s30
s_addc_u32 s37, s23, 0
s_mov_b32 s38, 294912
s_mov_b32 s39, 0x20000
MM a[84:87],v[44:47],a[180:183]
MM a[88:91],v[40:43],a[168:171]
TR v[60:61],v9,61440
MM a[88:91],v[44:47],a[184:187]
s_lshl_b32 s30, s95, 16
s_lshl_b32 s31, s24, 14
s_add_u32 s30, s30, s31
s_add_u32 s30, s30, 33554432
s_add_u32 s40, s22, s30
s_addc_u32 s41, s23, 0
s_mov_b32 s42, 16384
s_mov_b32 s43, 0x20000
MM a[92:95],v[40:43],a[172:175]
TR v[62:63],v9,61952
MM a[92:95],v[44:47],a[188:191]
s_waitcnt lgkmcnt(4)
MM a[80:83],v[48:51],a[192:195]
TR v[32:33],v10,8192
s_lshl_b32 s74, s91, 13
s_xor_b32 s77, s74, 8192
MM a[80:83],v[52:55],a[208:211]
s_mov_b32 s48, 0xd9c85140
s_mov_b32 s49, 0x377362ba
MM a[84:87],v[48:51],a[196:199]
TR v[34:35],v10,8704
s_lshl_b32 s75, s91, 2
s_add_u32 s75, s75, s24
s_mul_i32 s75, s75, 917504
s_mov_b32 s72, s75
MM a[84:87],v[52:55],a[212:215]
MM a[88:91],v[48:51],a[200:203]
TR v[36:37],v10,12288
s_mul_i32 s73, s91, 114688
s_add_u32 s76, s73, 4096
s_mov_b32 s80, 3
s_mov_b32 s50, 32
MM a[88:91],v[52:55],a[216:219]
MM a[92:95],v[48:51],a[204:207]
TR v[38:39],v10,12800
s_xor_b32 s30, s91, 1
s_lshl_b32 s64, s30, 2
s_add_u32 s64, s64, s24
s_mul_i32 s64, s64, 917504
s_mul_i32 s65, s30, 114688
s_add_u32 s65, s65, 106496
MM a[92:95],v[52:55],a[220:223]
s_waitcnt lgkmcnt(4)
MM a[80:83],v[56:59],a[224:227]
TR v[40:41],v10,16384
MM a[80:83],v[60:63],a[240:243]
s_mov_b32 s66, 8192
s_mov_b32 s68, -8192
s_mov_b32 s99, 2
MM a[84:87],v[56:59],a[228:231]
TR v[42:43],v10,16896
MM a[84:87],v[60:63],a[244:247]
s_cmp_lt_u32 s25, 4
s_cselect_b32 s67, 15, 13
MM a[88:91],v[56:59],a[232:235]
TR v[44:45],v10,20480
s_add_u32 s96, s72, 16384
s_add_u32 s97, s72, 32768
s_add_u32 s98, s72, 49152
MM a[88:91],v[60:63],a[248:251]
v_mov_b32 v30, s92
MM a[92:95],v[56:59],a[236:239]
TR v[46:47],v10,20992
MM a[92:95],v[60:63],a[252:255]
s_waitcnt lgkmcnt(4)
MM v[160:163],v[32:35],a[160:163]
TR v[48:49],v10,24576
MM v[160:163],v[36:39],a[176:179]
MM v[164:167],v[32:35],a[164:167]
TR v[50:51],v10,25088
MM v[164:167],v[36:39],a[180:183]
MM v[168:171],v[32:35],a[168:171]
TR v[52:53],v10,28672
MM v[168:171],v[36:39],a[184:187]
MM v[172:175],v[32:35],a[172:175]
TR v[54:55],v10,29184
global_load_dword v29, v30, s[22:23] sc1
s_add_u32 s84, s83, 32768
v_pk_mul_f32 v[20:21], v[128:129], s[86:87] op_sel:[0,1] op_sel_hi:[1,1]
v_pk_mul_f32 v[22:23], v[130:131], s[86:87] op_sel:[0,1] op_sel_hi:[1,1]
v_pk_mul_f32 v[24:25], v[144:145], s[86:87] op_sel:[0,1] op_sel_hi:[1,1]
v_pk_mul_f32 v[26:27], v[146:147], s[86:87] op_sel:[0,1] op_sel_hi:[1,1]
v_exp_f32 v20, v20
MM v[172:175],v[36:39],a[188:191]
s_waitcnt lgkmcnt(4)
v_accvgpr_read_b32 v112, a64
v_exp_f32 v21, v21
MM v[160:163],v[40:43],a[192:195]
TR v[56:57],v11,8192
v_accvgpr_read_b32 v113, a65
v_exp_f32 v22, v22
v_accvgpr_read_b32 v114, a66
MM v[160:163],v[44:47],a[208:211]
v_exp_f32 v23, v23
v_accvgpr_read_b32 v115, a67
MM v[164:167],v[40:43],a[196:199]
TR v[58:59],v11,8704
v_exp_f32 v24, v24
v_accvgpr_read_b32 v116, a80
v_exp_f32 v25, v25
MM v[164:167],v[44:47],a[212:215]
v_accvgpr_read_b32 v117, a81
v_exp_f32 v26, v26
MM v[168:171],v[40:43],a[200:203]
TR v[60:61],v11,12288
v_accvgpr_read_b32 v118, a82
v_exp_f32 v27, v27
v_accvgpr_read_b32 v119, a83
v_pk_mul_f32 v[128:129], v[128:129], v[112:113]
v_pk_mul_f32 v[130:131], v[130:131], v[114:115]
v_pk_mul_f32 v[144:145], v[144:145], v[116:117]
v_pk_mul_f32 v[146:147], v[146:147], v[118:119]
v_pk_add_f32 v[20:21], v[20:21], s[52:53]
v_pk_add_f32 v[22:23], v[22:23], s[52:53]
v_pk_add_f32 v[24:25], v[24:25], s[52:53]
v_pk_add_f32 v[26:27], v[26:27], s[52:53]
MM v[168:171],v[44:47],a[216:219]
v_rcp_f32 v20, v20
MM v[172:175],v[40:43],a[204:207]
TR v[62:63],v11,12800
v_rcp_f32 v21, v21
MM v[172:175],v[44:47],a[220:223]
s_waitcnt lgkmcnt(4)
v_rcp_f32 v22, v22
v_rcp_f32 v23, v23
MM v[160:163],v[48:51],a[224:227]
TR v[32:33],v11,16384
v_rcp_f32 v24, v24
MM v[160:163],v[52:55],a[240:243]
v_rcp_f32 v25, v25
MM v[164:167],v[48:51],a[228:231]
TR v[34:35],v11,16896
s_waitcnt vmcnt(1)
s_barrier
MM v[164:167],v[52:55],a[244:247]
v_mov_b32 v16, s89
s_cmp_lg_u32 s24, 0
s_cbranch_scc1 Ls12
v_mov_b32 v17, 1
s_mov_b64 exec, 1
global_atomic_add v16, v17, s[20:21] offset:0 sc1
s_mov_b64 exec, -1
Ls12:
MM v[168:171],v[48:51],a[232:235]
TR v[36:37],v11,20480
MM v[168:171],v[52:55],a[248:251]
MM v[172:175],v[48:51],a[236:239]
TR v[38:39],v11,20992
v_rcp_f32 v26, v26
v_rcp_f32 v27, v27
v_pk_mul_f32 v[128:129], v[128:129], v[20:21]
v_pk_mul_f32 v[130:131], v[130:131], v[22:23]
v_pk_mul_f32 v[144:145], v[144:145], v[24:25]
v_pk_mul_f32 v[146:147], v[146:147], v[26:27]
v_pk_mul_f32 v[20:21], v[132:133], s[86:87] op_sel:[0,1] op_sel_hi:[1,1]
v_pk_mul_f32 v[22:23], v[134:135], s[86:87] op_sel:[0,1] op_sel_hi:[1,1]
v_pk_mul_f32 v[24:25], v[148:149], s[86:87] op_sel:[0,1] op_sel_hi:[1,1]
v_pk_mul_f32 v[26:27], v[150:151], s[86:87] op_sel:[0,1] op_sel_hi:[1,1]
MM v[172:175],v[52:55],a[252:255]
s_waitcnt lgkmcnt(4)
v_cvt_pk_bf16_f32 v128, v128, v129
MM v[176:179],v[56:59],a[160:163]
TR v[40:41],v11,24576
v_cvt_pk_bf16_f32 v129, v130, v131
v_cvt_pk_bf16_f32 v130, v144, v145
s_add_u32 m0, s78, 0
s_nop 0
buffer_load_dwordx4 v28, s[32:35], s72 offen lds
MM v[176:179],v[60:63],a[176:179]
MM v[180:183],v[56:59],a[164:167]
TR v[42:43],v11,25088
v_cvt_pk_bf16_f32 v131, v146, v147
buffer_store_dwordx4 v[128:131], v2, s[56:59], s84 offen offset:0 sc0 sc1
v_exp_f32 v20, v20
MM v[180:183],v[60:63],a[180:183]
v_accvgpr_read_b32 v112, a68
v_exp_f32 v21, v21
MM v[184:187],v[56:59],a[168:171]
TR v[44:45],v11,28672
s_add_u32 m0, s78, 16384
s_nop 0
buffer_load_dwordx4 v28, s[44:47], s72 offen lds
MM v[184:187],v[60:63],a[184:187]
v_accvgpr_read_b32 v113, a69
v_exp_f32 v22, v22
MM v[188:191],v[56:59],a[172:175]
TR v[46:47],v11,29184
v_accvgpr_read_b32 v114, a70
v_exp_f32 v23, v23
MM v[188:191],v[60:63],a[188:191]
s_waitcnt lgkmcnt(4)
v_accvgpr_read_b32 v115, a71
s_add_u32 m0, s78, 1024
s_nop 0
buffer_load_dwordx4 v28, s[32:35], s96 offen lds
MM v[176:179],v[32:35],a[192:195]
TR v[48:49],v10,40960
v_exp_f32 v24, v24
MM v[176:179],v[36:39],a[208:211]
v_accvgpr_read_b32 v116, a84
v_exp_f32 v25, v25
v_accvgpr_read_b32 v117, a85
MM v[180:183],v[32:35],a[196:199]
TR v[50:51],v10,41472
v_exp_f32 v26, v26
v_accvgpr_read_b32 v118, a86
MM v[180:183],v[36:39],a[212:215]
s_add_u32 m0, s78, 17408
s_nop 0
buffer_load_dwordx4 v28, s[44:47], s96 offen lds
MM v[184:187],v[32:35],a[200:203]
TR v[52:53],v10,45056
v_exp_f32 v27, v27
v_accvgpr_read_b32 v119, a87
v_pk_mul_f32 v[132:133], v[132:133], v[112:113]
v_pk_mul_f32 v[134:135], v[134:135], v[114:115]
v_pk_mul_f32 v[148:149], v[148:149], v[116:117]
v_pk_mul_f32 v[150:151], v[150:151], v[118:119]
v_pk_add_f32 v[20:21], v[20:21], s[52:53]
v_pk_add_f32 v[22:23], v[22:23], s[52:53]
v_pk_add_f32 v[24:25], v[24:25], s[52:53]
v_pk_add_f32 v[26:27], v[26:27], s[52:53]
MM v[184:187],v[36:39],a[216:219]
v_rcp_f32 v20, v20
MM v[188:191],v[32:35],a[204:207]
TR v[54:55],v10,45568
v_rcp_f32 v21, v21
s_add_u32 m0, s78, 2048
s_nop 0
buffer_load_dwordx4 v28, s[32:35], s97 offen lds
MM v[188:191],v[36:39],a[220:223]
s_waitcnt lgkmcnt(4)
MM v[176:179],v[40:43],a[224:227]
TR v[56:57],v10,49152
v_rcp_f32 v22, v22
v_rcp_f32 v23, v23
MM v[176:179],v[44:47],a[240:243]
v_rcp_f32 v24, v24
MM v[180:183],v[40:43],a[228:231]
TR v[58:59],v10,49664
v_rcp_f32 v25, v25
MM v[180:183],v[44:47],a[244:247]
v_rcp_f32 v26, v26
MM v[184:187],v[40:43],a[232:235]
TR v[60:61],v10,53248
s_add_u32 m0, s78, 18432
s_nop 0
buffer_load_dwordx4 v28, s[44:47], s97 offen lds
MM v[184:187],v[44:47],a[248:251]
v_rcp_f32 v27, v27
v_pk_mul_f32 v[132:133], v[132:133], v[20:21]
v_pk_mul_f32 v[134:135], v[134:135], v[22:23]
v_pk_mul_f32 v[148:149], v[148:149], v[24:25]
v_pk_mul_f32 v[150:151], v[150:151], v[26:27]
v_pk_mul_f32 v[20:21], v[136:137], s[86:87] op_sel:[0,1] op_sel_hi:[1,1]
v_pk_mul_f32 v[22:23], v[138:139], s[86:87] op_sel:[0,1] op_sel_hi:[1,1]
v_pk_mul_f32 v[24:25], v[152:153], s[86:87] op_sel:[0,1] op_sel_hi:[1,1]
v_pk_mul_f32 v[26:27], v[154:155], s[86:87] op_sel:[0,1] op_sel_hi:[1,1]
MM v[188:191],v[40:43],a[236:239]
TR v[62:63],v10,53760
v_cvt_pk_bf16_f32 v132, v132, v133
v_cvt_pk_bf16_f32 v133, v134, v135
MM v[188:191],v[44:47],a[252:255]
s_waitcnt lgkmcnt(4)
v_cvt_pk_bf16_f32 v134, v148, v149
v_cvt_pk_bf16_f32 v135, v150, v151
s_add_u32 m0, s78, 3072
s_nop 0
buffer_load_dwordx4 v28, s[32:35], s98 offen lds
MM a[96:99],v[48:51],a[160:163]
TR v[32:33],v10,57344
MM a[96:99],v[52:55],a[176:179]
buffer_store_dwordx4 v[132:135], v2, s[56:59], s84 offen offset:1024 sc0 sc1
v_exp_f32 v20, v20
v_accvgpr_read_b32 v112, a72
MM a[100:103],v[48:51],a[164:167]
TR v[34:35],v10,57856
v_exp_f32 v21, v21
v_accvgpr_read_b32 v113, a73
MM a[100:103],v[52:55],a[180:183]
s_add_u32 m0, s78, 19456
s_nop 0
buffer_load_dwordx4 v28, s[44:47], s98 offen lds
MM a[104:107],v[48:51],a[168:171]
TR v[36:37],v10,61440
v_exp_f32 v22, v22
v_accvgpr_read_b32 v114, a74
MM a[104:107],v[52:55],a[184:187]
v_exp_f32 v23, v23
v_accvgpr_read_b32 v115, a75
MM a[108:111],v[48:51],a[172:175]
TR v[38:39],v10,61952
v_exp_f32 v24, v24
s_lshr_b64 s[48:49], s[48:49], 4
s_and_b32 s72, s48, 15
s_lshl_b32 s72, s72, 16
s_add_u32 s72, s72, s75
s_add_u32 s96, s72, 16384
s_add_u32 s97, s72, 32768
s_add_u32 s98, s72, 49152
MM a[108:111],v[52:55],a[188:191]
s_waitcnt lgkmcnt(4)
MM a[96:99],v[56:59],a[192:195]
TR v[40:41],v11,40960
v_accvgpr_read_b32 v116, a88
MM a[96:99],v[60:63],a[208:211]
v_exp_f32 v25, v25
v_accvgpr_read_b32 v117, a89
MM a[100:103],v[56:59],a[196:199]
TR v[42:43],v11,41472
v_exp_f32 v26, v26
v_accvgpr_read_b32 v118, a90
MM a[100:103],v[60:63],a[212:215]
v_exp_f32 v27, v27
s_add_u32 m0, s78, 32768
s_nop 0
buffer_load_dwordx4 v28, s[32:35], s72 offen lds
MM a[104:107],v[56:59],a[200:203]
TR v[44:45],v11,45056
v_accvgpr_read_b32 v119, a91
v_pk_mul_f32 v[136:137], v[136:137], v[112:113]
v_pk_mul_f32 v[138:139], v[138:139], v[114:115]
v_pk_mul_f32 v[152:153], v[152:153], v[116:117]
v_pk_mul_f32 v[154:155], v[154:155], v[118:119]
v_pk_add_f32 v[20:21], v[20:21], s[52:53]
v_pk_add_f32 v[22:23], v[22:23], s[52:53]
v_pk_add_f32 v[24:25], v[24:25], s[52:53]
v_pk_add_f32 v[26:27], v[26:27], s[52:53]
MM a[104:107],v[60:63],a[216:219]
v_rcp_f32 v20, v20
v_rcp_f32 v21, v21
MM a[108:111],v[56:59],a[204:207]
TR v[46:47],v11,45568
v_rcp_f32 v22, v22
MM a[108:111],v[60:63],a[220:223]
s_waitcnt lgkmcnt(4)
s_add_u32 m0, s78, 49152
s_nop 0
buffer_load_dwordx4 v28, s[44:47], s72 offen lds
MM a[96:99],v[32:35],a[224:227]
TR v[48:49],v11,49152
v_rcp_f32 v23, v23
MM a[96:99],v[36:39],a[240:243]
v_rcp_f32 v24, v24
MM a[100:103],v[32:35],a[228:231]
TR v[50:51],v11,49664
v_rcp_f32 v25, v25
MM a[100:103],v[36:39],a[244:247]
v_rcp_f32 v26, v26
MM a[104:107],v[32:35],a[232:235]
TR v[52:53],v11,53248
v_rcp_f32 v27, v27
s_add_u32 m0, s78, 33792
s_nop 0
buffer_load_dwordx4 v28, s[32:35], s96 offen lds
v_pk_mul_f32 v[136:137], v[136:137], v[20:21]
v_pk_mul_f32 v[138:139], v[138:139], v[22:23]
v_pk_mul_f32 v[152:153], v[152:153], v[24:25]
v_pk_mul_f32 v[154:155], v[154:155], v[26:27]
v_pk_mul_f32 v[20:21], v[140:141], s[86:87] op_sel:[0,1] op_sel_hi:[1,1]
v_pk_mul_f32 v[22:23], v[142:143], s[86:87] op_sel:[0,1] op_sel_hi:[1,1]
v_pk_mul_f32 v[24:25], v[156:157], s[86:87] op_sel:[0,1] op_sel_hi:[1,1]
v_pk_mul_f32 v[26:27], v[158:159], s[86:87] op_sel:[0,1] op_sel_hi:[1,1]
MM a[104:107],v[36:39],a[248:251]
MM a[108:111],v[32:35],a[236:239]
TR v[54:55],v11,53760
v_cvt_pk_bf16_f32 v136, v136, v137
v_cvt_pk_bf16_f32 v137, v138, v139
v_cvt_pk_bf16_f32 v138, v152, v153
MM a[108:111],v[36:39],a[252:255]
s_waitcnt lgkmcnt(4)
v_cvt_pk_bf16_f32 v139, v154, v155
buffer_store_dwordx4 v[136:139], v3, s[56:59], s84 offen offset:0 sc0 sc1
MM a[112:115],v[40:43],a[160:163]
TR v[56:57],v11,57344
s_add_u32 m0, s78, 50176
s_nop 0
buffer_load_dwordx4 v28, s[44:47], s96 offen lds
MM a[112:115],v[44:47],a[176:179]
v_exp_f32 v20, v20
v_accvgpr_read_b32 v112, a76
MM a[116:119],v[40:43],a[164:167]
TR v[58:59],v11,57856
v_exp_f32 v21, v21
v_accvgpr_read_b32 v113, a77
MM a[116:119],v[44:47],a[180:183]
v_exp_f32 v22, v22
s_add_u32 m0, s78, 34816
s_nop 0
buffer_load_dwordx4 v28, s[32:35], s97 offen lds
MM a[120:123],v[40:43],a[168:171]
TR v[60:61],v11,61440
v_accvgpr_read_b32 v114, a78
MM a[120:123],v[44:47],a[184:187]
v_exp_f32 v23, v23
v_accvgpr_read_b32 v115, a79
v_exp_f32 v24, v24
MM a[124:127],v[40:43],a[172:175]
TR v[62:63],v11,61952
v_accvgpr_read_b32 v116, a92
s_add_u32 m0, s78, 51200
s_nop 0
buffer_load_dwordx4 v28, s[44:47], s97 offen lds
MM a[124:127],v[44:47],a[188:191]
s_waitcnt lgkmcnt(4)
v_exp_f32 v25, v25
MM a[112:115],v[48:51],a[192:195]
TR v[32:33],v12,8192
v_accvgpr_read_b32 v117, a93
v_exp_f32 v26, v26
MM a[112:115],v[52:55],a[208:211]
v_accvgpr_read_b32 v118, a94
v_exp_f32 v27, v27
MM a[116:119],v[48:51],a[196:199]
TR v[34:35],v12,8448
v_accvgpr_read_b32 v119, a95
s_add_u32 m0, s78, 35840
s_nop 0
buffer_load_dwordx4 v28, s[32:35], s98 offen lds
v_pk_mul_f32 v[140:141], v[140:141], v[112:113]
v_pk_mul_f32 v[142:143], v[142:143], v[114:115]
v_pk_mul_f32 v[156:157], v[156:157], v[116:117]
v_pk_mul_f32 v[158:159], v[158:159], v[118:119]
v_pk_add_f32 v[20:21], v[20:21], s[52:53]
v_pk_add_f32 v[22:23], v[22:23], s[52:53]
v_pk_add_f32 v[24:25], v[24:25], s[52:53]
v_pk_add_f32 v[26:27], v[26:27], s[52:53]
MM a[116:119],v[52:55],a[212:215]
v_rcp_f32 v20, v20
MM a[120:123],v[48:51],a[200:203]
TR v[36:37],v12,10240
v_rcp_f32 v21, v21
MM a[120:123],v[52:55],a[216:219]
v_rcp_f32 v22, v22
MM a[124:127],v[48:51],a[204:207]
TR v[38:39],v12,10496
v_rcp_f32 v23, v23
s_add_u32 m0, s78, 52224
s_nop 0
buffer_load_dwordx4 v28, s[44:47], s98 offen lds
MM a[124:127],v[52:55],a[220:223]
s_waitcnt lgkmcnt(4)
MM a[112:115],v[56:59],a[224:227]
TR v[40:41],v12,16384
v_rcp_f32 v24, v24
MM a[112:115],v[60:63],a[240:243]
v_rcp_f32 v25, v25
v_rcp_f32 v26, v26
MM a[116:119],v[56:59],a[228:231]
TR v[42:43],v12,16640
v_rcp_f32 v27, v27
v_pk_mul_f32 v[140:141], v[140:141], v[20:21]
v_pk_mul_f32 v[142:143], v[142:143], v[22:23]
v_pk_mul_f32 v[156:157], v[156:157], v[24:25]
v_pk_mul_f32 v[158:159], v[158:159], v[26:27]
MM a[116:119],v[60:63],a[244:247]
s_lshr_b64 s[48:49], s[48:49], 4
s_and_b32 s72, s48, 15
s_lshl_b32 s72, s72, 16
s_add_u32 s72, s72, s75
s_add_u32 s96, s72, 16384
s_add_u32 s97, s72, 32768
s_add_u32 s98, s72, 49152
MM a[120:123],v[56:59],a[232:235]
TR v[44:45],v12,18432
MM a[120:123],v[60:63],a[248:251]
v_cvt_pk_bf16_f32 v140, v140, v141
MM a[124:127],v[56:59],a[236:239]
TR v[46:47],v12,18688
v_cvt_pk_bf16_f32 v141, v142, v143
v_cvt_pk_bf16_f32 v142, v156, v157
MM a[124:127],v[60:63],a[252:255]
s_waitcnt lgkmcnt(4)
v_cvt_pk_bf16_f32 v143, v158, v159
buffer_store_dwordx4 v[140:143], v3, s[56:59], s84 offen offset:1024 sc0 sc1
MM v[192:195],v[32:35],a[160:163]
TR v[48:49],v12,24576
MM v[192:195],v[36:39],a[176:179]
MM v[196:199],v[32:35],a[164:167]
TR v[50:51],v12,24832
MM v[196:199],v[36:39],a[180:183]
MM v[200:203],v[32:35],a[168:171]
TR v[52:53],v12,26624
MM v[200:203],v[36:39],a[184:187]
MM v[204:207],v[32:35],a[172:175]
TR v[54:55],v12,26880
s_add_u32 s84, s83, 49152
v_pk_mul_f32 v[20:21], v[160:161], s[86:87] op_sel:[0,1] op_sel_hi:[1,1]
v_pk_mul_f32 v[22:23], v[162:163], s[86:87] op_sel:[0,1] op_sel_hi:[1,1]
v_pk_mul_f32 v[24:25], v[176:177], s[86:87] op_sel:[0,1] op_sel_hi:[1,1]
v_pk_mul_f32 v[26:27], v[178:179], s[86:87] op_sel:[0,1] op_sel_hi:[1,1]
v_exp_f32 v20, v20
v_accvgpr_read_b32 v112, a96
MM v[204:207],v[36:39],a[188:191]
s_waitcnt lgkmcnt(4)
v_exp_f32 v21, v21
v_accvgpr_read_b32 v113, a97
MM v[192:195],v[40:43],a[192:195]
TR v[56:57],v13,8192
s_waitcnt vmcnt(20)
v_exp_f32 v22, v22
MM v[192:195],v[44:47],a[208:211]
v_accvgpr_read_b32 v114, a98
v_exp_f32 v23, v23
MM v[196:199],v[40:43],a[196:199]
TR v[58:59],v13,8448
v_accvgpr_read_b32 v115, a99
v_exp_f32 v24, v24
MM v[196:199],v[44:47],a[212:215]
v_readfirstlane_b32 s30, v29
s_nop 0
s_cmp_ge_u32 s30, 16
s_cbranch_scc1 Ld14
s_mov_b32 s31, 262144
Lp13:
global_load_dword v29, v30, s[22:23] offset:0 sc1
s_waitcnt vmcnt(0)
v_readfirstlane_b32 s30, v29
s_nop 0
s_cmp_ge_u32 s30, 16
s_cbranch_scc1 Ld14
s_sleep 4
s_sub_u32 s31, s31, 1
s_cmp_lg_u32 s31, 0
s_cbranch_scc1 Lp13
Ld14:
MM v[200:203],v[40:43],a[200:203]
TR v[60:61],v13,10240
MM v[200:203],v[44:47],a[216:219]
v_accvgpr_read_b32 v116, a112
MM v[204:207],v[40:43],a[204:207]
TR v[62:63],v13,10496
v_exp_f32 v25, v25
v_accvgpr_read_b32 v117, a113
MM v[204:207],v[44:47],a[220:223]
s_waitcnt lgkmcnt(4)
v_exp_f32 v26, v26
v_accvgpr_read_b32 v118, a114
MM v[192:195],v[48:51],a[224:227]
TR v[32:33],v13,16384
v_exp_f32 v27, v27
buffer_load_dwordx4 a[0:3], v2, s[36:39], s73 offen offset:0 sc1
MM v[192:195],v[52:55],a[240:243]
v_accvgpr_read_b32 v119, a115
v_pk_mul_f32 v[160:161], v[160:161], v[112:113]
v_pk_mul_f32 v[162:163], v[162:163], v[114:115]
v_pk_mul_f32 v[176:177], v[176:177], v[116:117]
v_pk_mul_f32 v[178:179], v[178:179], v[118:119]
v_pk_add_f32 v[20:21], v[20:21], s[52:53]
v_pk_add_f32 v[22:23], v[22:23], s[52:53]
v_pk_add_f32 v[24:25], v[24:25], s[52:53]
v_pk_add_f32 v[26:27], v[26:27], s[52:53]
v_rcp_f32 v20, v20
MM v[196:199],v[48:51],a[228:231]
TR v[34:35],v13,16640
v_rcp_f32 v21, v21
MM v[196:199],v[52:55],a[244:247]
v_rcp_f32 v22, v22
MM v[200:203],v[48:51],a[232:235]
TR v[36:37],v13,18432
buffer_load_dwordx4 a[4:7], v2, s[36:39], s73 offen offset:1024 sc1
MM v[200:203],v[52:55],a[248:251]
v_rcp_f32 v23, v23
MM v[204:207],v[48:51],a[236:239]
TR v[38:39],v13,18688
v_rcp_f32 v24, v24
MM v[204:207],v[52:55],a[252:255]
s_waitcnt lgkmcnt(4)
v_rcp_f32 v25, v25
MM v[208:211],v[56:59],a[160:163]
TR v[40:41],v13,24576
v_rcp_f32 v26, v26
MM v[208:211],v[60:63],a[176:179]
v_rcp_f32 v27, v27
v_pk_mul_f32 v[160:161], v[160:161], v[20:21]
v_pk_mul_f32 v[162:163], v[162:163], v[22:23]
v_pk_mul_f32 v[176:177], v[176:177], v[24:25]
v_pk_mul_f32 v[178:179], v[178:179], v[26:27]
v_pk_mul_f32 v[20:21], v[164:165], s[86:87] op_sel:[0,1] op_sel_hi:[1,1]
v_pk_mul_f32 v[22:23], v[166:167], s[86:87] op_sel:[0,1] op_sel_hi:[1,1]
v_pk_mul_f32 v[24:25], v[180:181], s[86:87] op_sel:[0,1] op_sel_hi:[1,1]
v_pk_mul_f32 v[26:27], v[182:183], s[86:87] op_sel:[0,1] op_sel_hi:[1,1]
MM v[212:215],v[56:59],a[164:167]
TR v[42:43],v13,24832
buffer_load_dwordx4 a[8:11], v2, s[36:39], s73 offen offset:2048 sc1
v_cvt_pk_bf16_f32 v160, v160, v161
MM v[212:215],v[60:63],a[180:183]
v_cvt_pk_bf16_f32 v161, v162, v163
v_cvt_pk_bf16_f32 v162, v176, v177
MM v[216:219],v[56:59],a[168:171]
TR v[44:45],v13,26624
v_cvt_pk_bf16_f32 v163, v178, v179
buffer_store_dwordx4 v[160:163], v2, s[56:59], s84 offen offset:0 sc0 sc1
MM v[216:219],v[60:63],a[184:187]
buffer_load_dwordx4 a[12:15], v2, s[36:39], s73 offen offset:3072 sc1
v_exp_f32 v20, v20
MM v[220:223],v[56:59],a[172:175]
TR v[46:47],v13,26880
v_accvgpr_read_b32 v112, a100
v_exp_f32 v21, v21
MM v[220:223],v[60:63],a[188:191]
s_waitcnt lgkmcnt(4)
v_accvgpr_read_b32 v113, a101
v_exp_f32 v22, v22
MM v[208:211],v[32:35],a[192:195]
TR v[48:49],v12,12288
v_accvgpr_read_b32 v114, a102
buffer_load_dwordx4 a[16:19], v2, s[36:39], s76 offen offset:0 sc1
MM v[208:211],v[36:39],a[208:211]
v_exp_f32 v23, v23
v_accvgpr_read_b32 v115, a103
MM v[212:215],v[32:35],a[196:199]
TR v[50:51],v12,12544
v_exp_f32 v24, v24
v_accvgpr_read_b32 v116, a116
MM v[212:215],v[36:39],a[212:215]
v_exp_f32 v25, v25
buffer_load_dwordx4 a[20:23], v2, s[36:39], s76 offen offset:1024 sc1
MM v[216:219],v[32:35],a[200:203]
TR v[52:53],v12,14336
v_accvgpr_read_b32 v117, a117
v_exp_f32 v26, v26
v_accvgpr_read_b32 v118, a118
MM v[216:219],v[36:39],a[216:219]
v_exp_f32 v27, v27
v_accvgpr_read_b32 v119, a119
v_pk_mul_f32 v[164:165], v[164:165], v[112:113]
v_pk_mul_f32 v[166:167], v[166:167], v[114:115]
v_pk_mul_f32 v[180:181], v[180:181], v[116:117]
v_pk_mul_f32 v[182:183], v[182:183], v[118:119]
v_pk_add_f32 v[20:21], v[20:21], s[52:53]
v_pk_add_f32 v[22:23], v[22:23], s[52:53]
v_pk_add_f32 v[24:25], v[24:25], s[52:53]
v_pk_add_f32 v[26:27], v[26:27], s[52:53]
MM v[220:223],v[32:35],a[204:207]
TR v[54:55],v12,14592
buffer_load_dwordx4 a[24:27], v2, s[36:39], s76 offen offset:2048 sc1
v_rcp_f32 v20, v20
MM v[220:223],v[36:39],a[220:223]
s_waitcnt lgkmcnt(4)
v_rcp_f32 v21, v21
MM v[208:211],v[40:43],a[224:227]
TR v[56:57],v12,20480
v_rcp_f32 v22, v22
MM v[208:211],v[44:47],a[240:243]
v_rcp_f32 v23, v23
MM v[212:215],v[40:43],a[228:231]
TR v[58:59],v12,20736
v_rcp_f32 v24, v24
MM v[212:215],v[44:47],a[244:247]
buffer_load_dwordx4 a[28:31], v2, s[36:39], s76 offen offset:3072 sc1
MM v[216:219],v[40:43],a[232:235]
TR v[60:61],v12,22528
v_rcp_f32 v25, v25
MM v[216:219],v[44:47],a[248:251]
v_rcp_f32 v26, v26
MM v[220:223],v[40:43],a[236:239]
TR v[62:63],v12,22784
v_rcp_f32 v27, v27
v_pk_mul_f32 v[164:165], v[164:165], v[20:21]
v_pk_mul_f32 v[166:167], v[166:167], v[22:23]
v_pk_mul_f32 v[180:181], v[180:181], v[24:25]
v_pk_mul_f32 v[182:183], v[182:183], v[26:27]
v_pk_mul_f32 v[20:21], v[168:169], s[86:87] op_sel:[0,1] op_sel_hi:[1,1]
v_pk_mul_f32 v[22:23], v[170:171], s[86:87] op_sel:[0,1] op_sel_hi:[1,1]
v_pk_mul_f32 v[24:25], v[184:185], s[86:87] op_sel:[0,1] op_sel_hi:[1,1]
v_pk_mul_f32 v[26:27], v[186:187], s[86:87] op_sel:[0,1] op_sel_hi:[1,1]
MM v[220:223],v[44:47],a[252:255]
s_waitcnt lgkmcnt(4)
v_cvt_pk_bf16_f32 v164, v164, v165
v_cvt_pk_bf16_f32 v165, v166, v167
MM v[224:227],v[48:51],a[160:163]
TR v[32:33],v12,28672
v_cvt_pk_bf16_f32 v166, v180, v181
v_cvt_pk_bf16_f32 v167, v182, v183
MM v[224:227],v[52:55],a[176:179]
s_waitcnt vmcnt(9)
s_barrier
MM v[228:231],v[48:51],a[164:167]
TR v[34:35],v12,28928
s_cmp_lg_u32 s24, 0
s_cbranch_scc1 Ls15
v_mov_b32 v31, 1
s_mov_b64 exec, 1
global_atomic_add v30, v31, s[22:23] offset:768 sc1
s_mov_b64 exec, -1
Ls15:
MM v[228:231],v[52:55],a[180:183]
MM v[232:235],v[48:51],a[168:171]
TR v[36:37],v12,30720
MM v[232:235],v[52:55],a[184:187]
buffer_store_dwordx4 v[164:167], v2, s[56:59], s84 offen offset:1024 sc0 sc1
s_add_u32 s73, s73, 8192
s_add_u32 s76, s76, 8192
MM v[236:239],v[48:51],a[172:175]
TR v[38:39],v12,30976
v_exp_f32 v20, v20
MM v[236:239],v[52:55],a[188:191]
s_waitcnt lgkmcnt(4)
v_accvgpr_read_b32 v112, a104
v_exp_f32 v21, v21
MM v[224:227],v[56:59],a[192:195]
TR v[40:41],v13,12288
v_accvgpr_read_b32 v113, a105
v_exp_f32 v22, v22
MM v[224:227],v[60:63],a[208:211]
v_accvgpr_read_b32 v114, a106
buffer_load_dwordx4 a[32:35], v2, s[36:39], s73 offen offset:0 sc1
MM v[228:231],v[56:59],a[196:199]
TR v[42:43],v13,12544
v_exp_f32 v23, v23
v_accvgpr_read_b32 v115, a107
MM v[228:231],v[60:63],a[212:215]
v_exp_f32 v24, v24
v_accvgpr_read_b32 v116, a120
MM v[232:235],v[56:59],a[200:203]
TR v[44:45],v13,14336
v_exp_f32 v25, v25
buffer_load_dwordx4 a[36:39], v2, s[36:39], s73 offen offset:1024 sc1
MM v[232:235],v[60:63],a[216:219]
v_accvgpr_read_b32 v117, a121
v_exp_f32 v26, v26
MM v[236:239],v[56:59],a[204:207]
TR v[46:47],v13,14592
v_accvgpr_read_b32 v118, a122
v_exp_f32 v27, v27
MM v[236:239],v[60:63],a[220:223]
s_waitcnt lgkmcnt(4)
v_accvgpr_read_b32 v119, a123
v_pk_mul_f32 v[168:169], v[168:169], v[112:113]
v_pk_mul_f32 v[170:171], v[170:171], v[114:115]
v_pk_mul_f32 v[184:185], v[184:185], v[116:117]
v_pk_mul_f32 v[186:187], v[186:187], v[118:119]
v_pk_add_f32 v[20:21], v[20:21], s[52:53]
v_pk_add_f32 v[22:23], v[22:23], s[52:53]
v_pk_add_f32 v[24:25], v[24:25], s[52:53]
v_pk_add_f32 v[26:27], v[26:27], s[52:53]
buffer_load_dwordx4 a[40:43], v2, s[36:39], s73 offen offset:2048 sc1
MM v[224:227],v[32:35],a[224:227]
TR v[48:49],v13,20480
v_rcp_f32 v20, v20
MM v[224:227],v[36:39],a[240:243]
v_rcp_f32 v21, v21
MM v[228:231],v[32:35],a[228:231]
TR v[50:51],v13,20736
v_rcp_f32 v22, v22
v_rcp_f32 v23, v23
MM v[228:231],v[36:39],a[244:247]
v_rcp_f32 v24, v24
MM v[232:235],v[32:35],a[232:235]
TR v[52:53],v13,22528
buffer_load_dwordx4 a[44:47], v2, s[36:39], s73 offen offset:3072 sc1
MM v[232:235],v[36:39],a[248:251]
v_rcp_f32 v25, v25
MM v[236:239],v[32:35],a[236:239]
TR v[54:55],v13,22784
v_rcp_f32 v26, v26
MM v[236:239],v[36:39],a[252:255]
s_waitcnt lgkmcnt(4)
v_rcp_f32 v27, v27
v_pk_mul_f32 v[168:169], v[168:169], v[20:21]
v_pk_mul_f32 v[170:171], v[170:171], v[22:23]
v_pk_mul_f32 v[184:185], v[184:185], v[24:25]
v_pk_mul_f32 v[186:187], v[186:187], v[26:27]
v_pk_mul_f32 v[20:21], v[172:173], s[86:87] op_sel:[0,1] op_sel_hi:[1,1]
v_pk_mul_f32 v[22:23], v[174:175], s[86:87] op_sel:[0,1] op_sel_hi:[1,1]
v_pk_mul_f32 v[24:25], v[188:189], s[86:87] op_sel:[0,1] op_sel_hi:[1,1]
v_pk_mul_f32 v[26:27], v[190:191], s[86:87] op_sel:[0,1] op_sel_hi:[1,1]
MM v[240:243],v[40:43],a[160:163]
TR v[56:57],v13,28672
v_cvt_pk_bf16_f32 v168, v168, v169
v_cvt_pk_bf16_f32 v169, v170, v171
MM v[240:243],v[44:47],a[176:179]
buffer_load_dwordx4 a[48:51], v2, s[36:39], s76 offen offset:0 sc1
v_cvt_pk_bf16_f32 v170, v184, v185
MM v[244:247],v[40:43],a[164:167]
TR v[58:59],v13,28928
v_cvt_pk_bf16_f32 v171, v186, v187
buffer_store_dwordx4 v[168:171], v3, s[56:59], s84 offen offset:0 sc0 sc1
MM v[244:247],v[44:47],a[180:183]
v_exp_f32 v20, v20
v_accvgpr_read_b32 v112, a108
MM v[248:251],v[40:43],a[168:171]
TR v[60:61],v13,30720
buffer_load_dwordx4 a[52:55], v2, s[36:39], s76 offen offset:1024 sc1
v_exp_f32 v21, v21
MM v[248:251],v[44:47],a[184:187]
v_accvgpr_read_b32 v113, a109
v_exp_f32 v22, v22
MM v[252:255],v[40:43],a[172:175]
TR v[62:63],v13,30976
v_accvgpr_read_b32 v114, a110
v_exp_f32 v23, v23
MM v[252:255],v[44:47],a[188:191]
s_waitcnt lgkmcnt(4)
v_accvgpr_read_b32 v115, a111
buffer_load_dwordx4 a[56:59], v2, s[36:39], s76 offen offset:2048 sc1
MM v[240:243],v[48:51],a[192:195]
v_exp_f32 v24, v24
v_accvgpr_read_b32 v116, a124
MM v[240:243],v[52:55],a[208:211]
v_exp_f32 v25, v25
v_accvgpr_read_b32 v117, a125
MM v[244:247],v[48:51],a[196:199]
v_exp_f32 v26, v26
buffer_load_dwordx4 a[60:63], v2, s[36:39], s76 offen offset:3072 sc1
MM v[244:247],v[52:55],a[212:215]
v_accvgpr_read_b32 v118, a126
v_exp_f32 v27, v27
MM v[248:251],v[48:51],a[200:203]
v_accvgpr_read_b32 v119, a127
v_pk_mul_f32 v[172:173], v[172:173], v[112:113]
v_pk_mul_f32 v[174:175], v[174:175], v[114:115]
v_pk_mul_f32 v[188:189], v[188:189], v[116:117]
v_pk_mul_f32 v[190:191], v[190:191], v[118:119]
v_pk_add_f32 v[20:21], v[20:21], s[52:53]
v_pk_add_f32 v[22:23], v[22:23], s[52:53]
v_pk_add_f32 v[24:25], v[24:25], s[52:53]
v_pk_add_f32 v[26:27], v[26:27], s[52:53]
v_rcp_f32 v20, v20
MM v[248:251],v[52:55],a[216:219]
s_add_u32 s73, s73, 8192
s_add_u32 s76, s76, 8192
MM v[252:255],v[48:51],a[204:207]
v_rcp_f32 v21, v21
MM v[252:255],v[52:55],a[220:223]
s_waitcnt lgkmcnt(0)
v_rcp_f32 v22, v22
MM v[240:243],v[56:59],a[224:227]
v_rcp_f32 v23, v23
MM v[240:243],v[60:63],a[240:243]
v_rcp_f32 v24, v24
MM v[244:247],v[56:59],a[228:231]
v_rcp_f32 v25, v25
MM v[244:247],v[60:63],a[244:247]
v_rcp_f32 v26, v26
MM v[248:251],v[56:59],a[232:235]
v_rcp_f32 v27, v27
v_pk_mul_f32 v[172:173], v[172:173], v[20:21]
v_pk_mul_f32 v[174:175], v[174:175], v[22:23]
v_pk_mul_f32 v[188:189], v[188:189], v[24:25]
v_pk_mul_f32 v[190:191], v[190:191], v[26:27]
MM v[248:251],v[60:63],a[248:251]
v_cvt_pk_bf16_f32 v172, v172, v173
MM v[252:255],v[56:59],a[236:239]
v_cvt_pk_bf16_f32 v173, v174, v175
v_cvt_pk_bf16_f32 v174, v188, v189
MM v[252:255],v[60:63],a[252:255]
v_cvt_pk_bf16_f32 v175, v190, v191
buffer_store_dwordx4 v[172:175], v3, s[56:59], s84 offen offset:1024 sc0 sc1
global_load_dword v29, v30, s[22:23] offset:1024 sc1
s_add_u32 s84, s83, 65536
v_mov_b32 v36, s87
v_mov_b32 v37, s87
v_mov_b32 v38, 1.0
v_mov_b32 v39, 1.0
v_pk_mul_f32 v[20:21], v[192:193], v[36:37]
v_pk_mul_f32 v[22:23], v[194:195], v[36:37]
v_exp_f32 v20, v20
v_exp_f32 v21, v21
v_exp_f32 v22, v22
v_exp_f32 v23, v23
v_pk_mul_f32 v[192:193], v[192:193], v[224:225]
v_pk_mul_f32 v[194:195], v[194:195], v[226:227]
v_pk_add_f32 v[20:21], v[20:21], v[38:39]
v_pk_add_f32 v[22:23], v[22:23], v[38:39]
v_rcp_f32 v20, v20
v_rcp_f32 v21, v21
v_rcp_f32 v22, v22
v_rcp_f32 v23, v23
v_pk_mul_f32 v[192:193], v[192:193], v[20:21]
v_pk_mul_f32 v[194:195], v[194:195], v[22:23]
v_cvt_pk_bf16_f32 v192, v192, v193
v_cvt_pk_bf16_f32 v193, v194, v195
v_pk_mul_f32 v[20:21], v[208:209], v[36:37]
v_pk_mul_f32 v[22:23], v[210:211], v[36:37]
v_exp_f32 v20, v20
v_exp_f32 v21, v21
v_exp_f32 v22, v22
v_exp_f32 v23, v23
v_pk_mul_f32 v[208:209], v[208:209], v[240:241]
v_pk_mul_f32 v[210:211], v[210:211], v[242:243]
v_pk_add_f32 v[20:21], v[20:21], v[38:39]
v_pk_add_f32 v[22:23], v[22:23], v[38:39]
v_rcp_f32 v20, v20
v_rcp_f32 v21, v21
v_rcp_f32 v22, v22
v_rcp_f32 v23, v23
v_pk_mul_f32 v[208:209], v[208:209], v[20:21]
v_pk_mul_f32 v[210:211], v[210:211], v[22:23]
v_cvt_pk_bf16_f32 v194, v208, v209
v_cvt_pk_bf16_f32 v195, v210, v211
buffer_store_dwordx4 v[192:195], v2, s[56:59], s84 offen offset:0 sc0 sc1
v_pk_mul_f32 v[20:21], v[196:197], v[36:37]
v_pk_mul_f32 v[22:23], v[198:199], v[36:37]
v_exp_f32 v20, v20
v_exp_f32 v21, v21
v_exp_f32 v22, v22
v_exp_f32 v23, v23
v_pk_mul_f32 v[196:197], v[196:197], v[228:229]
v_pk_mul_f32 v[198:199], v[198:199], v[230:231]
v_pk_add_f32 v[20:21], v[20:21], v[38:39]
v_pk_add_f32 v[22:23], v[22:23], v[38:39]
v_rcp_f32 v20, v20
v_rcp_f32 v21, v21
v_rcp_f32 v22, v22
v_rcp_f32 v23, v23
v_pk_mul_f32 v[196:197], v[196:197], v[20:21]
v_pk_mul_f32 v[198:199], v[198:199], v[22:23]
v_cvt_pk_bf16_f32 v196, v196, v197
v_cvt_pk_bf16_f32 v197, v198, v199
v_pk_mul_f32 v[20:21], v[212:213], v[36:37]
v_pk_mul_f32 v[22:23], v[214:215], v[36:37]
v_exp_f32 v20, v20
v_exp_f32 v21, v21
v_exp_f32 v22, v22
v_exp_f32 v23, v23
v_pk_mul_f32 v[212:213], v[212:213], v[244:245]
v_pk_mul_f32 v[214:215], v[214:215], v[246:247]
v_pk_add_f32 v[20:21], v[20:21], v[38:39]
v_pk_add_f32 v[22:23], v[22:23], v[38:39]
v_rcp_f32 v20, v20
v_rcp_f32 v21, v21
v_rcp_f32 v22, v22
v_rcp_f32 v23, v23
v_pk_mul_f32 v[212:213], v[212:213], v[20:21]
v_pk_mul_f32 v[214:215], v[214:215], v[22:23]
v_cvt_pk_bf16_f32 v198, v212, v213
v_cvt_pk_bf16_f32 v199, v214, v215
buffer_store_dwordx4 v[196:199], v2, s[56:59], s84 offen offset:1024 sc0 sc1
v_pk_mul_f32 v[20:21], v[200:201], v[36:37]
v_pk_mul_f32 v[22:23], v[202:203], v[36:37]
v_exp_f32 v20, v20
v_exp_f32 v21, v21
v_exp_f32 v22, v22
v_exp_f32 v23, v23
v_pk_mul_f32 v[200:201], v[200:201], v[232:233]
v_pk_mul_f32 v[202:203], v[202:203], v[234:235]
v_pk_add_f32 v[20:21], v[20:21], v[38:39]
v_pk_add_f32 v[22:23], v[22:23], v[38:39]
v_rcp_f32 v20, v20
v_rcp_f32 v21, v21
v_rcp_f32 v22, v22
v_rcp_f32 v23, v23
v_pk_mul_f32 v[200:201], v[200:201], v[20:21]
v_pk_mul_f32 v[202:203], v[202:203], v[22:23]
v_cvt_pk_bf16_f32 v200, v200, v201
v_cvt_pk_bf16_f32 v201, v202, v203
v_pk_mul_f32 v[20:21], v[216:217], v[36:37]
v_pk_mul_f32 v[22:23], v[218:219], v[36:37]
v_exp_f32 v20, v20
v_exp_f32 v21, v21
v_exp_f32 v22, v22
v_exp_f32 v23, v23
v_pk_mul_f32 v[216:217], v[216:217], v[248:249]
v_pk_mul_f32 v[218:219], v[218:219], v[250:251]
v_pk_add_f32 v[20:21], v[20:21], v[38:39]
v_pk_add_f32 v[22:23], v[22:23], v[38:39]
v_rcp_f32 v20, v20
v_rcp_f32 v21, v21
v_rcp_f32 v22, v22
v_rcp_f32 v23, v23
v_pk_mul_f32 v[216:217], v[216:217], v[20:21]
v_pk_mul_f32 v[218:219], v[218:219], v[22:23]
v_cvt_pk_bf16_f32 v202, v216, v217
v_cvt_pk_bf16_f32 v203, v218, v219
buffer_store_dwordx4 v[200:203], v3, s[56:59], s84 offen offset:0 sc0 sc1
v_pk_mul_f32 v[20:21], v[204:205], v[36:37]
v_pk_mul_f32 v[22:23], v[206:207], v[36:37]
v_exp_f32 v20, v20
v_exp_f32 v21, v21
v_exp_f32 v22, v22
v_exp_f32 v23, v23
v_pk_mul_f32 v[204:205], v[204:205], v[236:237]
v_pk_mul_f32 v[206:207], v[206:207], v[238:239]
v_pk_add_f32 v[20:21], v[20:21], v[38:39]
v_pk_add_f32 v[22:23], v[22:23], v[38:39]
v_rcp_f32 v20, v20
v_rcp_f32 v21, v21
v_rcp_f32 v22, v22
v_rcp_f32 v23, v23
v_pk_mul_f32 v[204:205], v[204:205], v[20:21]
v_pk_mul_f32 v[206:207], v[206:207], v[22:23]
v_cvt_pk_bf16_f32 v204, v204, v205
v_cvt_pk_bf16_f32 v205, v206, v207
v_pk_mul_f32 v[20:21], v[220:221], v[36:37]
v_pk_mul_f32 v[22:23], v[222:223], v[36:37]
v_exp_f32 v20, v20
v_exp_f32 v21, v21
v_exp_f32 v22, v22
v_exp_f32 v23, v23
v_pk_mul_f32 v[220:221], v[220:221], v[252:253]
v_pk_mul_f32 v[222:223], v[222:223], v[254:255]
v_pk_add_f32 v[20:21], v[20:21], v[38:39]
v_pk_add_f32 v[22:23], v[22:23], v[38:39]
v_rcp_f32 v20, v20
v_rcp_f32 v21, v21
v_rcp_f32 v22, v22
v_rcp_f32 v23, v23
v_pk_mul_f32 v[220:221], v[220:221], v[20:21]
v_pk_mul_f32 v[222:223], v[222:223], v[22:23]
v_cvt_pk_bf16_f32 v206, v220, v221
v_cvt_pk_bf16_f32 v207, v222, v223
buffer_store_dwordx4 v[204:207], v3, s[56:59], s84 offen offset:1024 sc0 sc1
v_lshrrev_b32 v12, 2, v1
v_bfe_u32 v13, v1, 3, 2
v_and_b32 v14, 3, v1
v_xor_b32 v15, 0, v13
v_lshlrev_b32 v15, 5, v15
v_lshl_add_u32 v15, v12, 7, v15
v_lshl_add_u32 v4, v14, 3, v15
v_add_u32 v8, 0x10000, v4
v_xor_b32 v15, 1, v13
v_lshlrev_b32 v15, 5, v15
v_lshl_add_u32 v15, v12, 7, v15
v_lshl_add_u32 v5, v14, 3, v15
v_add_u32 v9, 0x10000, v5
v_xor_b32 v15, 2, v13
v_lshlrev_b32 v15, 5, v15
v_lshl_add_u32 v15, v12, 7, v15
v_lshl_add_u32 v6, v14, 3, v15
v_add_u32 v10, 0x10000, v6
v_xor_b32 v15, 3, v13
v_lshlrev_b32 v15, 5, v15
v_lshl_add_u32 v15, v12, 7, v15
v_lshl_add_u32 v7, v14, 3, v15
v_add_u32 v11, 0x10000, v7
s_mov_b32 s51, 0
v_mov_b64 v[192:193], 0
v_mov_b64 v[194:195], 0
v_mov_b64 v[196:197], 0
v_mov_b64 v[198:199], 0
v_mov_b64 v[200:201], 0
v_mov_b64 v[202:203], 0
v_mov_b64 v[204:205], 0
v_mov_b64 v[206:207], 0
v_mov_b64 v[208:209], 0
v_mov_b64 v[210:211], 0
v_mov_b64 v[212:213], 0
v_mov_b64 v[214:215], 0
v_mov_b64 v[216:217], 0
v_mov_b64 v[218:219], 0
v_mov_b64 v[220:221], 0
v_mov_b64 v[222:223], 0
v_mov_b64 v[224:225], 0
v_mov_b64 v[226:227], 0
v_mov_b64 v[228:229], 0
v_mov_b64 v[230:231], 0
v_mov_b64 v[232:233], 0
v_mov_b64 v[234:235], 0
v_mov_b64 v[236:237], 0
v_mov_b64 v[238:239], 0
v_mov_b64 v[240:241], 0
v_mov_b64 v[242:243], 0
v_mov_b64 v[244:245], 0
v_mov_b64 v[246:247], 0
v_mov_b64 v[248:249], 0
v_mov_b64 v[250:251], 0
v_mov_b64 v[252:253], 0
v_mov_b64 v[254:255], 0
v_mov_b32 v24, s92
v_add_u32 v26, 256, v24
v_add_u32 v27, 512, v24
s_and_b32 s30, s25, 4
s_lshl_b32 s30, s30, 6
v_add_u32 v24, s30, v26
s_waitcnt vmcnt(4)
v_readfirstlane_b32 s30, v29
s_nop 0
s_cmp_ge_u32 s30, 16
s_cbranch_scc1 Ld17
s_mov_b32 s31, 262144
Lp16:
global_load_dword v29, v30, s[22:23] offset:1024 sc1
s_waitcnt vmcnt(0)
v_readfirstlane_b32 s30, v29
s_nop 0
s_cmp_ge_u32 s30, 16
s_cbranch_scc1 Ld17
s_sleep 4
s_sub_u32 s31, s31, 1
s_cmp_lg_u32 s31, 0
s_cbranch_scc1 Lp16
Ld17:
s_barrier
s_branch L2_start
L1_typeQ:
s_sub_u32 s31, 6291456, s11
s_add_u32 s40, s6, s11
s_addc_u32 s41, s7, 0
s_mov_b32 s42, s31
s_mov_b32 s43, 0x20000
s_lshl_b32 s30, s29, 8
s_add_u32 s30, s30, s10
s_sub_u32 s31, 7340032, s30
s_add_u32 s32, s12, s30
s_addc_u32 s33, s13, 0
s_mov_b32 s34, s31
s_mov_b32 s35, 0x20000
s_sub_u32 s31, 7340032, s30
s_add_u32 s36, s14, s30
s_addc_u32 s37, s15, 0
s_mov_b32 s38, s31
s_mov_b32 s39, 0x20000
s_lshl_b32 s31, s29, 13
s_add_u32 s83, s83, s31
s_add_u32 s30, s30, 128
s_sub_u32 s31, 7340032, s30
s_add_u32 s44, s12, s30
s_addc_u32 s45, s13, 0
s_mov_b32 s46, s31
s_mov_b32 s47, 0x20000
s_sub_u32 s31, 7340032, s30
s_add_u32 s48, s14, s30
s_addc_u32 s49, s15, 0
s_mov_b32 s50, s31
s_mov_b32 s51, 0x20000
s_lshl_b32 s85, s28, 12
s_add_u32 s85, s85, 229376
s_lshl_b32 s30, s26, 5
v_mov_b32 v30, s30
s_or_b32 s30, s25, s27
s_xor_b32 s31, s24, 3
s_or_b32 s30, s30, s31
s_cmp_lg_u32 s30, 0
s_cbranch_scc1 Lm18
s_waitcnt vmcnt(4)
v_mov_b32 v25, 1
s_mov_b64 exec, 1
global_store_dword v30, v25, s[20:21] sc0 sc1
s_mov_b64 exec, -1
Lm18:
s_add_u32 m0, s78, 0
s_nop 0
buffer_load_dwordx4 v17, s[32:35], s74 offen nt lds
s_add_u32 m0, s78, 4096
s_nop 0
buffer_load_dwordx4 v17, s[32:35], s75 offen nt lds
s_add_u32 m0, s78, 32768
s_nop 0
buffer_load_dwordx4 v17, s[36:39], s74 offen nt lds
s_add_u32 m0, s78, 36864
s_nop 0
buffer_load_dwordx4 v17, s[36:39], s75 offen nt lds
s_add_u32 m0, s78, 65536
s_nop 0
buffer_load_dwordx4 v16, s[40:43], s72 offen nt lds
s_add_u32 m0, s78, 69632
s_nop 0
buffer_load_dwordx4 v16, s[40:43], s73 offen nt lds
s_add_u32 m0, s78, 98304
s_nop 0
buffer_load_dwordx4 v17, s[44:47], s74 offen nt lds
s_add_u32 m0, s78, 102400
s_nop 0
buffer_load_dwordx4 v17, s[44:47], s75 offen nt lds
s_add_u32 m0, s78, 131072
s_nop 0
buffer_load_dwordx4 v17, s[48:51], s74 offen nt lds
s_add_u32 m0, s78, 135168
s_nop 0
buffer_load_dwordx4 v17, s[48:51], s75 offen nt lds
s_add_u32 s72, s72, 393216
s_add_u32 s73, s73, 393216
s_add_u32 s74, s74, 458752
s_add_u32 s75, s75, 458752
s_waitcnt vmcnt(10)
s_mov_b32 s3, 0xffff0000
v_lshlrev_b32 v80, 16, v64
v_and_b32 v81, s3, v64
v_lshlrev_b32 v82, 16, v65
v_and_b32 v83, s3, v65
v_lshlrev_b32 v84, 16, v66
v_and_b32 v85, s3, v66
v_lshlrev_b32 v86, 16, v67
v_and_b32 v87, s3, v67
v_lshlrev_b32 v88, 16, v68
v_and_b32 v89, s3, v68
v_lshlrev_b32 v90, 16, v69
v_and_b32 v91, s3, v69
v_lshlrev_b32 v92, 16, v70
v_and_b32 v93, s3, v70
v_lshlrev_b32 v94, 16, v71
v_and_b32 v95, s3, v71
v_lshlrev_b32 v96, 16, v72
v_and_b32 v97, s3, v72
v_lshlrev_b32 v98, 16, v73
v_and_b32 v99, s3, v73
v_lshlrev_b32 v100, 16, v74
v_and_b32 v101, s3, v74
v_lshlrev_b32 v102, 16, v75
v_and_b32 v103, s3, v75
v_lshlrev_b32 v104, 16, v76
v_and_b32 v105, s3, v76
v_lshlrev_b32 v106, 16, v77
v_and_b32 v107, s3, v77
v_lshlrev_b32 v108, 16, v78
v_and_b32 v109, s3, v78
v_lshlrev_b32 v110, 16, v79
v_and_b32 v111, s3, v79
v_pk_add_f32 v[112:113], v[80:81], v[84:85]
v_pk_add_f32 v[114:115], v[82:83], v[86:87]
v_pk_add_f32 v[112:113], v[112:113], v[88:89]
v_pk_add_f32 v[114:115], v[114:115], v[90:91]
v_pk_add_f32 v[112:113], v[112:113], v[92:93]
v_pk_add_f32 v[114:115], v[114:115], v[94:95]
v_pk_add_f32 v[112:113], v[112:113], v[96:97]
v_pk_add_f32 v[114:115], v[114:115], v[98:99]
v_pk_add_f32 v[112:113], v[112:113], v[100:101]
v_pk_add_f32 v[114:115], v[114:115], v[102:103]
v_pk_add_f32 v[112:113], v[112:113], v[104:105]
v_pk_add_f32 v[114:115], v[114:115], v[106:107]
v_pk_add_f32 v[112:113], v[112:113], v[108:109]
v_pk_add_f32 v[114:115], v[114:115], v[110:111]
v_pk_add_f32 v[112:113], v[112:113], v[114:115]
v_add_f32 v112, v112, v113
s_nop 1
v_add_f32_dpp v112, v112, v112 quad_perm:[1,0,3,2] row_mask:0xf bank_mask:0xf
s_nop 1
v_add_f32_dpp v112, v112, v112 quad_perm:[2,3,0,1] row_mask:0xf bank_mask:0xf
s_nop 1
v_add_f32_dpp v112, v112, v112 row_half_mirror row_mask:0xf bank_mask:0xf
s_nop 1
v_add_f32_dpp v112, v112, v112 row_mirror row_mask:0xf bank_mask:0xf
v_mov_b32 v113, v112
s_nop 1
v_permlane16_swap_b32 v113, v112
v_add_f32 v112, v112, v113
v_mul_f32 v112, 0xba800000, v112
v_mov_b32 v113, v112
v_pk_add_f32 v[64:65], v[80:81], v[112:113]
v_pk_mul_f32 v[116:117], v[64:65], v[64:65]
v_pk_add_f32 v[66:67], v[82:83], v[112:113]
v_pk_mul_f32 v[118:119], v[66:67], v[66:67]
v_pk_add_f32 v[68:69], v[84:85], v[112:113]
v_pk_fma_f32 v[116:117], v[68:69], v[68:69], v[116:117]
v_pk_add_f32 v[70:71], v[86:87], v[112:113]
v_pk_fma_f32 v[118:119], v[70:71], v[70:71], v[118:119]
v_pk_add_f32 v[64:65], v[88:89], v[112:113]
v_pk_fma_f32 v[116:117], v[64:65], v[64:65], v[116:117]
v_pk_add_f32 v[66:67], v[90:91], v[112:113]
v_pk_fma_f32 v[118:119], v[66:67], v[66:67], v[118:119]
v_pk_add_f32 v[68:69], v[92:93], v[112:113]
v_pk_fma_f32 v[116:117], v[68:69], v[68:69], v[116:117]
v_pk_add_f32 v[70:71], v[94:95], v[112:113]
v_pk_fma_f32 v[118:119], v[70:71], v[70:71], v[118:119]
v_pk_add_f32 v[64:65], v[96:97], v[112:113]
v_pk_fma_f32 v[116:117], v[64:65], v[64:65], v[116:117]
v_pk_add_f32 v[66:67], v[98:99], v[112:113]
v_pk_fma_f32 v[118:119], v[66:67], v[66:67], v[118:119]
v_pk_add_f32 v[68:69], v[100:101], v[112:113]
v_pk_fma_f32 v[116:117], v[68:69], v[68:69], v[116:117]
v_pk_add_f32 v[70:71], v[102:103], v[112:113]
v_pk_fma_f32 v[118:119], v[70:71], v[70:71], v[118:119]
v_pk_add_f32 v[64:65], v[104:105], v[112:113]
v_pk_fma_f32 v[116:117], v[64:65], v[64:65], v[116:117]
v_pk_add_f32 v[66:67], v[106:107], v[112:113]
v_pk_fma_f32 v[118:119], v[66:67], v[66:67], v[118:119]
v_pk_add_f32 v[68:69], v[108:109], v[112:113]
v_pk_fma_f32 v[116:117], v[68:69], v[68:69], v[116:117]
v_pk_add_f32 v[70:71], v[110:111], v[112:113]
v_pk_fma_f32 v[118:119], v[70:71], v[70:71], v[118:119]
v_pk_add_f32 v[116:117], v[116:117], v[118:119]
v_add_f32 v116, v116, v117
v_cvt_pk_bf16_f32 v112, v112, v112
v_and_b32 v112, s3, v112
v_mov_b32 v113, v112
v_add_f32_dpp v116, v116, v116 quad_perm:[1,0,3,2] row_mask:0xf bank_mask:0xf
s_nop 1
v_add_f32_dpp v116, v116, v116 quad_perm:[2,3,0,1] row_mask:0xf bank_mask:0xf
s_nop 1
v_add_f32_dpp v116, v116, v116 row_half_mirror row_mask:0xf bank_mask:0xf
s_nop 1
v_add_f32_dpp v116, v116, v116 row_mirror row_mask:0xf bank_mask:0xf
v_mov_b32 v117, v116
s_nop 1
v_permlane16_swap_b32 v117, v116
v_add_f32 v116, v116, v117
v_pk_add_f32 v[80:81], v[80:81], v[112:113]
v_mul_f32 v116, 0x3a800000, v116
v_cvt_pk_bf16_f32 v81, v80, v81
v_lshlrev_b32 v80, 16, v81
v_and_b32 v81, s3, v81
v_pk_add_f32 v[82:83], v[82:83], v[112:113]
v_cvt_pk_bf16_f32 v116, v116, v116
v_cvt_pk_bf16_f32 v83, v82, v83
v_lshlrev_b32 v82, 16, v83
v_and_b32 v83, s3, v83
v_pk_add_f32 v[84:85], v[84:85], v[112:113]
v_and_b32 v116, s3, v116
v_cvt_pk_bf16_f32 v85, v84, v85
v_lshlrev_b32 v84, 16, v85
v_and_b32 v85, s3, v85
v_pk_add_f32 v[86:87], v[86:87], v[112:113]
s_add_u32 m0, s78, 8192
v_add_f32 v116, 0x3727c5ac, v116
v_cvt_pk_bf16_f32 v87, v86, v87
buffer_load_dwordx4 v17, s[32:35], s74 offen nt lds
v_lshlrev_b32 v86, 16, v87
v_and_b32 v87, s3, v87
v_pk_add_f32 v[88:89], v[88:89], v[112:113]
v_cvt_pk_bf16_f32 v116, v116, v116
v_cvt_pk_bf16_f32 v89, v88, v89
v_lshlrev_b32 v88, 16, v89
v_and_b32 v89, s3, v89
v_pk_add_f32 v[90:91], v[90:91], v[112:113]
s_add_u32 m0, s78, 12288
v_and_b32 v116, s3, v116
v_cvt_pk_bf16_f32 v91, v90, v91
buffer_load_dwordx4 v17, s[32:35], s75 offen nt lds
v_lshlrev_b32 v90, 16, v91
v_and_b32 v91, s3, v91
v_pk_add_f32 v[92:93], v[92:93], v[112:113]
v_sqrt_f32 v116, v116
v_cvt_pk_bf16_f32 v93, v92, v93
v_lshlrev_b32 v92, 16, v93
v_and_b32 v93, s3, v93
v_pk_add_f32 v[94:95], v[94:95], v[112:113]
s_add_u32 m0, s78, 40960
v_cvt_pk_bf16_f32 v116, v116, v116
v_cvt_pk_bf16_f32 v95, v94, v95
buffer_load_dwordx4 v17, s[36:39], s74 offen nt lds
v_lshlrev_b32 v94, 16, v95
v_and_b32 v95, s3, v95
v_pk_add_f32 v[96:97], v[96:97], v[112:113]
v_and_b32 v116, s3, v116
v_cvt_pk_bf16_f32 v97, v96, v97
v_lshlrev_b32 v96, 16, v97
v_and_b32 v97, s3, v97
v_pk_add_f32 v[98:99], v[98:99], v[112:113]
s_add_u32 m0, s78, 45056
v_rcp_f32 v116, v116
v_cvt_pk_bf16_f32 v99, v98, v99
buffer_load_dwordx4 v17, s[36:39], s75 offen nt lds
v_lshlrev_b32 v98, 16, v99
v_and_b32 v99, s3, v99
v_pk_add_f32 v[100:101], v[100:101], v[112:113]
v_mov_b32 v117, v116
v_cvt_pk_bf16_f32 v101, v100, v101
v_lshlrev_b32 v100, 16, v101
v_and_b32 v101, s3, v101
v_pk_add_f32 v[102:103], v[102:103], v[112:113]
v_cvt_pk_bf16_f32 v103, v102, v103
v_lshlrev_b32 v102, 16, v103
v_and_b32 v103, s3, v103
v_pk_add_f32 v[104:105], v[104:105], v[112:113]
v_cvt_pk_bf16_f32 v105, v104, v105
v_lshlrev_b32 v104, 16, v105
v_and_b32 v105, s3, v105
v_pk_add_f32 v[106:107], v[106:107], v[112:113]
v_cvt_pk_bf16_f32 v107, v106, v107
v_lshlrev_b32 v106, 16, v107
v_and_b32 v107, s3, v107
v_pk_add_f32 v[108:109], v[108:109], v[112:113]
v_cvt_pk_bf16_f32 v109, v108, v109
v_lshlrev_b32 v108, 16, v109
v_and_b32 v109, s3, v109
v_pk_add_f32 v[110:111], v[110:111], v[112:113]
v_cvt_pk_bf16_f32 v111, v110, v111
v_lshlrev_b32 v110, 16, v111
v_and_b32 v111, s3, v111
v_pk_mul_f32 v[80:81], v[80:81], v[116:117]
v_cvt_pk_bf16_f32 v64, v80, v81
v_pk_mul_f32 v[82:83], v[82:83], v[116:117]
v_cvt_pk_bf16_f32 v65, v82, v83
v_pk_mul_f32 v[84:85], v[84:85], v[116:117]
v_cvt_pk_bf16_f32 v66, v84, v85
v_pk_mul_f32 v[86:87], v[86:87], v[116:117]
v_cvt_pk_bf16_f32 v67, v86, v87
v_pk_mul_f32 v[88:89], v[88:89], v[116:117]
v_cvt_pk_bf16_f32 v68, v88, v89
v_pk_mul_f32 v[90:91], v[90:91], v[116:117]
v_cvt_pk_bf16_f32 v69, v90, v91
v_pk_mul_f32 v[92:93], v[92:93], v[116:117]
v_cvt_pk_bf16_f32 v70, v92, v93
v_pk_mul_f32 v[94:95], v[94:95], v[116:117]
v_cvt_pk_bf16_f32 v71, v94, v95
v_pk_mul_f32 v[96:97], v[96:97], v[116:117]
v_cvt_pk_bf16_f32 v72, v96, v97
v_pk_mul_f32 v[98:99], v[98:99], v[116:117]
v_cvt_pk_bf16_f32 v73, v98, v99
v_pk_mul_f32 v[100:101], v[100:101], v[116:117]
v_cvt_pk_bf16_f32 v74, v100, v101
v_pk_mul_f32 v[102:103], v[102:103], v[116:117]
v_cvt_pk_bf16_f32 v75, v102, v103
v_pk_mul_f32 v[104:105], v[104:105], v[116:117]
v_cvt_pk_bf16_f32 v76, v104, v105
v_pk_mul_f32 v[106:107], v[106:107], v[116:117]
v_cvt_pk_bf16_f32 v77, v106, v107
v_pk_mul_f32 v[108:109], v[108:109], v[116:117]
v_cvt_pk_bf16_f32 v78, v108, v109
v_pk_mul_f32 v[110:111], v[110:111], v[116:117]
v_cvt_pk_bf16_f32 v79, v110, v111
global_load_dword v29, v30, s[20:21] sc1
ds_write_b128 v22, v[64:67] offset:24576
ds_write_b128 v22, v[68:71] offset:28672
ds_write_b128 v22, v[72:75] offset:57344
ds_write_b128 v22, v[76:79] offset:61440
s_waitcnt lgkmcnt(0)
s_barrier
ds_read_b128 v[64:67], v21 offset:24576
ds_read_b128 v[68:71], v21 offset:25600
ds_read_b128 v[72:75], v21 offset:26624
ds_read_b128 v[76:79], v21 offset:27648
s_waitcnt lgkmcnt(3)
global_store_dwordx4 v23, v[64:67], s[22:23] sc0 sc1
v_add_u32 v23, 0x2000, v23
s_waitcnt lgkmcnt(2)
global_store_dwordx4 v23, v[68:71], s[22:23] sc0 sc1
v_add_u32 v23, 0x2000, v23
s_waitcnt lgkmcnt(1)
global_store_dwordx4 v23, v[72:75], s[22:23] sc0 sc1
v_add_u32 v23, 0x2000, v23
s_waitcnt lgkmcnt(0)
global_store_dwordx4 v23, v[76:79], s[22:23] sc0 sc1
v_accvgpr_write_b32 a127, 0
v_accvgpr_write_b32 a126, 0
v_accvgpr_write_b32 a125, 0
v_accvgpr_write_b32 a124, 0
s_add_u32 m0, s78, 73728
v_accvgpr_write_b32 a123, 0
v_accvgpr_write_b32 a122, 0
buffer_load_dwordx4 v16, s[40:43], s72 offen nt lds
v_accvgpr_write_b32 a121, 0
v_accvgpr_write_b32 a120, 0
v_accvgpr_write_b32 a119, 0
v_accvgpr_write_b32 a118, 0
s_add_u32 m0, s78, 77824
v_accvgpr_write_b32 a117, 0
v_accvgpr_write_b32 a116, 0
buffer_load_dwordx4 v16, s[40:43], s73 offen nt lds
v_accvgpr_write_b32 a115, 0
v_accvgpr_write_b32 a114, 0
v_accvgpr_write_b32 a113, 0
v_accvgpr_write_b32 a112, 0
s_add_u32 m0, s78, 106496
v_accvgpr_write_b32 a111, 0
v_accvgpr_write_b32 a110, 0
buffer_load_dwordx4 v17, s[44:47], s74 offen nt lds
v_accvgpr_write_b32 a109, 0
v_accvgpr_write_b32 a108, 0
v_accvgpr_write_b32 a107, 0
v_accvgpr_write_b32 a106, 0
s_add_u32 m0, s78, 110592
v_accvgpr_write_b32 a105, 0
v_accvgpr_write_b32 a104, 0
buffer_load_dwordx4 v17, s[44:47], s75 offen nt lds
v_accvgpr_write_b32 a103, 0
v_accvgpr_write_b32 a102, 0
v_accvgpr_write_b32 a101, 0
v_accvgpr_write_b32 a100, 0
s_add_u32 m0, s78, 139264
v_accvgpr_write_b32 a99, 0
v_accvgpr_write_b32 a98, 0
buffer_load_dwordx4 v17, s[48:51], s74 offen nt lds
v_accvgpr_write_b32 a97, 0
v_accvgpr_write_b32 a96, 0
v_accvgpr_write_b32 a95, 0
v_accvgpr_write_b32 a94, 0
s_add_u32 m0, s78, 143360
v_accvgpr_write_b32 a93, 0
v_accvgpr_write_b32 a92, 0
buffer_load_dwordx4 v17, s[48:51], s75 offen nt lds
v_accvgpr_write_b32 a91, 0
v_accvgpr_write_b32 a90, 0
v_accvgpr_write_b32 a89, 0
v_accvgpr_write_b32 a88, 0
v_accvgpr_write_b32 a87, 0
v_accvgpr_write_b32 a86, 0
v_accvgpr_write_b32 a85, 0
v_accvgpr_write_b32 a84, 0
v_accvgpr_write_b32 a83, 0
v_accvgpr_write_b32 a82, 0
v_accvgpr_write_b32 a81, 0
v_accvgpr_write_b32 a80, 0
v_accvgpr_write_b32 a79, 0
v_accvgpr_write_b32 a78, 0
v_accvgpr_write_b32 a77, 0
v_accvgpr_write_b32 a76, 0
v_accvgpr_write_b32 a75, 0
v_accvgpr_write_b32 a74, 0
v_accvgpr_write_b32 a73, 0
v_accvgpr_write_b32 a72, 0
v_accvgpr_write_b32 a71, 0
v_accvgpr_write_b32 a70, 0
v_accvgpr_write_b32 a69, 0
v_accvgpr_write_b32 a68, 0
v_accvgpr_write_b32 a67, 0
v_accvgpr_write_b32 a66, 0
v_accvgpr_write_b32 a65, 0
v_accvgpr_write_b32 a64, 0
s_waitcnt vmcnt(6)
s_barrier
s_cmp_lg_u32 s24, 0
s_cbranch_scc1 La19
v_readfirstlane_b32 s30, v29
s_nop 0
s_cmp_ge_u32 s30, 1
s_cbranch_scc1 Ld21
s_mov_b32 s31, 262144
Lp20:
global_load_dword v29, v30, s[20:21] offset:0 sc1
s_waitcnt vmcnt(0)
v_readfirstlane_b32 s30, v29
s_nop 0
s_cmp_ge_u32 s30, 1
s_cbranch_scc1 Ld21
s_sleep 1
s_sub_u32 s31, s31, 1
s_cmp_lg_u32 s31, 0
s_cbranch_scc1 Lp20
Ld21:
s_lshl_b32 s30, s27, 3
s_add_u32 s30, s30, s25
s_lshl_b64 exec, 1, s30
v_mov_b32 v25, 1
global_store_dword v31, v25, s[22:23] sc0 sc1
s_mov_b64 exec, -1
La19:
v_mov_b32 v255, 0
v_mov_b32 v254, 0
v_mov_b32 v253, 0
v_mov_b32 v252, 0
v_mov_b32 v251, 0
v_mov_b32 v250, 0
s_add_u32 s72, s72, 393216
s_add_u32 s73, s73, 393216
s_add_u32 s74, s74, 458752
s_add_u32 s75, s75, 458752
s_add_u32 m0, s78, 16384
v_mov_b32 v249, 0
v_mov_b32 v248, 0
buffer_load_dwordx4 v17, s[32:35], s74 offen nt lds
v_mov_b32 v247, 0
v_mov_b32 v246, 0
v_mov_b32 v245, 0
v_mov_b32 v244, 0
v_mov_b32 v243, 0
v_mov_b32 v242, 0
s_add_u32 m0, s78, 20480
v_mov_b32 v241, 0
v_mov_b32 v240, 0
buffer_load_dwordx4 v17, s[32:35], s75 offen nt lds
v_mov_b32 v239, 0
v_mov_b32 v238, 0
v_mov_b32 v237, 0
v_mov_b32 v236, 0
v_mov_b32 v235, 0
v_mov_b32 v234, 0
s_add_u32 m0, s78, 49152
v_mov_b32 v233, 0
v_mov_b32 v232, 0
buffer_load_dwordx4 v17, s[36:39], s74 offen nt lds
v_mov_b32 v231, 0
v_mov_b32 v230, 0
v_mov_b32 v229, 0
v_mov_b32 v228, 0
v_mov_b32 v227, 0
v_mov_b32 v226, 0
s_add_u32 m0, s78, 53248
v_mov_b32 v225, 0
v_mov_b32 v224, 0
buffer_load_dwordx4 v17, s[36:39], s75 offen nt lds
v_mov_b32 v223, 0
v_mov_b32 v222, 0
v_mov_b32 v221, 0
v_mov_b32 v220, 0
v_mov_b32 v219, 0
v_mov_b32 v218, 0
s_add_u32 m0, s78, 81920
v_mov_b32 v217, 0
v_mov_b32 v216, 0
buffer_load_dwordx4 v16, s[40:43], s72 offen nt lds
v_mov_b32 v215, 0
v_mov_b32 v214, 0
v_mov_b32 v213, 0
v_mov_b32 v212, 0
v_mov_b32 v211, 0
v_mov_b32 v210, 0
s_add_u32 m0, s78, 86016
v_mov_b32 v209, 0
v_mov_b32 v208, 0
buffer_load_dwordx4 v16, s[40:43], s73 offen nt lds
v_mov_b32 v207, 0
v_mov_b32 v206, 0
v_mov_b32 v205, 0
v_mov_b32 v204, 0
v_mov_b32 v203, 0
v_mov_b32 v202, 0
s_add_u32 m0, s78, 114688
v_mov_b32 v201, 0
v_mov_b32 v200, 0
buffer_load_dwordx4 v17, s[44:47], s74 offen nt lds
v_mov_b32 v199, 0
v_mov_b32 v198, 0
v_mov_b32 v197, 0
v_mov_b32 v196, 0
v_mov_b32 v195, 0
v_mov_b32 v194, 0
s_add_u32 m0, s78, 118784
v_mov_b32 v193, 0
v_mov_b32 v192, 0
buffer_load_dwordx4 v17, s[44:47], s75 offen nt lds
v_mov_b32 v191, 0
v_mov_b32 v190, 0
v_mov_b32 v189, 0
v_mov_b32 v188, 0
v_mov_b32 v187, 0
v_mov_b32 v186, 0
s_add_u32 m0, s78, 147456
v_mov_b32 v185, 0
v_mov_b32 v184, 0
buffer_load_dwordx4 v17, s[48:51], s74 offen nt lds
v_mov_b32 v183, 0
v_mov_b32 v182, 0
v_mov_b32 v181, 0
v_mov_b32 v180, 0
v_mov_b32 v179, 0
v_mov_b32 v178, 0
s_add_u32 m0, s78, 151552
v_mov_b32 v177, 0
v_mov_b32 v176, 0
buffer_load_dwordx4 v17, s[48:51], s75 offen nt lds
v_mov_b32 v175, 0
v_mov_b32 v174, 0
v_mov_b32 v173, 0
v_mov_b32 v172, 0
v_mov_b32 v171, 0
v_mov_b32 v170, 0
v_mov_b32 v169, 0
v_mov_b32 v168, 0
v_mov_b32 v167, 0
v_mov_b32 v166, 0
v_mov_b32 v165, 0
v_mov_b32 v164, 0
v_mov_b32 v163, 0
v_mov_b32 v162, 0
v_mov_b32 v161, 0
v_mov_b32 v160, 0
v_mov_b32 v159, 0
v_mov_b32 v158, 0
v_mov_b32 v157, 0
v_mov_b32 v156, 0
v_mov_b32 v155, 0
v_mov_b32 v154, 0
v_mov_b32 v153, 0
v_mov_b32 v152, 0
v_mov_b32 v151, 0
v_mov_b32 v150, 0
v_mov_b32 v149, 0
v_mov_b32 v148, 0
v_mov_b32 v147, 0
v_mov_b32 v146, 0
v_mov_b32 v145, 0
v_mov_b32 v144, 0
v_mov_b32 v143, 0
v_mov_b32 v142, 0
v_mov_b32 v141, 0
v_mov_b32 v140, 0
v_mov_b32 v139, 0
v_mov_b32 v138, 0
v_mov_b32 v137, 0
v_mov_b32 v136, 0
v_mov_b32 v135, 0
v_mov_b32 v134, 0
v_mov_b32 v133, 0
v_mov_b32 v132, 0
v_mov_b32 v131, 0
v_mov_b32 v130, 0
v_mov_b32 v129, 0
v_mov_b32 v128, 0
v_accvgpr_write_b32 a63, 0
v_accvgpr_write_b32 a62, 0
v_accvgpr_write_b32 a61, 0
v_accvgpr_write_b32 a60, 0
v_accvgpr_write_b32 a59, 0
v_accvgpr_write_b32 a58, 0
v_accvgpr_write_b32 a57, 0
v_accvgpr_write_b32 a56, 0
v_accvgpr_write_b32 a55, 0
v_accvgpr_write_b32 a54, 0
v_accvgpr_write_b32 a53, 0
v_accvgpr_write_b32 a52, 0
v_accvgpr_write_b32 a51, 0
v_accvgpr_write_b32 a50, 0
v_accvgpr_write_b32 a49, 0
v_accvgpr_write_b32 a48, 0
v_accvgpr_write_b32 a47, 0
v_accvgpr_write_b32 a46, 0
v_accvgpr_write_b32 a45, 0
v_accvgpr_write_b32 a44, 0
v_accvgpr_write_b32 a43, 0
v_accvgpr_write_b32 a42, 0
v_accvgpr_write_b32 a41, 0
v_accvgpr_write_b32 a40, 0
v_accvgpr_write_b32 a39, 0
v_accvgpr_write_b32 a38, 0
v_accvgpr_write_b32 a37, 0
v_accvgpr_write_b32 a36, 0
v_accvgpr_write_b32 a35, 0
v_accvgpr_write_b32 a34, 0
v_accvgpr_write_b32 a33, 0
v_accvgpr_write_b32 a32, 0
v_accvgpr_write_b32 a31, 0
v_accvgpr_write_b32 a30, 0
v_accvgpr_write_b32 a29, 0
v_accvgpr_write_b32 a28, 0
v_accvgpr_write_b32 a27, 0
v_accvgpr_write_b32 a26, 0
v_accvgpr_write_b32 a25, 0
v_accvgpr_write_b32 a24, 0
v_accvgpr_write_b32 a23, 0
v_accvgpr_write_b32 a22, 0
v_accvgpr_write_b32 a21, 0
v_accvgpr_write_b32 a20, 0
v_accvgpr_write_b32 a19, 0
v_accvgpr_write_b32 a18, 0
v_accvgpr_write_b32 a17, 0
v_accvgpr_write_b32 a16, 0
v_accvgpr_write_b32 a15, 0
v_accvgpr_write_b32 a14, 0
v_accvgpr_write_b32 a13, 0
v_accvgpr_write_b32 a12, 0
v_accvgpr_write_b32 a11, 0
v_accvgpr_write_b32 a10, 0
v_accvgpr_write_b32 a9, 0
v_accvgpr_write_b32 a8, 0
v_accvgpr_write_b32 a7, 0
v_accvgpr_write_b32 a6, 0
v_accvgpr_write_b32 a5, 0
v_accvgpr_write_b32 a4, 0
v_accvgpr_write_b32 a3, 0
v_accvgpr_write_b32 a2, 0
v_accvgpr_write_b32 a1, 0
v_accvgpr_write_b32 a0, 0
v_mov_b32 v127, 0
v_mov_b32 v126, 0
v_mov_b32 v125, 0
v_mov_b32 v124, 0
v_mov_b32 v123, 0
v_mov_b32 v122, 0
v_mov_b32 v121, 0
v_mov_b32 v120, 0
v_mov_b32 v119, 0
v_mov_b32 v118, 0
v_mov_b32 v117, 0
v_mov_b32 v116, 0
v_mov_b32 v115, 0
v_mov_b32 v114, 0
v_mov_b32 v113, 0
v_mov_b32 v112, 0
v_mov_b32 v111, 0
v_mov_b32 v110, 0
v_mov_b32 v109, 0
v_mov_b32 v108, 0
v_mov_b32 v107, 0
v_mov_b32 v106, 0
v_mov_b32 v105, 0
v_mov_b32 v104, 0
v_mov_b32 v103, 0
v_mov_b32 v102, 0
v_mov_b32 v101, 0
v_mov_b32 v100, 0
v_mov_b32 v99, 0
v_mov_b32 v98, 0
v_mov_b32 v97, 0
v_mov_b32 v96, 0
v_mov_b32 v95, 0
v_mov_b32 v94, 0
v_mov_b32 v93, 0
v_mov_b32 v92, 0
v_mov_b32 v91, 0
v_mov_b32 v90, 0
v_mov_b32 v89, 0
v_mov_b32 v88, 0
v_mov_b32 v87, 0
v_mov_b32 v86, 0
v_mov_b32 v85, 0
v_mov_b32 v84, 0
v_mov_b32 v83, 0
v_mov_b32 v82, 0
v_mov_b32 v81, 0
v_mov_b32 v80, 0
v_mov_b32 v79, 0
v_mov_b32 v78, 0
v_mov_b32 v77, 0
v_mov_b32 v76, 0
v_mov_b32 v75, 0
v_mov_b32 v74, 0
v_mov_b32 v73, 0
v_mov_b32 v72, 0
v_mov_b32 v71, 0
v_mov_b32 v70, 0
v_mov_b32 v69, 0
v_mov_b32 v68, 0
v_mov_b32 v67, 0
v_mov_b32 v66, 0
v_mov_b32 v65, 0
v_mov_b32 v64, 0
s_add_u32 s72, s72, 393216
s_add_u32 s73, s73, 393216
s_add_u32 s74, s74, 458752
s_add_u32 s75, s75, 458752
TR v[32:33],v4,0
TR v[34:35],v4,512
TR v[36:37],v4,4096
TR v[38:39],v4,4608
TR v[40:41],v5,0
TR v[42:43],v5,512
TR v[44:45],v5,4096
TR v[46:47],v5,4608
s_mov_b32 s80, 3
s_getpc_b64 s[10:11]
Lc22:
s_sub_u32 s10, s10, Lc22-recurrent_scan__linear_attn_block__glu_gated_swiglu__prompt_kernel
s_subb_u32 s11, s11, 0
s_lshr_b32 s30, s2, 3
s_lshl_b32 s30, s30, 2
s_add_u32 s30, s30, s24
s_lshl_b32 s30, s30, 10
s_min_u32 s30, s30, L_end-recurrent_scan__linear_attn_block__glu_gated_swiglu__prompt_kernel-1024
v_add_u32 v28, s30, v2
v_mov_b32 v29, s11
v_add_co_u32 v28, vcc, s10, v28
s_nop 1
v_addc_co_u32 v29, vcc, 0, v29, vcc
s_cmp_lg_u32 s24, 0
s_cbranch_scc1 Lw23
s_mov_b32 s31, 262144
Lp24:
global_load_dword v25, v31, s[22:23] sc1
s_waitcnt vmcnt(0)
v_cmp_ne_u32 vcc, 1, v25
s_nop 0
s_cmp_eq_u64 vcc, 0
s_cbranch_scc1 Ld25
s_sleep 2
s_sub_u32 s31, s31, 1
s_cmp_lg_u32 s31, 0
s_cbranch_scc1 Lp24
Ld25:
Lw23:
s_barrier
buffer_load_dwordx4 a[128:131], v2, s[52:55], s76 offen offset:0 sc1
buffer_load_dwordx4 a[132:135], v2, s[52:55], s76 offen offset:1024 sc1
buffer_load_dwordx4 a[136:139], v2, s[52:55], s76 offen offset:2048 sc1
buffer_load_dwordx4 a[140:143], v2, s[52:55], s76 offen offset:3072 sc1
buffer_load_dwordx4 a[144:147], v19, s[52:55], s76 offen offset:0 sc1
buffer_load_dwordx4 a[148:151], v19, s[52:55], s76 offen offset:1024 sc1
buffer_load_dwordx4 a[152:155], v19, s[52:55], s76 offen offset:2048 sc1
buffer_load_dwordx4 a[156:159], v19, s[52:55], s76 offen offset:3072 sc1
s_add_u32 s76, s76, 8192
buffer_load_dwordx4 a[160:163], v2, s[52:55], s76 offen offset:0 sc1
buffer_load_dwordx4 a[164:167], v2, s[52:55], s76 offen offset:1024 sc1
buffer_load_dwordx4 a[168:171], v2, s[52:55], s76 offen offset:2048 sc1
buffer_load_dwordx4 a[172:175], v2, s[52:55], s76 offen offset:3072 sc1
buffer_load_dwordx4 a[176:179], v19, s[52:55], s76 offen offset:0 sc1
buffer_load_dwordx4 a[180:183], v19, s[52:55], s76 offen offset:1024 sc1
buffer_load_dwordx4 a[184:187], v19, s[52:55], s76 offen offset:2048 sc1
buffer_load_dwordx4 a[188:191], v19, s[52:55], s76 offen offset:3072 sc1
s_add_u32 s76, s76, 8192
s_waitcnt vmcnt(8) lgkmcnt(4)
.p2align 6
L1Q_loop:
MM v[64:67],v[32:35],a[128:131]
TR v[48:49],v6,0
MM v[64:67],v[36:39],a[144:147]
buffer_load_dwordx4 v[20:23], v2, s[64:67], s81 offen
s_add_u32 s81, s81, 0x100000
MM v[68:71],v[32:35],a[132:135]
TR v[50:51],v6,512
MM v[68:71],v[36:39],a[148:151]
MM v[72:75],v[32:35],a[136:139]
TR v[52:53],v6,4096
MM v[72:75],v[36:39],a[152:155]
buffer_load_dwordx4 a[192:195], v2, s[52:55], s76 offen offset:0 sc1
MM v[76:79],v[32:35],a[140:143]
TR v[54:55],v6,4608
MM v[76:79],v[36:39],a[156:159]
s_waitcnt lgkmcnt(4)
MM v[80:83],v[40:43],a[128:131]
TR v[56:57],v7,0
MM v[80:83],v[44:47],a[144:147]
MM v[84:87],v[40:43],a[132:135]
TR v[58:59],v7,512
MM v[84:87],v[44:47],a[148:151]
buffer_load_dwordx4 a[196:199], v2, s[52:55], s76 offen offset:1024 sc1
MM v[88:91],v[40:43],a[136:139]
TR v[60:61],v7,4096
MM v[88:91],v[44:47],a[152:155]
MM v[92:95],v[40:43],a[140:143]
TR v[62:63],v7,4608
MM v[92:95],v[44:47],a[156:159]
s_waitcnt lgkmcnt(4)
MM v[96:99],v[48:51],a[128:131]
TR v[32:33],v4,32768
MM v[96:99],v[52:55],a[144:147]
MM v[100:103],v[48:51],a[132:135]
TR v[34:35],v4,33280
MM v[100:103],v[52:55],a[148:151]
buffer_load_dwordx4 a[200:203], v2, s[52:55], s76 offen offset:2048 sc1
MM v[104:107],v[48:51],a[136:139]
TR v[36:37],v4,36864
MM v[104:107],v[52:55],a[152:155]
MM v[108:111],v[48:51],a[140:143]
TR v[38:39],v4,37376
MM v[108:111],v[52:55],a[156:159]
s_waitcnt lgkmcnt(4)
MM v[112:115],v[56:59],a[128:131]
TR v[40:41],v5,32768
MM v[112:115],v[60:63],a[144:147]
MM v[116:119],v[56:59],a[132:135]
TR v[42:43],v5,33280
MM v[116:119],v[60:63],a[148:151]
buffer_load_dwordx4 a[204:207], v2, s[52:55], s76 offen offset:3072 sc1
MM v[120:123],v[56:59],a[136:139]
TR v[44:45],v5,36864
MM v[120:123],v[60:63],a[152:155]
MM v[124:127],v[56:59],a[140:143]
TR v[46:47],v5,37376
MM v[124:127],v[60:63],a[156:159]
s_waitcnt lgkmcnt(4)
MM a[0:3],v[32:35],a[128:131]
TR v[48:49],v6,32768
MM a[0:3],v[36:39],a[144:147]
MM a[4:7],v[32:35],a[132:135]
TR v[50:51],v6,33280
MM a[4:7],v[36:39],a[148:151]
buffer_load_dwordx4 a[208:211], v19, s[52:55], s76 offen offset:0 sc1
MM a[8:11],v[32:35],a[136:139]
TR v[52:53],v6,36864
MM a[8:11],v[36:39],a[152:155]
MM a[12:15],v[32:35],a[140:143]
TR v[54:55],v6,37376
MM a[12:15],v[36:39],a[156:159]
s_waitcnt lgkmcnt(4)
MM a[16:19],v[40:43],a[128:131]
TR v[56:57],v7,32768
MM a[16:19],v[44:47],a[144:147]
MM a[20:23],v[40:43],a[132:135]
TR v[58:59],v7,33280
MM a[20:23],v[44:47],a[148:151]
buffer_load_dwordx4 a[212:215], v19, s[52:55], s76 offen offset:1024 sc1
MM a[24:27],v[40:43],a[136:139]
TR v[60:61],v7,36864
MM a[24:27],v[44:47],a[152:155]
MM a[28:31],v[40:43],a[140:143]
TR v[62:63],v7,37376
MM a[28:31],v[44:47],a[156:159]
s_waitcnt lgkmcnt(4)
MM a[32:35],v[48:51],a[128:131]
TR v[32:33],v8,0
MM a[32:35],v[52:55],a[144:147]
MM a[36:39],v[48:51],a[132:135]
TR v[34:35],v8,512
MM a[36:39],v[52:55],a[148:151]
buffer_load_dwordx4 a[216:219], v19, s[52:55], s76 offen offset:2048 sc1
MM a[40:43],v[48:51],a[136:139]
TR v[36:37],v8,4096
MM a[40:43],v[52:55],a[152:155]
MM a[44:47],v[48:51],a[140:143]
TR v[38:39],v8,4608
MM a[44:47],v[52:55],a[156:159]
s_waitcnt lgkmcnt(4)
MM a[48:51],v[56:59],a[128:131]
TR v[40:41],v9,0
MM a[48:51],v[60:63],a[144:147]
MM a[52:55],v[56:59],a[132:135]
TR v[42:43],v9,512
MM a[52:55],v[60:63],a[148:151]
buffer_load_dwordx4 a[220:223], v19, s[52:55], s76 offen offset:3072 sc1
MM a[56:59],v[56:59],a[136:139]
TR v[44:45],v9,4096
MM a[56:59],v[60:63],a[152:155]
MM a[60:63],v[56:59],a[140:143]
TR v[46:47],v9,4608
MM a[60:63],v[60:63],a[156:159]
s_waitcnt lgkmcnt(4)
MM v[128:131],v[32:35],a[128:131]
TR v[48:49],v10,0
MM v[128:131],v[36:39],a[144:147]
MM v[132:135],v[32:35],a[132:135]
TR v[50:51],v10,512
s_add_u32 m0, s78, 24576
MM v[132:135],v[36:39],a[148:151]
buffer_load_dwordx4 v17, s[32:35], s74 offen nt lds
MM v[136:139],v[32:35],a[136:139]
TR v[52:53],v10,4096
MM v[136:139],v[36:39],a[152:155]
MM v[140:143],v[32:35],a[140:143]
TR v[54:55],v10,4608
MM v[140:143],v[36:39],a[156:159]
s_waitcnt lgkmcnt(4)
MM v[144:147],v[40:43],a[128:131]
TR v[56:57],v11,0
s_add_u32 m0, s78, 28672
MM v[144:147],v[44:47],a[144:147]
buffer_load_dwordx4 v17, s[32:35], s75 offen nt lds
MM v[148:151],v[40:43],a[132:135]
TR v[58:59],v11,512
MM v[148:151],v[44:47],a[148:151]
MM v[152:155],v[40:43],a[136:139]
TR v[60:61],v11,4096
MM v[152:155],v[44:47],a[152:155]
MM v[156:159],v[40:43],a[140:143]
TR v[62:63],v11,4608
MM v[156:159],v[44:47],a[156:159]
s_waitcnt lgkmcnt(4)
MM v[160:163],v[48:51],a[128:131]
TR v[32:33],v8,32768
s_add_u32 m0, s78, 57344
MM v[160:163],v[52:55],a[144:147]
buffer_load_dwordx4 v17, s[36:39], s74 offen nt lds
MM v[164:167],v[48:51],a[132:135]
TR v[34:35],v8,33280
MM v[164:167],v[52:55],a[148:151]
MM v[168:171],v[48:51],a[136:139]
TR v[36:37],v8,36864
MM v[168:171],v[52:55],a[152:155]
MM v[172:175],v[48:51],a[140:143]
TR v[38:39],v8,37376
MM v[172:175],v[52:55],a[156:159]
s_waitcnt lgkmcnt(4)
MM v[176:179],v[56:59],a[128:131]
TR v[40:41],v9,32768
s_add_u32 m0, s78, 61440
MM v[176:179],v[60:63],a[144:147]
buffer_load_dwordx4 v17, s[36:39], s75 offen nt lds
MM v[180:183],v[56:59],a[132:135]
TR v[42:43],v9,33280
MM v[180:183],v[60:63],a[148:151]
MM v[184:187],v[56:59],a[136:139]
TR v[44:45],v9,36864
MM v[184:187],v[60:63],a[152:155]
MM v[188:191],v[56:59],a[140:143]
TR v[46:47],v9,37376
MM v[188:191],v[60:63],a[156:159]
s_waitcnt lgkmcnt(4)
MM v[192:195],v[32:35],a[128:131]
TR v[48:49],v10,32768
s_add_u32 m0, s78, 90112
MM v[192:195],v[36:39],a[144:147]
buffer_load_dwordx4 v16, s[40:43], s72 offen nt lds
MM v[196:199],v[32:35],a[132:135]
TR v[50:51],v10,33280
MM v[196:199],v[36:39],a[148:151]
MM v[200:203],v[32:35],a[136:139]
TR v[52:53],v10,36864
MM v[200:203],v[36:39],a[152:155]
MM v[204:207],v[32:35],a[140:143]
TR v[54:55],v10,37376
MM v[204:207],v[36:39],a[156:159]
s_waitcnt lgkmcnt(4)
MM v[208:211],v[40:43],a[128:131]
TR v[56:57],v11,32768
s_add_u32 m0, s78, 94208
MM v[208:211],v[44:47],a[144:147]
buffer_load_dwordx4 v16, s[40:43], s73 offen nt lds
MM v[212:215],v[40:43],a[132:135]
TR v[58:59],v11,33280
MM v[212:215],v[44:47],a[148:151]
MM v[216:219],v[40:43],a[136:139]
TR v[60:61],v11,36864
MM v[216:219],v[44:47],a[152:155]
MM v[220:223],v[40:43],a[140:143]
TR v[62:63],v11,37376
MM v[220:223],v[44:47],a[156:159]
s_waitcnt lgkmcnt(4)
MM v[224:227],v[48:51],a[128:131]
TR v[32:33],v12,0
s_add_u32 m0, s78, 122880
MM v[224:227],v[52:55],a[144:147]
buffer_load_dwordx4 v17, s[44:47], s74 offen nt lds
MM v[228:231],v[48:51],a[132:135]
TR v[34:35],v12,512
MM v[228:231],v[52:55],a[148:151]
MM v[232:235],v[48:51],a[136:139]
TR v[36:37],v12,4096
MM v[232:235],v[52:55],a[152:155]
MM v[236:239],v[48:51],a[140:143]
TR v[38:39],v12,4608
MM v[236:239],v[52:55],a[156:159]
s_waitcnt lgkmcnt(4)
MM v[240:243],v[56:59],a[128:131]
TR v[40:41],v13,0
s_add_u32 m0, s78, 126976
MM v[240:243],v[60:63],a[144:147]
buffer_load_dwordx4 v17, s[44:47], s75 offen nt lds
MM v[244:247],v[56:59],a[132:135]
TR v[42:43],v13,512
MM v[244:247],v[60:63],a[148:151]
MM v[248:251],v[56:59],a[136:139]
TR v[44:45],v13,4096
MM v[248:251],v[60:63],a[152:155]
MM v[252:255],v[56:59],a[140:143]
TR v[46:47],v13,4608
MM v[252:255],v[60:63],a[156:159]
s_waitcnt lgkmcnt(4)
MM a[64:67],v[32:35],a[128:131]
TR v[48:49],v14,0
s_add_u32 m0, s78, 155648
MM a[64:67],v[36:39],a[144:147]
buffer_load_dwordx4 v17, s[48:51], s74 offen nt lds
MM a[68:71],v[32:35],a[132:135]
TR v[50:51],v14,512
MM a[68:71],v[36:39],a[148:151]
MM a[72:75],v[32:35],a[136:139]
TR v[52:53],v14,4096
MM a[72:75],v[36:39],a[152:155]
MM a[76:79],v[32:35],a[140:143]
TR v[54:55],v14,4608
MM a[76:79],v[36:39],a[156:159]
s_waitcnt lgkmcnt(4)
MM a[80:83],v[40:43],a[128:131]
TR v[56:57],v15,0
s_add_u32 m0, s78, 159744
MM a[80:83],v[44:47],a[144:147]
buffer_load_dwordx4 v17, s[48:51], s75 offen nt lds
MM a[84:87],v[40:43],a[132:135]
TR v[58:59],v15,512
MM a[84:87],v[44:47],a[148:151]
MM a[88:91],v[40:43],a[136:139]
TR v[60:61],v15,4096
MM a[88:91],v[44:47],a[152:155]
MM a[92:95],v[40:43],a[140:143]
TR v[62:63],v15,4608
MM a[92:95],v[44:47],a[156:159]
s_waitcnt lgkmcnt(4)
MM a[96:99],v[48:51],a[128:131]
MM a[96:99],v[52:55],a[144:147]
s_waitcnt vmcnt(19) lgkmcnt(0)
s_barrier
MM a[100:103],v[48:51],a[132:135]
TR v[32:33],v4,8192
MM a[100:103],v[52:55],a[148:151]
TR v[34:35],v4,8704
MM a[104:107],v[48:51],a[136:139]
TR v[36:37],v4,12288
MM a[104:107],v[52:55],a[152:155]
TR v[38:39],v4,12800
MM a[108:111],v[48:51],a[140:143]
MM a[108:111],v[52:55],a[156:159]
MM a[112:115],v[56:59],a[128:131]
TR v[40:41],v5,8192
MM a[112:115],v[60:63],a[144:147]
s_add_u32 s72, s72, 393216
s_add_u32 s73, s73, 393216
MM a[116:119],v[56:59],a[132:135]
TR v[42:43],v5,8704
MM a[116:119],v[60:63],a[148:151]
s_add_u32 s74, s74, 458752
s_add_u32 s75, s75, 458752
MM a[120:123],v[56:59],a[136:139]
TR v[44:45],v5,12288
MM a[120:123],v[60:63],a[152:155]
s_add_u32 s76, s76, 8192
MM a[124:127],v[56:59],a[140:143]
TR v[46:47],v5,12800
MM a[124:127],v[60:63],a[156:159]
s_waitcnt lgkmcnt(4)
L1Q_s1:
MM v[64:67],v[32:35],a[160:163]
TR v[48:49],v6,8192
MM v[64:67],v[36:39],a[176:179]
buffer_load_dwordx4 v[20:23], v2, s[64:67], s81 offen
s_add_u32 s81, s81, 0x100000
MM v[68:71],v[32:35],a[164:167]
TR v[50:51],v6,8704
MM v[68:71],v[36:39],a[180:183]
global_load_dwordx4 v[24:27], v[28:29], off
MM v[72:75],v[32:35],a[168:171]
TR v[52:53],v6,12288
MM v[72:75],v[36:39],a[184:187]
MM v[76:79],v[32:35],a[172:175]
TR v[54:55],v6,12800
MM v[76:79],v[36:39],a[188:191]
s_waitcnt lgkmcnt(4)
buffer_load_dwordx4 a[224:227], v2, s[52:55], s76 offen offset:0 sc1
MM v[80:83],v[40:43],a[160:163]
TR v[56:57],v7,8192
MM v[80:83],v[44:47],a[176:179]
MM v[84:87],v[40:43],a[164:167]
TR v[58:59],v7,8704
MM v[84:87],v[44:47],a[180:183]
MM v[88:91],v[40:43],a[168:171]
TR v[60:61],v7,12288
MM v[88:91],v[44:47],a[184:187]
buffer_load_dwordx4 a[228:231], v2, s[52:55], s76 offen offset:1024 sc1
MM v[92:95],v[40:43],a[172:175]
TR v[62:63],v7,12800
MM v[92:95],v[44:47],a[188:191]
s_waitcnt lgkmcnt(4)
MM v[96:99],v[48:51],a[160:163]
TR v[32:33],v4,40960
MM v[96:99],v[52:55],a[176:179]
MM v[100:103],v[48:51],a[164:167]
TR v[34:35],v4,41472
MM v[100:103],v[52:55],a[180:183]
MM v[104:107],v[48:51],a[168:171]
TR v[36:37],v4,45056
MM v[104:107],v[52:55],a[184:187]
buffer_load_dwordx4 a[232:235], v2, s[52:55], s76 offen offset:2048 sc1
MM v[108:111],v[48:51],a[172:175]
TR v[38:39],v4,45568
MM v[108:111],v[52:55],a[188:191]
s_waitcnt lgkmcnt(4)
MM v[112:115],v[56:59],a[160:163]
TR v[40:41],v5,40960
MM v[112:115],v[60:63],a[176:179]
MM v[116:119],v[56:59],a[164:167]
TR v[42:43],v5,41472
MM v[116:119],v[60:63],a[180:183]
MM v[120:123],v[56:59],a[168:171]
TR v[44:45],v5,45056
MM v[120:123],v[60:63],a[184:187]
buffer_load_dwordx4 a[236:239], v2, s[52:55], s76 offen offset:3072 sc1
MM v[124:127],v[56:59],a[172:175]
TR v[46:47],v5,45568
MM v[124:127],v[60:63],a[188:191]
s_waitcnt lgkmcnt(4)
MM a[0:3],v[32:35],a[160:163]
TR v[48:49],v6,40960
MM a[0:3],v[36:39],a[176:179]
MM a[4:7],v[32:35],a[164:167]
TR v[50:51],v6,41472
MM a[4:7],v[36:39],a[180:183]
MM a[8:11],v[32:35],a[168:171]
TR v[52:53],v6,45056
MM a[8:11],v[36:39],a[184:187]
buffer_load_dwordx4 a[240:243], v19, s[52:55], s76 offen offset:0 sc1
MM a[12:15],v[32:35],a[172:175]
TR v[54:55],v6,45568
MM a[12:15],v[36:39],a[188:191]
s_waitcnt lgkmcnt(4)
MM a[16:19],v[40:43],a[160:163]
TR v[56:57],v7,40960
MM a[16:19],v[44:47],a[176:179]
MM a[20:23],v[40:43],a[164:167]
TR v[58:59],v7,41472
MM a[20:23],v[44:47],a[180:183]
buffer_load_dwordx4 a[244:247], v19, s[52:55], s76 offen offset:1024 sc1
MM a[24:27],v[40:43],a[168:171]
TR v[60:61],v7,45056
MM a[24:27],v[44:47],a[184:187]
MM a[28:31],v[40:43],a[172:175]
TR v[62:63],v7,45568
MM a[28:31],v[44:47],a[188:191]
s_waitcnt lgkmcnt(4)
MM a[32:35],v[48:51],a[160:163]
TR v[32:33],v8,8192
MM a[32:35],v[52:55],a[176:179]
MM a[36:39],v[48:51],a[164:167]
TR v[34:35],v8,8704
MM a[36:39],v[52:55],a[180:183]
buffer_load_dwordx4 a[248:251], v19, s[52:55], s76 offen offset:2048 sc1
MM a[40:43],v[48:51],a[168:171]
TR v[36:37],v8,12288
MM a[40:43],v[52:55],a[184:187]
MM a[44:47],v[48:51],a[172:175]
TR v[38:39],v8,12800
MM a[44:47],v[52:55],a[188:191]
s_waitcnt lgkmcnt(4)
MM a[48:51],v[56:59],a[160:163]
TR v[40:41],v9,8192
MM a[48:51],v[60:63],a[176:179]
MM a[52:55],v[56:59],a[164:167]
TR v[42:43],v9,8704
MM a[52:55],v[60:63],a[180:183]
buffer_load_dwordx4 a[252:255], v19, s[52:55], s76 offen offset:3072 sc1
MM a[56:59],v[56:59],a[168:171]
TR v[44:45],v9,12288
MM a[56:59],v[60:63],a[184:187]
MM a[60:63],v[56:59],a[172:175]
TR v[46:47],v9,12800
MM a[60:63],v[60:63],a[188:191]
s_waitcnt lgkmcnt(4)
MM v[128:131],v[32:35],a[160:163]
TR v[48:49],v10,8192
MM v[128:131],v[36:39],a[176:179]
MM v[132:135],v[32:35],a[164:167]
TR v[50:51],v10,8704
s_add_u32 m0, s78, 0
MM v[132:135],v[36:39],a[180:183]
buffer_load_dwordx4 v17, s[32:35], s74 offen nt lds
MM v[136:139],v[32:35],a[168:171]
TR v[52:53],v10,12288
MM v[136:139],v[36:39],a[184:187]
MM v[140:143],v[32:35],a[172:175]
TR v[54:55],v10,12800
MM v[140:143],v[36:39],a[188:191]
s_waitcnt lgkmcnt(4)
MM v[144:147],v[40:43],a[160:163]
TR v[56:57],v11,8192
s_add_u32 m0, s78, 4096
MM v[144:147],v[44:47],a[176:179]
buffer_load_dwordx4 v17, s[32:35], s75 offen nt lds
MM v[148:151],v[40:43],a[164:167]
TR v[58:59],v11,8704
MM v[148:151],v[44:47],a[180:183]
MM v[152:155],v[40:43],a[168:171]
TR v[60:61],v11,12288
MM v[152:155],v[44:47],a[184:187]
MM v[156:159],v[40:43],a[172:175]
TR v[62:63],v11,12800
MM v[156:159],v[44:47],a[188:191]
s_waitcnt lgkmcnt(4)
MM v[160:163],v[48:51],a[160:163]
TR v[32:33],v8,40960
s_add_u32 m0, s78, 32768
MM v[160:163],v[52:55],a[176:179]
buffer_load_dwordx4 v17, s[36:39], s74 offen nt lds
MM v[164:167],v[48:51],a[164:167]
TR v[34:35],v8,41472
MM v[164:167],v[52:55],a[180:183]
MM v[168:171],v[48:51],a[168:171]
TR v[36:37],v8,45056
MM v[168:171],v[52:55],a[184:187]
MM v[172:175],v[48:51],a[172:175]
TR v[38:39],v8,45568
MM v[172:175],v[52:55],a[188:191]
s_waitcnt lgkmcnt(4)
MM v[176:179],v[56:59],a[160:163]
TR v[40:41],v9,40960
s_add_u32 m0, s78, 36864
MM v[176:179],v[60:63],a[176:179]
buffer_load_dwordx4 v17, s[36:39], s75 offen nt lds
MM v[180:183],v[56:59],a[164:167]
TR v[42:43],v9,41472
MM v[180:183],v[60:63],a[180:183]
MM v[184:187],v[56:59],a[168:171]
TR v[44:45],v9,45056
MM v[184:187],v[60:63],a[184:187]
MM v[188:191],v[56:59],a[172:175]
TR v[46:47],v9,45568
MM v[188:191],v[60:63],a[188:191]
s_waitcnt lgkmcnt(4)
MM v[192:195],v[32:35],a[160:163]
TR v[48:49],v10,40960
s_add_u32 m0, s78, 65536
MM v[192:195],v[36:39],a[176:179]
buffer_load_dwordx4 v16, s[40:43], s72 offen nt lds
MM v[196:199],v[32:35],a[164:167]
TR v[50:51],v10,41472
MM v[196:199],v[36:39],a[180:183]
MM v[200:203],v[32:35],a[168:171]
TR v[52:53],v10,45056
MM v[200:203],v[36:39],a[184:187]
MM v[204:207],v[32:35],a[172:175]
TR v[54:55],v10,45568
MM v[204:207],v[36:39],a[188:191]
s_waitcnt lgkmcnt(4)
MM v[208:211],v[40:43],a[160:163]
TR v[56:57],v11,40960
s_add_u32 m0, s78, 69632
MM v[208:211],v[44:47],a[176:179]
buffer_load_dwordx4 v16, s[40:43], s73 offen nt lds
MM v[212:215],v[40:43],a[164:167]
TR v[58:59],v11,41472
MM v[212:215],v[44:47],a[180:183]
MM v[216:219],v[40:43],a[168:171]
TR v[60:61],v11,45056
MM v[216:219],v[44:47],a[184:187]
MM v[220:223],v[40:43],a[172:175]
TR v[62:63],v11,45568
MM v[220:223],v[44:47],a[188:191]
s_waitcnt lgkmcnt(4)
MM v[224:227],v[48:51],a[160:163]
TR v[32:33],v12,8192
s_add_u32 m0, s78, 98304
MM v[224:227],v[52:55],a[176:179]
buffer_load_dwordx4 v17, s[44:47], s74 offen nt lds
MM v[228:231],v[48:51],a[164:167]
TR v[34:35],v12,8704
MM v[228:231],v[52:55],a[180:183]
MM v[232:235],v[48:51],a[168:171]
TR v[36:37],v12,12288
MM v[232:235],v[52:55],a[184:187]
MM v[236:239],v[48:51],a[172:175]
TR v[38:39],v12,12800
MM v[236:239],v[52:55],a[188:191]
s_waitcnt lgkmcnt(4)
MM v[240:243],v[56:59],a[160:163]
TR v[40:41],v13,8192
s_add_u32 m0, s78, 102400
MM v[240:243],v[60:63],a[176:179]
buffer_load_dwordx4 v17, s[44:47], s75 offen nt lds
MM v[244:247],v[56:59],a[164:167]
TR v[42:43],v13,8704
MM v[244:247],v[60:63],a[180:183]
MM v[248:251],v[56:59],a[168:171]
TR v[44:45],v13,12288
MM v[248:251],v[60:63],a[184:187]
MM v[252:255],v[56:59],a[172:175]
TR v[46:47],v13,12800
MM v[252:255],v[60:63],a[188:191]
s_waitcnt lgkmcnt(4)
MM a[64:67],v[32:35],a[160:163]
TR v[48:49],v14,8192
s_add_u32 m0, s78, 131072
MM a[64:67],v[36:39],a[176:179]
buffer_load_dwordx4 v17, s[48:51], s74 offen nt lds
MM a[68:71],v[32:35],a[164:167]
TR v[50:51],v14,8704
MM a[68:71],v[36:39],a[180:183]
MM a[72:75],v[32:35],a[168:171]
TR v[52:53],v14,12288
MM a[72:75],v[36:39],a[184:187]
MM a[76:79],v[32:35],a[172:175]
TR v[54:55],v14,12800
MM a[76:79],v[36:39],a[188:191]
s_waitcnt lgkmcnt(4)
MM a[80:83],v[40:43],a[160:163]
TR v[56:57],v15,8192
s_add_u32 m0, s78, 135168
MM a[80:83],v[44:47],a[176:179]
buffer_load_dwordx4 v17, s[48:51], s75 offen nt lds
MM a[84:87],v[40:43],a[164:167]
TR v[58:59],v15,8704
MM a[84:87],v[44:47],a[180:183]
MM a[88:91],v[40:43],a[168:171]
TR v[60:61],v15,12288
MM a[88:91],v[44:47],a[184:187]
MM a[92:95],v[40:43],a[172:175]
TR v[62:63],v15,12800
MM a[92:95],v[44:47],a[188:191]
s_waitcnt lgkmcnt(4)
MM a[96:99],v[48:51],a[160:163]
MM a[96:99],v[52:55],a[176:179]
s_waitcnt vmcnt(20) lgkmcnt(0)
s_barrier
MM a[100:103],v[48:51],a[164:167]
TR v[32:33],v4,16384
MM a[100:103],v[52:55],a[180:183]
TR v[34:35],v4,16896
MM a[104:107],v[48:51],a[168:171]
TR v[36:37],v4,20480
MM a[104:107],v[52:55],a[184:187]
TR v[38:39],v4,20992
MM a[108:111],v[48:51],a[172:175]
MM a[108:111],v[52:55],a[188:191]
MM a[112:115],v[56:59],a[160:163]
TR v[40:41],v5,16384
MM a[112:115],v[60:63],a[176:179]
s_add_u32 s72, s72, 393216
s_add_u32 s73, s73, 393216
MM a[116:119],v[56:59],a[164:167]
TR v[42:43],v5,16896
MM a[116:119],v[60:63],a[180:183]
s_add_u32 s74, s74, 458752
s_add_u32 s75, s75, 458752
MM a[120:123],v[56:59],a[168:171]
TR v[44:45],v5,20480
MM a[120:123],v[60:63],a[184:187]
s_add_u32 s76, s76, 8192
MM a[124:127],v[56:59],a[172:175]
TR v[46:47],v5,20992
MM a[124:127],v[60:63],a[188:191]
s_waitcnt lgkmcnt(4)
MM v[64:67],v[32:35],a[192:195]
TR v[48:49],v6,16384
MM v[64:67],v[36:39],a[208:211]
buffer_load_dwordx4 v[20:23], v2, s[64:67], s81 offen
s_add_u32 s81, s81, 0x100000
MM v[68:71],v[32:35],a[196:199]
TR v[50:51],v6,16896
MM v[68:71],v[36:39],a[212:215]
MM v[72:75],v[32:35],a[200:203]
TR v[52:53],v6,20480
MM v[72:75],v[36:39],a[216:219]
buffer_load_dwordx4 a[128:131], v2, s[52:55], s76 offen offset:0 sc1
MM v[76:79],v[32:35],a[204:207]
TR v[54:55],v6,20992
MM v[76:79],v[36:39],a[220:223]
s_waitcnt lgkmcnt(4)
MM v[80:83],v[40:43],a[192:195]
TR v[56:57],v7,16384
MM v[80:83],v[44:47],a[208:211]
MM v[84:87],v[40:43],a[196:199]
TR v[58:59],v7,16896
MM v[84:87],v[44:47],a[212:215]
buffer_load_dwordx4 a[132:135], v2, s[52:55], s76 offen offset:1024 sc1
MM v[88:91],v[40:43],a[200:203]
TR v[60:61],v7,20480
MM v[88:91],v[44:47],a[216:219]
MM v[92:95],v[40:43],a[204:207]
TR v[62:63],v7,20992
MM v[92:95],v[44:47],a[220:223]
s_waitcnt lgkmcnt(4)
MM v[96:99],v[48:51],a[192:195]
TR v[32:33],v4,49152
MM v[96:99],v[52:55],a[208:211]
MM v[100:103],v[48:51],a[196:199]
TR v[34:35],v4,49664
MM v[100:103],v[52:55],a[212:215]
buffer_load_dwordx4 a[136:139], v2, s[52:55], s76 offen offset:2048 sc1
MM v[104:107],v[48:51],a[200:203]
TR v[36:37],v4,53248
MM v[104:107],v[52:55],a[216:219]
MM v[108:111],v[48:51],a[204:207]
TR v[38:39],v4,53760
MM v[108:111],v[52:55],a[220:223]
s_waitcnt lgkmcnt(4)
MM v[112:115],v[56:59],a[192:195]
TR v[40:41],v5,49152
MM v[112:115],v[60:63],a[208:211]
MM v[116:119],v[56:59],a[196:199]
TR v[42:43],v5,49664
MM v[116:119],v[60:63],a[212:215]
buffer_load_dwordx4 a[140:143], v2, s[52:55], s76 offen offset:3072 sc1
MM v[120:123],v[56:59],a[200:203]
TR v[44:45],v5,53248
MM v[120:123],v[60:63],a[216:219]
MM v[124:127],v[56:59],a[204:207]
TR v[46:47],v5,53760
MM v[124:127],v[60:63],a[220:223]
s_waitcnt lgkmcnt(4)
MM a[0:3],v[32:35],a[192:195]
TR v[48:49],v6,49152
MM a[0:3],v[36:39],a[208:211]
MM a[4:7],v[32:35],a[196:199]
TR v[50:51],v6,49664
MM a[4:7],v[36:39],a[212:215]
buffer_load_dwordx4 a[144:147], v19, s[52:55], s76 offen offset:0 sc1
MM a[8:11],v[32:35],a[200:203]
TR v[52:53],v6,53248
MM a[8:11],v[36:39],a[216:219]
MM a[12:15],v[32:35],a[204:207]
TR v[54:55],v6,53760
MM a[12:15],v[36:39],a[220:223]
s_waitcnt lgkmcnt(4)
MM a[16:19],v[40:43],a[192:195]
TR v[56:57],v7,49152
MM a[16:19],v[44:47],a[208:211]
MM a[20:23],v[40:43],a[196:199]
TR v[58:59],v7,49664
MM a[20:23],v[44:47],a[212:215]
buffer_load_dwordx4 a[148:151], v19, s[52:55], s76 offen offset:1024 sc1
MM a[24:27],v[40:43],a[200:203]
TR v[60:61],v7,53248
MM a[24:27],v[44:47],a[216:219]
MM a[28:31],v[40:43],a[204:207]
TR v[62:63],v7,53760
MM a[28:31],v[44:47],a[220:223]
s_waitcnt lgkmcnt(4)
MM a[32:35],v[48:51],a[192:195]
TR v[32:33],v8,16384
MM a[32:35],v[52:55],a[208:211]
MM a[36:39],v[48:51],a[196:199]
TR v[34:35],v8,16896
MM a[36:39],v[52:55],a[212:215]
buffer_load_dwordx4 a[152:155], v19, s[52:55], s76 offen offset:2048 sc1
MM a[40:43],v[48:51],a[200:203]
TR v[36:37],v8,20480
MM a[40:43],v[52:55],a[216:219]
MM a[44:47],v[48:51],a[204:207]
TR v[38:39],v8,20992
MM a[44:47],v[52:55],a[220:223]
s_waitcnt lgkmcnt(4)
MM a[48:51],v[56:59],a[192:195]
TR v[40:41],v9,16384
MM a[48:51],v[60:63],a[208:211]
MM a[52:55],v[56:59],a[196:199]
TR v[42:43],v9,16896
MM a[52:55],v[60:63],a[212:215]
buffer_load_dwordx4 a[156:159], v19, s[52:55], s76 offen offset:3072 sc1
MM a[56:59],v[56:59],a[200:203]
TR v[44:45],v9,20480
MM a[56:59],v[60:63],a[216:219]
MM a[60:63],v[56:59],a[204:207]
TR v[46:47],v9,20992
MM a[60:63],v[60:63],a[220:223]
s_waitcnt lgkmcnt(4)
MM v[128:131],v[32:35],a[192:195]
TR v[48:49],v10,16384
MM v[128:131],v[36:39],a[208:211]
MM v[132:135],v[32:35],a[196:199]
TR v[50:51],v10,16896
s_add_u32 m0, s78, 8192
MM v[132:135],v[36:39],a[212:215]
buffer_load_dwordx4 v17, s[32:35], s74 offen nt lds
MM v[136:139],v[32:35],a[200:203]
TR v[52:53],v10,20480
MM v[136:139],v[36:39],a[216:219]
MM v[140:143],v[32:35],a[204:207]
TR v[54:55],v10,20992
MM v[140:143],v[36:39],a[220:223]
s_waitcnt lgkmcnt(4)
MM v[144:147],v[40:43],a[192:195]
TR v[56:57],v11,16384
s_add_u32 m0, s78, 12288
MM v[144:147],v[44:47],a[208:211]
buffer_load_dwordx4 v17, s[32:35], s75 offen nt lds
MM v[148:151],v[40:43],a[196:199]
TR v[58:59],v11,16896
MM v[148:151],v[44:47],a[212:215]
MM v[152:155],v[40:43],a[200:203]
TR v[60:61],v11,20480
MM v[152:155],v[44:47],a[216:219]
MM v[156:159],v[40:43],a[204:207]
TR v[62:63],v11,20992
MM v[156:159],v[44:47],a[220:223]
s_waitcnt lgkmcnt(4)
MM v[160:163],v[48:51],a[192:195]
TR v[32:33],v8,49152
s_add_u32 m0, s78, 40960
MM v[160:163],v[52:55],a[208:211]
buffer_load_dwordx4 v17, s[36:39], s74 offen nt lds
MM v[164:167],v[48:51],a[196:199]
TR v[34:35],v8,49664
MM v[164:167],v[52:55],a[212:215]
MM v[168:171],v[48:51],a[200:203]
TR v[36:37],v8,53248
MM v[168:171],v[52:55],a[216:219]
MM v[172:175],v[48:51],a[204:207]
TR v[38:39],v8,53760
MM v[172:175],v[52:55],a[220:223]
s_waitcnt lgkmcnt(4)
MM v[176:179],v[56:59],a[192:195]
TR v[40:41],v9,49152
s_add_u32 m0, s78, 45056
MM v[176:179],v[60:63],a[208:211]
buffer_load_dwordx4 v17, s[36:39], s75 offen nt lds
MM v[180:183],v[56:59],a[196:199]
TR v[42:43],v9,49664
MM v[180:183],v[60:63],a[212:215]
MM v[184:187],v[56:59],a[200:203]
TR v[44:45],v9,53248
MM v[184:187],v[60:63],a[216:219]
MM v[188:191],v[56:59],a[204:207]
TR v[46:47],v9,53760
MM v[188:191],v[60:63],a[220:223]
s_waitcnt lgkmcnt(4)
MM v[192:195],v[32:35],a[192:195]
TR v[48:49],v10,49152
s_add_u32 m0, s78, 73728
MM v[192:195],v[36:39],a[208:211]
buffer_load_dwordx4 v16, s[40:43], s72 offen nt lds
MM v[196:199],v[32:35],a[196:199]
TR v[50:51],v10,49664
MM v[196:199],v[36:39],a[212:215]
MM v[200:203],v[32:35],a[200:203]
TR v[52:53],v10,53248
MM v[200:203],v[36:39],a[216:219]
MM v[204:207],v[32:35],a[204:207]
TR v[54:55],v10,53760
MM v[204:207],v[36:39],a[220:223]
s_waitcnt lgkmcnt(4)
MM v[208:211],v[40:43],a[192:195]
TR v[56:57],v11,49152
s_add_u32 m0, s78, 77824
MM v[208:211],v[44:47],a[208:211]
buffer_load_dwordx4 v16, s[40:43], s73 offen nt lds
MM v[212:215],v[40:43],a[196:199]
TR v[58:59],v11,49664
MM v[212:215],v[44:47],a[212:215]
MM v[216:219],v[40:43],a[200:203]
TR v[60:61],v11,53248
MM v[216:219],v[44:47],a[216:219]
MM v[220:223],v[40:43],a[204:207]
TR v[62:63],v11,53760
MM v[220:223],v[44:47],a[220:223]
s_waitcnt lgkmcnt(4)
MM v[224:227],v[48:51],a[192:195]
TR v[32:33],v12,16384
s_add_u32 m0, s78, 106496
MM v[224:227],v[52:55],a[208:211]
buffer_load_dwordx4 v17, s[44:47], s74 offen nt lds
MM v[228:231],v[48:51],a[196:199]
TR v[34:35],v12,16896
MM v[228:231],v[52:55],a[212:215]
MM v[232:235],v[48:51],a[200:203]
TR v[36:37],v12,20480
MM v[232:235],v[52:55],a[216:219]
MM v[236:239],v[48:51],a[204:207]
TR v[38:39],v12,20992
MM v[236:239],v[52:55],a[220:223]
s_waitcnt lgkmcnt(4)
MM v[240:243],v[56:59],a[192:195]
TR v[40:41],v13,16384
s_add_u32 m0, s78, 110592
MM v[240:243],v[60:63],a[208:211]
buffer_load_dwordx4 v17, s[44:47], s75 offen nt lds
MM v[244:247],v[56:59],a[196:199]
TR v[42:43],v13,16896
MM v[244:247],v[60:63],a[212:215]
MM v[248:251],v[56:59],a[200:203]
TR v[44:45],v13,20480
MM v[248:251],v[60:63],a[216:219]
MM v[252:255],v[56:59],a[204:207]
TR v[46:47],v13,20992
MM v[252:255],v[60:63],a[220:223]
s_waitcnt lgkmcnt(4)
MM a[64:67],v[32:35],a[192:195]
TR v[48:49],v14,16384
s_add_u32 m0, s78, 139264
MM a[64:67],v[36:39],a[208:211]
buffer_load_dwordx4 v17, s[48:51], s74 offen nt lds
MM a[68:71],v[32:35],a[196:199]
TR v[50:51],v14,16896
MM a[68:71],v[36:39],a[212:215]
MM a[72:75],v[32:35],a[200:203]
TR v[52:53],v14,20480
MM a[72:75],v[36:39],a[216:219]
MM a[76:79],v[32:35],a[204:207]
TR v[54:55],v14,20992
MM a[76:79],v[36:39],a[220:223]
s_waitcnt lgkmcnt(4)
MM a[80:83],v[40:43],a[192:195]
TR v[56:57],v15,16384
s_add_u32 m0, s78, 143360
MM a[80:83],v[44:47],a[208:211]
buffer_load_dwordx4 v17, s[48:51], s75 offen nt lds
MM a[84:87],v[40:43],a[196:199]
TR v[58:59],v15,16896
MM a[84:87],v[44:47],a[212:215]
MM a[88:91],v[40:43],a[200:203]
TR v[60:61],v15,20480
MM a[88:91],v[44:47],a[216:219]
MM a[92:95],v[40:43],a[204:207]
TR v[62:63],v15,20992
MM a[92:95],v[44:47],a[220:223]
s_waitcnt lgkmcnt(4)
MM a[96:99],v[48:51],a[192:195]
MM a[96:99],v[52:55],a[208:211]
s_waitcnt vmcnt(19) lgkmcnt(0)
s_barrier
MM a[100:103],v[48:51],a[196:199]
TR v[32:33],v4,24576
MM a[100:103],v[52:55],a[212:215]
TR v[34:35],v4,25088
MM a[104:107],v[48:51],a[200:203]
TR v[36:37],v4,28672
MM a[104:107],v[52:55],a[216:219]
TR v[38:39],v4,29184
MM a[108:111],v[48:51],a[204:207]
MM a[108:111],v[52:55],a[220:223]
MM a[112:115],v[56:59],a[192:195]
TR v[40:41],v5,24576
MM a[112:115],v[60:63],a[208:211]
s_add_u32 s72, s72, 393216
s_add_u32 s73, s73, 393216
MM a[116:119],v[56:59],a[196:199]
TR v[42:43],v5,25088
MM a[116:119],v[60:63],a[212:215]
s_add_u32 s74, s74, 458752
s_add_u32 s75, s75, 458752
MM a[120:123],v[56:59],a[200:203]
TR v[44:45],v5,28672
MM a[120:123],v[60:63],a[216:219]
s_add_u32 s76, s76, 8192
MM a[124:127],v[56:59],a[204:207]
TR v[46:47],v5,29184
MM a[124:127],v[60:63],a[220:223]
s_waitcnt lgkmcnt(4)
MM v[64:67],v[32:35],a[224:227]
TR v[48:49],v6,24576
MM v[64:67],v[36:39],a[240:243]
buffer_load_dwordx4 v[20:23], v2, s[68:71], s82 offen
s_add_u32 s82, s82, 0x100000
MM v[68:71],v[32:35],a[228:231]
TR v[50:51],v6,25088
MM v[68:71],v[36:39],a[244:247]
MM v[72:75],v[32:35],a[232:235]
TR v[52:53],v6,28672
MM v[72:75],v[36:39],a[248:251]
buffer_load_dwordx4 a[160:163], v2, s[52:55], s76 offen offset:0 sc1
MM v[76:79],v[32:35],a[236:239]
TR v[54:55],v6,29184
MM v[76:79],v[36:39],a[252:255]
s_waitcnt lgkmcnt(4)
MM v[80:83],v[40:43],a[224:227]
TR v[56:57],v7,24576
MM v[80:83],v[44:47],a[240:243]
MM v[84:87],v[40:43],a[228:231]
TR v[58:59],v7,25088
MM v[84:87],v[44:47],a[244:247]
buffer_load_dwordx4 a[164:167], v2, s[52:55], s76 offen offset:1024 sc1
MM v[88:91],v[40:43],a[232:235]
TR v[60:61],v7,28672
MM v[88:91],v[44:47],a[248:251]
MM v[92:95],v[40:43],a[236:239]
TR v[62:63],v7,29184
MM v[92:95],v[44:47],a[252:255]
s_waitcnt lgkmcnt(4)
MM v[96:99],v[48:51],a[224:227]
TR v[32:33],v4,57344
MM v[96:99],v[52:55],a[240:243]
MM v[100:103],v[48:51],a[228:231]
TR v[34:35],v4,57856
MM v[100:103],v[52:55],a[244:247]
buffer_load_dwordx4 a[168:171], v2, s[52:55], s76 offen offset:2048 sc1
MM v[104:107],v[48:51],a[232:235]
TR v[36:37],v4,61440
MM v[104:107],v[52:55],a[248:251]
MM v[108:111],v[48:51],a[236:239]
TR v[38:39],v4,61952
MM v[108:111],v[52:55],a[252:255]
s_waitcnt lgkmcnt(4)
MM v[112:115],v[56:59],a[224:227]
TR v[40:41],v5,57344
MM v[112:115],v[60:63],a[240:243]
MM v[116:119],v[56:59],a[228:231]
TR v[42:43],v5,57856
MM v[116:119],v[60:63],a[244:247]
buffer_load_dwordx4 a[172:175], v2, s[52:55], s76 offen offset:3072 sc1
MM v[120:123],v[56:59],a[232:235]
TR v[44:45],v5,61440
MM v[120:123],v[60:63],a[248:251]
MM v[124:127],v[56:59],a[236:239]
TR v[46:47],v5,61952
MM v[124:127],v[60:63],a[252:255]
s_waitcnt lgkmcnt(4)
MM a[0:3],v[32:35],a[224:227]
TR v[48:49],v6,57344
MM a[0:3],v[36:39],a[240:243]
MM a[4:7],v[32:35],a[228:231]
TR v[50:51],v6,57856
MM a[4:7],v[36:39],a[244:247]
buffer_load_dwordx4 a[176:179], v19, s[52:55], s76 offen offset:0 sc1
MM a[8:11],v[32:35],a[232:235]
TR v[52:53],v6,61440
MM a[8:11],v[36:39],a[248:251]
MM a[12:15],v[32:35],a[236:239]
TR v[54:55],v6,61952
MM a[12:15],v[36:39],a[252:255]
s_waitcnt lgkmcnt(4)
MM a[16:19],v[40:43],a[224:227]
TR v[56:57],v7,57344
MM a[16:19],v[44:47],a[240:243]
MM a[20:23],v[40:43],a[228:231]
TR v[58:59],v7,57856
MM a[20:23],v[44:47],a[244:247]
buffer_load_dwordx4 a[180:183], v19, s[52:55], s76 offen offset:1024 sc1
MM a[24:27],v[40:43],a[232:235]
TR v[60:61],v7,61440
MM a[24:27],v[44:47],a[248:251]
MM a[28:31],v[40:43],a[236:239]
TR v[62:63],v7,61952
MM a[28:31],v[44:47],a[252:255]
s_waitcnt lgkmcnt(4)
MM a[32:35],v[48:51],a[224:227]
TR v[32:33],v8,24576
MM a[32:35],v[52:55],a[240:243]
MM a[36:39],v[48:51],a[228:231]
TR v[34:35],v8,25088
MM a[36:39],v[52:55],a[244:247]
buffer_load_dwordx4 a[184:187], v19, s[52:55], s76 offen offset:2048 sc1
MM a[40:43],v[48:51],a[232:235]
TR v[36:37],v8,28672
MM a[40:43],v[52:55],a[248:251]
MM a[44:47],v[48:51],a[236:239]
TR v[38:39],v8,29184
MM a[44:47],v[52:55],a[252:255]
s_waitcnt lgkmcnt(4)
MM a[48:51],v[56:59],a[224:227]
TR v[40:41],v9,24576
MM a[48:51],v[60:63],a[240:243]
MM a[52:55],v[56:59],a[228:231]
TR v[42:43],v9,25088
MM a[52:55],v[60:63],a[244:247]
buffer_load_dwordx4 a[188:191], v19, s[52:55], s76 offen offset:3072 sc1
MM a[56:59],v[56:59],a[232:235]
TR v[44:45],v9,28672
MM a[56:59],v[60:63],a[248:251]
MM a[60:63],v[56:59],a[236:239]
TR v[46:47],v9,29184
MM a[60:63],v[60:63],a[252:255]
s_waitcnt lgkmcnt(4)
MM v[128:131],v[32:35],a[224:227]
TR v[48:49],v10,24576
MM v[128:131],v[36:39],a[240:243]
MM v[132:135],v[32:35],a[228:231]
TR v[50:51],v10,25088
s_add_u32 m0, s78, 16384
MM v[132:135],v[36:39],a[244:247]
buffer_load_dwordx4 v17, s[32:35], s74 offen nt lds
MM v[136:139],v[32:35],a[232:235]
TR v[52:53],v10,28672
MM v[136:139],v[36:39],a[248:251]
MM v[140:143],v[32:35],a[236:239]
TR v[54:55],v10,29184
MM v[140:143],v[36:39],a[252:255]
s_waitcnt lgkmcnt(4)
MM v[144:147],v[40:43],a[224:227]
TR v[56:57],v11,24576
s_add_u32 m0, s78, 20480
MM v[144:147],v[44:47],a[240:243]
buffer_load_dwordx4 v17, s[32:35], s75 offen nt lds
MM v[148:151],v[40:43],a[228:231]
TR v[58:59],v11,25088
MM v[148:151],v[44:47],a[244:247]
MM v[152:155],v[40:43],a[232:235]
TR v[60:61],v11,28672
MM v[152:155],v[44:47],a[248:251]
MM v[156:159],v[40:43],a[236:239]
TR v[62:63],v11,29184
MM v[156:159],v[44:47],a[252:255]
s_waitcnt lgkmcnt(4)
MM v[160:163],v[48:51],a[224:227]
TR v[32:33],v8,57344
s_add_u32 m0, s78, 49152
MM v[160:163],v[52:55],a[240:243]
buffer_load_dwordx4 v17, s[36:39], s74 offen nt lds
MM v[164:167],v[48:51],a[228:231]
TR v[34:35],v8,57856
MM v[164:167],v[52:55],a[244:247]
MM v[168:171],v[48:51],a[232:235]
TR v[36:37],v8,61440
MM v[168:171],v[52:55],a[248:251]
MM v[172:175],v[48:51],a[236:239]
TR v[38:39],v8,61952
MM v[172:175],v[52:55],a[252:255]
s_waitcnt lgkmcnt(4)
MM v[176:179],v[56:59],a[224:227]
TR v[40:41],v9,57344
s_add_u32 m0, s78, 53248
MM v[176:179],v[60:63],a[240:243]
buffer_load_dwordx4 v17, s[36:39], s75 offen nt lds
MM v[180:183],v[56:59],a[228:231]
TR v[42:43],v9,57856
MM v[180:183],v[60:63],a[244:247]
MM v[184:187],v[56:59],a[232:235]
TR v[44:45],v9,61440
MM v[184:187],v[60:63],a[248:251]
MM v[188:191],v[56:59],a[236:239]
TR v[46:47],v9,61952
MM v[188:191],v[60:63],a[252:255]
s_waitcnt lgkmcnt(4)
MM v[192:195],v[32:35],a[224:227]
TR v[48:49],v10,57344
s_add_u32 m0, s78, 81920
MM v[192:195],v[36:39],a[240:243]
buffer_load_dwordx4 v16, s[40:43], s72 offen nt lds
MM v[196:199],v[32:35],a[228:231]
TR v[50:51],v10,57856
MM v[196:199],v[36:39],a[244:247]
MM v[200:203],v[32:35],a[232:235]
TR v[52:53],v10,61440
MM v[200:203],v[36:39],a[248:251]
MM v[204:207],v[32:35],a[236:239]
TR v[54:55],v10,61952
MM v[204:207],v[36:39],a[252:255]
s_waitcnt lgkmcnt(4)
MM v[208:211],v[40:43],a[224:227]
TR v[56:57],v11,57344
s_add_u32 m0, s78, 86016
MM v[208:211],v[44:47],a[240:243]
buffer_load_dwordx4 v16, s[40:43], s73 offen nt lds
MM v[212:215],v[40:43],a[228:231]
TR v[58:59],v11,57856
MM v[212:215],v[44:47],a[244:247]
MM v[216:219],v[40:43],a[232:235]
TR v[60:61],v11,61440
MM v[216:219],v[44:47],a[248:251]
MM v[220:223],v[40:43],a[236:239]
TR v[62:63],v11,61952
MM v[220:223],v[44:47],a[252:255]
s_waitcnt lgkmcnt(4)
MM v[224:227],v[48:51],a[224:227]
TR v[32:33],v12,24576
s_add_u32 m0, s78, 114688
MM v[224:227],v[52:55],a[240:243]
buffer_load_dwordx4 v17, s[44:47], s74 offen nt lds
MM v[228:231],v[48:51],a[228:231]
TR v[34:35],v12,25088
MM v[228:231],v[52:55],a[244:247]
MM v[232:235],v[48:51],a[232:235]
TR v[36:37],v12,28672
MM v[232:235],v[52:55],a[248:251]
MM v[236:239],v[48:51],a[236:239]
TR v[38:39],v12,29184
MM v[236:239],v[52:55],a[252:255]
s_waitcnt lgkmcnt(4)
MM v[240:243],v[56:59],a[224:227]
TR v[40:41],v13,24576
s_add_u32 m0, s78, 118784
MM v[240:243],v[60:63],a[240:243]
buffer_load_dwordx4 v17, s[44:47], s75 offen nt lds
MM v[244:247],v[56:59],a[228:231]
TR v[42:43],v13,25088
MM v[244:247],v[60:63],a[244:247]
MM v[248:251],v[56:59],a[232:235]
TR v[44:45],v13,28672
MM v[248:251],v[60:63],a[248:251]
MM v[252:255],v[56:59],a[236:239]
TR v[46:47],v13,29184
MM v[252:255],v[60:63],a[252:255]
s_waitcnt lgkmcnt(4)
MM a[64:67],v[32:35],a[224:227]
TR v[48:49],v14,24576
s_add_u32 m0, s78, 147456
MM a[64:67],v[36:39],a[240:243]
buffer_load_dwordx4 v17, s[48:51], s74 offen nt lds
MM a[68:71],v[32:35],a[228:231]
TR v[50:51],v14,25088
MM a[68:71],v[36:39],a[244:247]
MM a[72:75],v[32:35],a[232:235]
TR v[52:53],v14,28672
MM a[72:75],v[36:39],a[248:251]
MM a[76:79],v[32:35],a[236:239]
TR v[54:55],v14,29184
MM a[76:79],v[36:39],a[252:255]
s_waitcnt lgkmcnt(4)
MM a[80:83],v[40:43],a[224:227]
TR v[56:57],v15,24576
s_add_u32 m0, s78, 151552
MM a[80:83],v[44:47],a[240:243]
buffer_load_dwordx4 v17, s[48:51], s75 offen nt lds
MM a[84:87],v[40:43],a[228:231]
TR v[58:59],v15,25088
MM a[84:87],v[44:47],a[244:247]
MM a[88:91],v[40:43],a[232:235]
TR v[60:61],v15,28672
MM a[88:91],v[44:47],a[248:251]
MM a[92:95],v[40:43],a[236:239]
TR v[62:63],v15,29184
MM a[92:95],v[44:47],a[252:255]
s_waitcnt lgkmcnt(4)
MM a[96:99],v[48:51],a[224:227]
MM a[96:99],v[52:55],a[240:243]
s_waitcnt vmcnt(19) lgkmcnt(0)
s_barrier
MM a[100:103],v[48:51],a[228:231]
TR v[32:33],v4,0
MM a[100:103],v[52:55],a[244:247]
TR v[34:35],v4,512
MM a[104:107],v[48:51],a[232:235]
TR v[36:37],v4,4096
MM a[104:107],v[52:55],a[248:251]
TR v[38:39],v4,4608
MM a[108:111],v[48:51],a[236:239]
MM a[108:111],v[52:55],a[252:255]
MM a[112:115],v[56:59],a[224:227]
TR v[40:41],v5,0
MM a[112:115],v[60:63],a[240:243]
s_add_u32 s72, s72, 393216
s_add_u32 s73, s73, 393216
MM a[116:119],v[56:59],a[228:231]
TR v[42:43],v5,512
MM a[116:119],v[60:63],a[244:247]
s_add_u32 s74, s74, 458752
s_add_u32 s75, s75, 458752
MM a[120:123],v[56:59],a[232:235]
TR v[44:45],v5,4096
MM a[120:123],v[60:63],a[248:251]
s_add_u32 s76, s76, 8192
MM a[124:127],v[56:59],a[236:239]
TR v[46:47],v5,4608
MM a[124:127],v[60:63],a[252:255]
s_waitcnt lgkmcnt(4)
s_sub_u32 s80, s80, 1
s_cmp_lg_u32 s80, 0
s_cbranch_scc1 L1Q_loop
MM v[64:67],v[32:35],a[128:131]
TR v[48:49],v6,0
MM v[64:67],v[36:39],a[144:147]
MM v[68:71],v[32:35],a[132:135]
TR v[50:51],v6,512
MM v[68:71],v[36:39],a[148:151]
buffer_load_dwordx4 a[192:195], v2, s[52:55], s76 offen offset:0 sc1
MM v[72:75],v[32:35],a[136:139]
TR v[52:53],v6,4096
MM v[72:75],v[36:39],a[152:155]
MM v[76:79],v[32:35],a[140:143]
TR v[54:55],v6,4608
MM v[76:79],v[36:39],a[156:159]
s_waitcnt lgkmcnt(4)
buffer_load_dwordx4 a[196:199], v2, s[52:55], s76 offen offset:1024 sc1
MM v[80:83],v[40:43],a[128:131]
TR v[56:57],v7,0
MM v[80:83],v[44:47],a[144:147]
MM v[84:87],v[40:43],a[132:135]
TR v[58:59],v7,512
MM v[84:87],v[44:47],a[148:151]
buffer_load_dwordx4 a[200:203], v2, s[52:55], s76 offen offset:2048 sc1
MM v[88:91],v[40:43],a[136:139]
TR v[60:61],v7,4096
MM v[88:91],v[44:47],a[152:155]
MM v[92:95],v[40:43],a[140:143]
TR v[62:63],v7,4608
MM v[92:95],v[44:47],a[156:159]
s_waitcnt lgkmcnt(4)
buffer_load_dwordx4 a[204:207], v2, s[52:55], s76 offen offset:3072 sc1
MM v[96:99],v[48:51],a[128:131]
TR v[32:33],v4,32768
MM v[96:99],v[52:55],a[144:147]
MM v[100:103],v[48:51],a[132:135]
TR v[34:35],v4,33280
MM v[100:103],v[52:55],a[148:151]
buffer_load_dwordx4 a[208:211], v19, s[52:55], s76 offen offset:0 sc1
MM v[104:107],v[48:51],a[136:139]
TR v[36:37],v4,36864
MM v[104:107],v[52:55],a[152:155]
MM v[108:111],v[48:51],a[140:143]
TR v[38:39],v4,37376
MM v[108:111],v[52:55],a[156:159]
s_waitcnt lgkmcnt(4)
buffer_load_dwordx4 a[212:215], v19, s[52:55], s76 offen offset:1024 sc1
MM v[112:115],v[56:59],a[128:131]
TR v[40:41],v5,32768
MM v[112:115],v[60:63],a[144:147]
MM v[116:119],v[56:59],a[132:135]
TR v[42:43],v5,33280
MM v[116:119],v[60:63],a[148:151]
buffer_load_dwordx4 a[216:219], v19, s[52:55], s76 offen offset:2048 sc1
MM v[120:123],v[56:59],a[136:139]
TR v[44:45],v5,36864
MM v[120:123],v[60:63],a[152:155]
MM v[124:127],v[56:59],a[140:143]
TR v[46:47],v5,37376
MM v[124:127],v[60:63],a[156:159]
s_waitcnt lgkmcnt(4)
buffer_load_dwordx4 a[220:223], v19, s[52:55], s76 offen offset:3072 sc1
MM a[0:3],v[32:35],a[128:131]
TR v[48:49],v6,32768
MM a[0:3],v[36:39],a[144:147]
MM a[4:7],v[32:35],a[132:135]
TR v[50:51],v6,33280
s_add_u32 s76, s76, 8192
MM a[4:7],v[36:39],a[148:151]
buffer_load_dwordx4 a[224:227], v2, s[52:55], s76 offen offset:0 sc1
MM a[8:11],v[32:35],a[136:139]
TR v[52:53],v6,36864
MM a[8:11],v[36:39],a[152:155]
MM a[12:15],v[32:35],a[140:143]
TR v[54:55],v6,37376
MM a[12:15],v[36:39],a[156:159]
s_waitcnt lgkmcnt(4)
buffer_load_dwordx4 a[228:231], v2, s[52:55], s76 offen offset:1024 sc1
MM a[16:19],v[40:43],a[128:131]
TR v[56:57],v7,32768
MM a[16:19],v[44:47],a[144:147]
MM a[20:23],v[40:43],a[132:135]
TR v[58:59],v7,33280
MM a[20:23],v[44:47],a[148:151]
buffer_load_dwordx4 a[232:235], v2, s[52:55], s76 offen offset:2048 sc1
MM a[24:27],v[40:43],a[136:139]
TR v[60:61],v7,36864
MM a[24:27],v[44:47],a[152:155]
MM a[28:31],v[40:43],a[140:143]
TR v[62:63],v7,37376
MM a[28:31],v[44:47],a[156:159]
s_waitcnt lgkmcnt(4)
buffer_load_dwordx4 a[236:239], v2, s[52:55], s76 offen offset:3072 sc1
MM a[32:35],v[48:51],a[128:131]
TR v[32:33],v8,0
MM a[32:35],v[52:55],a[144:147]
MM a[36:39],v[48:51],a[132:135]
TR v[34:35],v8,512
MM a[36:39],v[52:55],a[148:151]
buffer_load_dwordx4 a[240:243], v19, s[52:55], s76 offen offset:0 sc1
MM a[40:43],v[48:51],a[136:139]
TR v[36:37],v8,4096
MM a[40:43],v[52:55],a[152:155]
MM a[44:47],v[48:51],a[140:143]
TR v[38:39],v8,4608
MM a[44:47],v[52:55],a[156:159]
s_waitcnt lgkmcnt(4)
buffer_load_dwordx4 a[244:247], v19, s[52:55], s76 offen offset:1024 sc1
MM a[48:51],v[56:59],a[128:131]
TR v[40:41],v9,0
MM a[48:51],v[60:63],a[144:147]
MM a[52:55],v[56:59],a[132:135]
TR v[42:43],v9,512
MM a[52:55],v[60:63],a[148:151]
buffer_load_dwordx4 a[248:251], v19, s[52:55], s76 offen offset:2048 sc1
MM a[56:59],v[56:59],a[136:139]
TR v[44:45],v9,4096
MM a[56:59],v[60:63],a[152:155]
MM a[60:63],v[56:59],a[140:143]
TR v[46:47],v9,4608
MM a[60:63],v[60:63],a[156:159]
s_waitcnt lgkmcnt(4)
buffer_load_dwordx4 a[252:255], v19, s[52:55], s76 offen offset:3072 sc1
MM v[128:131],v[32:35],a[128:131]
TR v[48:49],v10,0
MM v[128:131],v[36:39],a[144:147]
MM v[132:135],v[32:35],a[132:135]
TR v[50:51],v10,512
s_add_u32 m0, s78, 24576
MM v[132:135],v[36:39],a[148:151]
buffer_load_dwordx4 v17, s[32:35], s74 offen nt lds
MM v[136:139],v[32:35],a[136:139]
TR v[52:53],v10,4096
MM v[136:139],v[36:39],a[152:155]
MM v[140:143],v[32:35],a[140:143]
TR v[54:55],v10,4608
MM v[140:143],v[36:39],a[156:159]
s_waitcnt lgkmcnt(4)
MM v[144:147],v[40:43],a[128:131]
TR v[56:57],v11,0
s_add_u32 m0, s78, 28672
MM v[144:147],v[44:47],a[144:147]
buffer_load_dwordx4 v17, s[32:35], s75 offen nt lds
MM v[148:151],v[40:43],a[132:135]
TR v[58:59],v11,512
MM v[148:151],v[44:47],a[148:151]
MM v[152:155],v[40:43],a[136:139]
TR v[60:61],v11,4096
MM v[152:155],v[44:47],a[152:155]
MM v[156:159],v[40:43],a[140:143]
TR v[62:63],v11,4608
MM v[156:159],v[44:47],a[156:159]
s_waitcnt lgkmcnt(4)
MM v[160:163],v[48:51],a[128:131]
TR v[32:33],v8,32768
s_add_u32 m0, s78, 57344
MM v[160:163],v[52:55],a[144:147]
buffer_load_dwordx4 v17, s[36:39], s74 offen nt lds
MM v[164:167],v[48:51],a[132:135]
TR v[34:35],v8,33280
MM v[164:167],v[52:55],a[148:151]
MM v[168:171],v[48:51],a[136:139]
TR v[36:37],v8,36864
MM v[168:171],v[52:55],a[152:155]
MM v[172:175],v[48:51],a[140:143]
TR v[38:39],v8,37376
MM v[172:175],v[52:55],a[156:159]
s_waitcnt lgkmcnt(4)
MM v[176:179],v[56:59],a[128:131]
TR v[40:41],v9,32768
s_add_u32 m0, s78, 61440
MM v[176:179],v[60:63],a[144:147]
buffer_load_dwordx4 v17, s[36:39], s75 offen nt lds
MM v[180:183],v[56:59],a[132:135]
TR v[42:43],v9,33280
MM v[180:183],v[60:63],a[148:151]
MM v[184:187],v[56:59],a[136:139]
TR v[44:45],v9,36864
MM v[184:187],v[60:63],a[152:155]
MM v[188:191],v[56:59],a[140:143]
TR v[46:47],v9,37376
MM v[188:191],v[60:63],a[156:159]
s_waitcnt lgkmcnt(4)
MM v[192:195],v[32:35],a[128:131]
TR v[48:49],v10,32768
s_add_u32 m0, s78, 90112
MM v[192:195],v[36:39],a[144:147]
buffer_load_dwordx4 v16, s[40:43], s72 offen nt lds
MM v[196:199],v[32:35],a[132:135]
TR v[50:51],v10,33280
MM v[196:199],v[36:39],a[148:151]
MM v[200:203],v[32:35],a[136:139]
TR v[52:53],v10,36864
MM v[200:203],v[36:39],a[152:155]
MM v[204:207],v[32:35],a[140:143]
TR v[54:55],v10,37376
MM v[204:207],v[36:39],a[156:159]
s_waitcnt lgkmcnt(4)
MM v[208:211],v[40:43],a[128:131]
TR v[56:57],v11,32768
s_add_u32 m0, s78, 94208
MM v[208:211],v[44:47],a[144:147]
buffer_load_dwordx4 v16, s[40:43], s73 offen nt lds
MM v[212:215],v[40:43],a[132:135]
TR v[58:59],v11,33280
MM v[212:215],v[44:47],a[148:151]
MM v[216:219],v[40:43],a[136:139]
TR v[60:61],v11,36864
MM v[216:219],v[44:47],a[152:155]
MM v[220:223],v[40:43],a[140:143]
TR v[62:63],v11,37376
MM v[220:223],v[44:47],a[156:159]
s_waitcnt lgkmcnt(4)
MM v[224:227],v[48:51],a[128:131]
TR v[32:33],v12,0
s_add_u32 m0, s78, 122880
MM v[224:227],v[52:55],a[144:147]
buffer_load_dwordx4 v17, s[44:47], s74 offen nt lds
MM v[228:231],v[48:51],a[132:135]
TR v[34:35],v12,512
MM v[228:231],v[52:55],a[148:151]
MM v[232:235],v[48:51],a[136:139]
TR v[36:37],v12,4096
MM v[232:235],v[52:55],a[152:155]
MM v[236:239],v[48:51],a[140:143]
TR v[38:39],v12,4608
MM v[236:239],v[52:55],a[156:159]
s_waitcnt lgkmcnt(4)
MM v[240:243],v[56:59],a[128:131]
TR v[40:41],v13,0
s_add_u32 m0, s78, 126976
MM v[240:243],v[60:63],a[144:147]
buffer_load_dwordx4 v17, s[44:47], s75 offen nt lds
MM v[244:247],v[56:59],a[132:135]
TR v[42:43],v13,512
MM v[244:247],v[60:63],a[148:151]
MM v[248:251],v[56:59],a[136:139]
TR v[44:45],v13,4096
MM v[248:251],v[60:63],a[152:155]
MM v[252:255],v[56:59],a[140:143]
TR v[46:47],v13,4608
MM v[252:255],v[60:63],a[156:159]
s_waitcnt lgkmcnt(4)
MM a[64:67],v[32:35],a[128:131]
TR v[48:49],v14,0
s_add_u32 m0, s78, 155648
MM a[64:67],v[36:39],a[144:147]
buffer_load_dwordx4 v17, s[48:51], s74 offen nt lds
MM a[68:71],v[32:35],a[132:135]
TR v[50:51],v14,512
MM a[68:71],v[36:39],a[148:151]
MM a[72:75],v[32:35],a[136:139]
TR v[52:53],v14,4096
MM a[72:75],v[36:39],a[152:155]
MM a[76:79],v[32:35],a[140:143]
TR v[54:55],v14,4608
MM a[76:79],v[36:39],a[156:159]
s_waitcnt lgkmcnt(4)
MM a[80:83],v[40:43],a[128:131]
TR v[56:57],v15,0
s_add_u32 m0, s78, 159744
MM a[80:83],v[44:47],a[144:147]
buffer_load_dwordx4 v17, s[48:51], s75 offen nt lds
MM a[84:87],v[40:43],a[132:135]
TR v[58:59],v15,512
MM a[84:87],v[44:47],a[148:151]
MM a[88:91],v[40:43],a[136:139]
TR v[60:61],v15,4096
MM a[88:91],v[44:47],a[152:155]
MM a[92:95],v[40:43],a[140:143]
TR v[62:63],v15,4608
MM a[92:95],v[44:47],a[156:159]
s_waitcnt lgkmcnt(4)
MM a[96:99],v[48:51],a[128:131]
MM a[96:99],v[52:55],a[144:147]
s_waitcnt vmcnt(18)
s_waitcnt lgkmcnt(0)
s_barrier
MM a[100:103],v[48:51],a[132:135]
TR v[32:33],v4,8192
MM a[100:103],v[52:55],a[148:151]
TR v[34:35],v4,8704
MM a[104:107],v[48:51],a[136:139]
TR v[36:37],v4,12288
MM a[104:107],v[52:55],a[152:155]
TR v[38:39],v4,12800
MM a[108:111],v[48:51],a[140:143]
MM a[108:111],v[52:55],a[156:159]
MM a[112:115],v[56:59],a[128:131]
TR v[40:41],v4,16384
MM a[112:115],v[60:63],a[144:147]
MM a[116:119],v[56:59],a[132:135]
TR v[42:43],v4,16896
MM a[116:119],v[60:63],a[148:151]
MM a[120:123],v[56:59],a[136:139]
TR v[44:45],v4,20480
MM a[120:123],v[60:63],a[152:155]
MM a[124:127],v[56:59],a[140:143]
TR v[46:47],v4,20992
MM a[124:127],v[60:63],a[156:159]
s_waitcnt lgkmcnt(4)
MM v[64:67],v[32:35],a[160:163]
TR v[48:49],v5,8192
v_mov_b32 v16, s89
MM v[64:67],v[36:39],a[176:179]
MM v[68:71],v[32:35],a[164:167]
TR v[50:51],v5,8704
v_lshrrev_b32 v19, 4, v1
MM v[68:71],v[36:39],a[180:183]
MM v[72:75],v[32:35],a[168:171]
TR v[52:53],v5,12288
v_lshlrev_b32 v19, 4, v19
MM v[72:75],v[36:39],a[184:187]
MM v[76:79],v[32:35],a[172:175]
TR v[54:55],v5,12800
MM v[76:79],v[36:39],a[188:191]
s_waitcnt lgkmcnt(4)
s_lshl_b32 s30, s24, 11
v_add_u32 v18, s30, v2
MM v[64:67],v[40:43],a[192:195]
TR v[56:57],v5,16384
MM v[64:67],v[44:47],a[208:211]
MM v[68:71],v[40:43],a[196:199]
TR v[58:59],v5,16896
MM v[68:71],v[44:47],a[212:215]
MM v[72:75],v[40:43],a[200:203]
TR v[60:61],v5,20480
s_lshl_b32 s30, s24, 6
s_add_u32 s30, s30, 8192
v_add_u32 v19, s30, v19
MM v[72:75],v[44:47],a[216:219]
MM v[76:79],v[40:43],a[204:207]
TR v[62:63],v5,20992
MM v[76:79],v[44:47],a[220:223]
s_waitcnt lgkmcnt(4)
MM v[80:83],v[48:51],a[160:163]
TR v[32:33],v4,40960
MM v[80:83],v[52:55],a[176:179]
MM v[84:87],v[48:51],a[164:167]
TR v[34:35],v4,41472
MM v[84:87],v[52:55],a[180:183]
s_mov_b32 s52, 1.0
MM v[88:91],v[48:51],a[168:171]
TR v[36:37],v4,45056
MM v[88:91],v[52:55],a[184:187]
s_mov_b32 s53, 1.0
MM v[92:95],v[48:51],a[172:175]
TR v[38:39],v4,45568
MM v[92:95],v[52:55],a[188:191]
s_waitcnt lgkmcnt(4)
MM v[80:83],v[56:59],a[192:195]
TR v[40:41],v4,49152
MM v[80:83],v[60:63],a[208:211]
MM v[84:87],v[56:59],a[196:199]
TR v[42:43],v4,49664
MM v[84:87],v[60:63],a[212:215]
MM v[88:91],v[56:59],a[200:203]
TR v[44:45],v4,53248
MM v[88:91],v[60:63],a[216:219]
MM v[92:95],v[56:59],a[204:207]
TR v[46:47],v4,53760
MM v[92:95],v[60:63],a[220:223]
s_waitcnt lgkmcnt(4)
MM a[0:3],v[32:35],a[160:163]
TR v[48:49],v5,40960
MM a[0:3],v[36:39],a[176:179]
MM a[4:7],v[32:35],a[164:167]
TR v[50:51],v5,41472
MM a[4:7],v[36:39],a[180:183]
MM a[8:11],v[32:35],a[168:171]
TR v[52:53],v5,45056
MM a[8:11],v[36:39],a[184:187]
MM a[12:15],v[32:35],a[172:175]
TR v[54:55],v5,45568
MM a[12:15],v[36:39],a[188:191]
s_waitcnt lgkmcnt(4)
MM a[0:3],v[40:43],a[192:195]
TR v[56:57],v5,49152
MM a[0:3],v[44:47],a[208:211]
MM a[4:7],v[40:43],a[196:199]
TR v[58:59],v5,49664
MM a[4:7],v[44:47],a[212:215]
MM a[8:11],v[40:43],a[200:203]
TR v[60:61],v5,53248
MM a[8:11],v[44:47],a[216:219]
MM a[12:15],v[40:43],a[204:207]
TR v[62:63],v5,53760
MM a[12:15],v[44:47],a[220:223]
s_waitcnt vmcnt(0)
s_barrier
s_waitcnt lgkmcnt(4)
MM a[16:19],v[48:51],a[160:163]
TR v[32:33],v4,24576
MM a[16:19],v[52:55],a[176:179]
MM a[20:23],v[48:51],a[164:167]
TR v[34:35],v4,25088
v_and_b32 v24, 15, v1
MM a[20:23],v[52:55],a[180:183]
MM a[24:27],v[48:51],a[168:171]
TR v[36:37],v4,28672
v_lshlrev_b32 v24, 11, v24
MM a[24:27],v[52:55],a[184:187]
MM a[28:31],v[48:51],a[172:175]
TR v[38:39],v4,29184
v_bfe_u32 v25, v1, 4, 1
MM a[28:31],v[52:55],a[188:191]
s_waitcnt lgkmcnt(4)
MM a[16:19],v[56:59],a[192:195]
TR v[40:41],v5,24576
MM a[16:19],v[60:63],a[208:211]
v_lshl_add_u32 v24, v25, 5, v24
MM a[20:23],v[56:59],a[196:199]
TR v[42:43],v5,25088
MM a[20:23],v[60:63],a[212:215]
v_lshrrev_b32 v25, 5, v1
MM a[24:27],v[56:59],a[200:203]
TR v[44:45],v5,28672
MM a[24:27],v[60:63],a[216:219]
v_lshl_add_u32 v24, v25, 4, v24
MM a[28:31],v[56:59],a[204:207]
TR v[46:47],v5,29184
MM a[28:31],v[60:63],a[220:223]
s_waitcnt lgkmcnt(4)
MM v[64:67],v[32:35],a[224:227]
TR v[48:49],v4,57344
v_add_u32 v24, s94, v24
MM v[64:67],v[36:39],a[240:243]
MM v[68:71],v[32:35],a[228:231]
TR v[50:51],v4,57856
v_add_u32 v25, 32768, v24
MM v[68:71],v[36:39],a[244:247]
MM v[72:75],v[32:35],a[232:235]
TR v[52:53],v4,61440
global_load_dwordx4 a[128:131], v24, s[4:5] offset:0 nt
MM v[72:75],v[36:39],a[248:251]
MM v[76:79],v[32:35],a[236:239]
TR v[54:55],v4,61952
MM v[76:79],v[36:39],a[252:255]
s_waitcnt lgkmcnt(4)
global_load_dwordx4 a[136:139], v24, s[4:5] offset:64 nt
MM v[80:83],v[40:43],a[224:227]
TR v[56:57],v5,57344
MM v[80:83],v[44:47],a[240:243]
global_load_dwordx4 a[132:135], v25, s[4:5] offset:0 nt
MM v[84:87],v[40:43],a[228:231]
TR v[58:59],v5,57856
MM v[84:87],v[44:47],a[244:247]
global_load_dwordx4 a[140:143], v25, s[4:5] offset:64 nt
MM v[88:91],v[40:43],a[232:235]
TR v[60:61],v5,61440
MM v[88:91],v[44:47],a[248:251]
MM v[92:95],v[40:43],a[236:239]
TR v[62:63],v5,61952
v_lshrrev_b32 v29, 4, v1
v_bfe_u32 v28, v1, 1, 2
v_xor_b32 v28, v28, v29
MM v[92:95],v[44:47],a[252:255]
s_waitcnt lgkmcnt(4)
v_lshlrev_b32 v28, 5, v28
v_and_b32 v29, 1, v1
MM a[0:3],v[48:51],a[224:227]
TR v[32:33],v6,8192
v_lshl_add_u32 v28, v29, 4, v28
v_lshrrev_b32 v29, 3, v1
v_lshl_add_u32 v28, v29, 11, v28
MM a[0:3],v[52:55],a[240:243]
s_lshl_b32 s78, s24, 12
s_and_b32 s79, s94, 0x7ff
MM a[4:7],v[48:51],a[228:231]
TR v[34:35],v6,8704
s_sub_u32 s31, 7340032, s79
s_add_u32 s32, s16, s79
s_addc_u32 s33, s17, 0
s_mov_b32 s34, s31
s_mov_b32 s35, 0x20000
MM a[4:7],v[52:55],a[244:247]
MM a[8:11],v[48:51],a[232:235]
TR v[36:37],v6,12288
s_xor_b32 s30, s79, 128
s_sub_u32 s31, 7340032, s30
s_add_u32 s44, s16, s30
s_addc_u32 s45, s17, 0
s_mov_b32 s46, s31
s_mov_b32 s47, 0x20000
MM a[8:11],v[52:55],a[248:251]
MM a[12:15],v[48:51],a[236:239]
TR v[38:39],v6,12800
s_lshr_b32 s30, s95, 3
s_lshl_b32 s30, s30, 2
s_add_u32 s30, s30, s24
s_mul_i32 s30, s30, 294912
s_add_u32 s30, s30, 4194304
s_add_u32 s36, s22, s30
s_addc_u32 s37, s23, 0
s_mov_b32 s38, 294912
s_mov_b32 s39, 0x20000
MM a[12:15],v[52:55],a[252:255]
s_waitcnt lgkmcnt(4)
MM a[16:19],v[56:59],a[224:227]
TR v[40:41],v6,16384
s_lshl_b32 s30, s95, 16
s_lshl_b32 s31, s24, 14
s_add_u32 s30, s30, s31
s_add_u32 s30, s30, 33554432
s_add_u32 s40, s22, s30
s_addc_u32 s41, s23, 0
s_mov_b32 s42, 16384
s_mov_b32 s43, 0x20000
MM a[16:19],v[60:63],a[240:243]
MM a[20:23],v[56:59],a[228:231]
TR v[42:43],v6,16896
MM a[20:23],v[60:63],a[244:247]
s_lshl_b32 s74, s91, 13
s_xor_b32 s77, s74, 8192
MM a[24:27],v[56:59],a[232:235]
TR v[44:45],v6,20480
s_mov_b32 s48, 0xd9c85140
s_mov_b32 s49, 0x377362ba
s_lshl_b32 s75, s91, 2
s_add_u32 s75, s75, s24
s_mul_i32 s75, s75, 917504
s_mov_b32 s72, s75
MM a[24:27],v[60:63],a[248:251]
MM a[28:31],v[56:59],a[236:239]
TR v[46:47],v6,20992
s_mul_i32 s73, s91, 114688
s_add_u32 s76, s73, 4096
s_mov_b32 s80, 3
s_mov_b32 s50, 32
MM a[28:31],v[60:63],a[252:255]
s_waitcnt lgkmcnt(4)
MM v[96:99],v[32:35],a[160:163]
TR v[48:49],v6,24576
s_xor_b32 s30, s91, 1
s_lshl_b32 s64, s30, 2
s_add_u32 s64, s64, s24
s_mul_i32 s64, s64, 917504
s_mul_i32 s65, s30, 114688
s_add_u32 s65, s65, 106496
MM v[96:99],v[36:39],a[176:179]
MM v[100:103],v[32:35],a[164:167]
TR v[50:51],v6,25088
s_mov_b32 s66, 8192
s_mov_b32 s68, -8192
s_mov_b32 s99, 2
MM v[100:103],v[36:39],a[180:183]
s_cmp_lt_u32 s25, 4
s_cselect_b32 s67, 15, 13
MM v[104:107],v[32:35],a[168:171]
TR v[52:53],v6,28672
s_add_u32 s96, s72, 16384
s_add_u32 s97, s72, 32768
s_add_u32 s98, s72, 49152
MM v[104:107],v[36:39],a[184:187]
v_mov_b32 v30, s92
MM v[108:111],v[32:35],a[172:175]
TR v[54:55],v6,29184
s_add_u32 s84, s83, 0
v_mul_f32 v20, s87, v64
v_mul_f32 v21, s87, v65
v_mul_f32 v22, s87, v66
MM v[108:111],v[36:39],a[188:191]
s_waitcnt lgkmcnt(4)
v_mul_f32 v23, s87, v67
v_exp_f32 v20, v20
v_accvgpr_read_b32 v24, a0
MM v[96:99],v[40:43],a[192:195]
TR v[56:57],v7,8192
v_exp_f32 v21, v21
v_accvgpr_read_b32 v25, a1
v_exp_f32 v22, v22
MM v[96:99],v[44:47],a[208:211]
v_accvgpr_read_b32 v26, a2
v_exp_f32 v23, v23
v_accvgpr_read_b32 v27, a3
MM v[100:103],v[40:43],a[196:199]
TR v[58:59],v7,8704
v_add_f32 v20, 1.0, v20
v_add_f32 v21, 1.0, v21
v_add_f32 v22, 1.0, v22
MM v[100:103],v[44:47],a[212:215]
v_add_f32 v23, 1.0, v23
v_rcp_f32 v20, v20
MM v[104:107],v[40:43],a[200:203]
TR v[60:61],v7,12288
v_mul_f32 v64, v64, v24
v_rcp_f32 v21, v21
MM v[104:107],v[44:47],a[216:219]
v_mul_f32 v65, v65, v25
v_rcp_f32 v22, v22
MM v[108:111],v[40:43],a[204:207]
TR v[62:63],v7,12800
v_mul_f32 v66, v66, v26
v_rcp_f32 v23, v23
MM v[108:111],v[44:47],a[220:223]
s_waitcnt lgkmcnt(4)
v_mul_f32 v67, v67, v27
v_mul_f32 v64, v64, v20
v_mul_f32 v65, v65, v21
MM v[96:99],v[48:51],a[224:227]
TR v[32:33],v7,16384
v_mul_f32 v66, v66, v22
v_mul_f32 v67, v67, v23
v_cvt_pk_bf16_f32 v64, v64, v65
MM v[96:99],v[52:55],a[240:243]
v_cvt_pk_bf16_f32 v65, v66, v67
v_mul_f32 v20, s87, v80
v_mul_f32 v21, s87, v81
MM v[100:103],v[48:51],a[228:231]
TR v[34:35],v7,16896
v_mul_f32 v22, s87, v82
v_mul_f32 v23, s87, v83
v_exp_f32 v20, v20
v_accvgpr_read_b32 v24, a16
MM v[100:103],v[52:55],a[244:247]
v_exp_f32 v21, v21
v_accvgpr_read_b32 v25, a17
v_exp_f32 v22, v22
MM v[104:107],v[48:51],a[232:235]
TR v[36:37],v7,20480
v_accvgpr_read_b32 v26, a18
v_exp_f32 v23, v23
v_accvgpr_read_b32 v27, a19
MM v[104:107],v[52:55],a[248:251]
v_add_f32 v20, 1.0, v20
v_add_f32 v21, 1.0, v21
v_add_f32 v22, 1.0, v22
MM v[108:111],v[48:51],a[236:239]
TR v[38:39],v7,20992
v_add_f32 v23, 1.0, v23
v_rcp_f32 v20, v20
MM v[108:111],v[52:55],a[252:255]
s_waitcnt lgkmcnt(4)
v_mul_f32 v80, v80, v24
v_rcp_f32 v21, v21
MM v[112:115],v[56:59],a[160:163]
TR v[40:41],v7,24576
v_mul_f32 v81, v81, v25
v_rcp_f32 v22, v22
MM v[112:115],v[60:63],a[176:179]
v_mul_f32 v82, v82, v26
v_rcp_f32 v23, v23
MM v[116:119],v[56:59],a[164:167]
TR v[42:43],v7,25088
v_mul_f32 v83, v83, v27
v_mul_f32 v80, v80, v20
v_mul_f32 v81, v81, v21
MM v[116:119],v[60:63],a[180:183]
v_mul_f32 v82, v82, v22
v_mul_f32 v83, v83, v23
v_cvt_pk_bf16_f32 v66, v80, v81
MM v[120:123],v[56:59],a[168:171]
TR v[44:45],v7,28672
v_cvt_pk_bf16_f32 v67, v82, v83
buffer_store_dwordx4 v[64:67], v2, s[56:59], s84 offen offset:0 sc0 sc1
v_mul_f32 v20, s87, v68
MM v[120:123],v[60:63],a[184:187]
v_mul_f32 v21, s87, v69
v_mul_f32 v22, s87, v70
v_mul_f32 v23, s87, v71
MM v[124:127],v[56:59],a[172:175]
TR v[46:47],v7,29184
v_exp_f32 v20, v20
v_accvgpr_read_b32 v24, a4
v_exp_f32 v21, v21
MM v[124:127],v[60:63],a[188:191]
s_waitcnt lgkmcnt(4)
v_accvgpr_read_b32 v25, a5
v_exp_f32 v22, v22
v_accvgpr_read_b32 v26, a6
v_exp_f32 v23, v23
MM v[112:115],v[32:35],a[192:195]
TR v[48:49],v6,40960
v_accvgpr_read_b32 v27, a7
v_add_f32 v20, 1.0, v20
v_add_f32 v21, 1.0, v21
MM v[112:115],v[36:39],a[208:211]
v_add_f32 v22, 1.0, v22
v_add_f32 v23, 1.0, v23
v_rcp_f32 v20, v20
MM v[116:119],v[32:35],a[196:199]
TR v[50:51],v6,41472
v_mul_f32 v68, v68, v24
v_rcp_f32 v21, v21
MM v[116:119],v[36:39],a[212:215]
v_mul_f32 v69, v69, v25
v_rcp_f32 v22, v22
MM v[120:123],v[32:35],a[200:203]
TR v[52:53],v6,45056
v_mul_f32 v70, v70, v26
v_rcp_f32 v23, v23
MM v[120:123],v[36:39],a[216:219]
v_mul_f32 v71, v71, v27
v_mul_f32 v68, v68, v20
MM v[124:127],v[32:35],a[204:207]
TR v[54:55],v6,45568
v_mul_f32 v69, v69, v21
v_mul_f32 v70, v70, v22
v_mul_f32 v71, v71, v23
MM v[124:127],v[36:39],a[220:223]
s_waitcnt lgkmcnt(4)
v_cvt_pk_bf16_f32 v68, v68, v69
v_cvt_pk_bf16_f32 v69, v70, v71
v_mul_f32 v20, s87, v84
MM v[112:115],v[40:43],a[224:227]
TR v[56:57],v6,49152
v_mul_f32 v21, s87, v85
v_mul_f32 v22, s87, v86
v_mul_f32 v23, s87, v87
MM v[112:115],v[44:47],a[240:243]
v_exp_f32 v20, v20
v_accvgpr_read_b32 v24, a20
v_exp_f32 v21, v21
MM v[116:119],v[40:43],a[228:231]
TR v[58:59],v6,49664
v_accvgpr_read_b32 v25, a21
v_exp_f32 v22, v22
v_accvgpr_read_b32 v26, a22
MM v[116:119],v[44:47],a[244:247]
v_exp_f32 v23, v23
v_accvgpr_read_b32 v27, a23
v_add_f32 v20, 1.0, v20
MM v[120:123],v[40:43],a[232:235]
TR v[60:61],v6,53248
v_add_f32 v21, 1.0, v21
v_add_f32 v22, 1.0, v22
v_add_f32 v23, 1.0, v23
v_rcp_f32 v20, v20
MM v[120:123],v[44:47],a[248:251]
v_mul_f32 v84, v84, v24
v_rcp_f32 v21, v21
MM v[124:127],v[40:43],a[236:239]
TR v[62:63],v6,53760
v_mul_f32 v85, v85, v25
v_rcp_f32 v22, v22
MM v[124:127],v[44:47],a[252:255]
s_waitcnt lgkmcnt(4)
v_mul_f32 v86, v86, v26
v_rcp_f32 v23, v23
MM a[32:35],v[48:51],a[160:163]
TR v[32:33],v6,57344
v_mul_f32 v87, v87, v27
v_mul_f32 v84, v84, v20
MM a[32:35],v[52:55],a[176:179]
v_mul_f32 v85, v85, v21
v_mul_f32 v86, v86, v22
v_mul_f32 v87, v87, v23
MM a[36:39],v[48:51],a[164:167]
TR v[34:35],v6,57856
v_cvt_pk_bf16_f32 v70, v84, v85
v_cvt_pk_bf16_f32 v71, v86, v87
buffer_store_dwordx4 v[68:71], v2, s[56:59], s84 offen offset:1024 sc0 sc1
MM a[36:39],v[52:55],a[180:183]
v_mul_f32 v20, s87, v72
v_mul_f32 v21, s87, v73
v_mul_f32 v22, s87, v74
MM a[40:43],v[48:51],a[168:171]
TR v[36:37],v6,61440
v_mul_f32 v23, s87, v75
v_exp_f32 v20, v20
v_accvgpr_read_b32 v24, a8
MM a[40:43],v[52:55],a[184:187]
v_exp_f32 v21, v21
v_accvgpr_read_b32 v25, a9
v_exp_f32 v22, v22
MM a[44:47],v[48:51],a[172:175]
TR v[38:39],v6,61952
v_accvgpr_read_b32 v26, a10
v_exp_f32 v23, v23
v_accvgpr_read_b32 v27, a11
MM a[44:47],v[52:55],a[188:191]
s_waitcnt lgkmcnt(4)
v_add_f32 v20, 1.0, v20
v_add_f32 v21, 1.0, v21
v_add_f32 v22, 1.0, v22
MM a[32:35],v[56:59],a[192:195]
TR v[40:41],v7,40960
v_add_f32 v23, 1.0, v23
v_rcp_f32 v20, v20
MM a[32:35],v[60:63],a[208:211]
v_mul_f32 v72, v72, v24
v_rcp_f32 v21, v21
v_mul_f32 v73, v73, v25
MM a[36:39],v[56:59],a[196:199]
TR v[42:43],v7,41472
v_rcp_f32 v22, v22
v_mul_f32 v74, v74, v26
MM a[36:39],v[60:63],a[212:215]
v_rcp_f32 v23, v23
v_mul_f32 v75, v75, v27
MM a[40:43],v[56:59],a[200:203]
TR v[44:45],v7,45056
v_mul_f32 v72, v72, v20
v_mul_f32 v73, v73, v21
v_mul_f32 v74, v74, v22
MM a[40:43],v[60:63],a[216:219]
v_mul_f32 v75, v75, v23
v_cvt_pk_bf16_f32 v72, v72, v73
v_cvt_pk_bf16_f32 v73, v74, v75
MM a[44:47],v[56:59],a[204:207]
TR v[46:47],v7,45568
v_mul_f32 v20, s87, v88
v_mul_f32 v21, s87, v89
v_mul_f32 v22, s87, v90
MM a[44:47],v[60:63],a[220:223]
s_waitcnt lgkmcnt(4)
v_mul_f32 v23, s87, v91
v_exp_f32 v20, v20
v_accvgpr_read_b32 v24, a24
MM a[32:35],v[32:35],a[224:227]
TR v[48:49],v7,49152
v_exp_f32 v21, v21
v_accvgpr_read_b32 v25, a25
v_exp_f32 v22, v22
MM a[32:35],v[36:39],a[240:243]
v_accvgpr_read_b32 v26, a26
v_exp_f32 v23, v23
v_accvgpr_read_b32 v27, a27
MM a[36:39],v[32:35],a[228:231]
TR v[50:51],v7,49664
v_add_f32 v20, 1.0, v20
v_add_f32 v21, 1.0, v21
v_add_f32 v22, 1.0, v22
MM a[36:39],v[36:39],a[244:247]
v_add_f32 v23, 1.0, v23
v_rcp_f32 v20, v20
MM a[40:43],v[32:35],a[232:235]
TR v[52:53],v7,53248
v_mul_f32 v88, v88, v24
v_rcp_f32 v21, v21
MM a[40:43],v[36:39],a[248:251]
v_mul_f32 v89, v89, v25
v_rcp_f32 v22, v22
MM a[44:47],v[32:35],a[236:239]
TR v[54:55],v7,53760
v_mul_f32 v90, v90, v26
v_rcp_f32 v23, v23
v_mul_f32 v91, v91, v27
MM a[44:47],v[36:39],a[252:255]
s_waitcnt lgkmcnt(4)
v_mul_f32 v88, v88, v20
v_mul_f32 v89, v89, v21
v_mul_f32 v90, v90, v22
MM a[48:51],v[40:43],a[160:163]
TR v[56:57],v7,57344
v_mul_f32 v91, v91, v23
v_cvt_pk_bf16_f32 v74, v88, v89
v_cvt_pk_bf16_f32 v75, v90, v91
MM a[48:51],v[44:47],a[176:179]
buffer_store_dwordx4 v[72:75], v3, s[56:59], s84 offen offset:0 sc0 sc1
v_mul_f32 v20, s87, v76
v_mul_f32 v21, s87, v77
MM a[52:55],v[40:43],a[164:167]
TR v[58:59],v7,57856
v_mul_f32 v22, s87, v78
v_mul_f32 v23, s87, v79
v_exp_f32 v20, v20
MM a[52:55],v[44:47],a[180:183]
v_accvgpr_read_b32 v24, a12
v_exp_f32 v21, v21
v_accvgpr_read_b32 v25, a13
MM a[56:59],v[40:43],a[168:171]
TR v[60:61],v7,61440
v_exp_f32 v22, v22
v_accvgpr_read_b32 v26, a14
v_exp_f32 v23, v23
MM a[56:59],v[44:47],a[184:187]
v_accvgpr_read_b32 v27, a15
v_add_f32 v20, 1.0, v20
v_add_f32 v21, 1.0, v21
MM a[60:63],v[40:43],a[172:175]
TR v[62:63],v7,61952
v_add_f32 v22, 1.0, v22
v_add_f32 v23, 1.0, v23
v_rcp_f32 v20, v20
MM a[60:63],v[44:47],a[188:191]
s_waitcnt lgkmcnt(4)
v_mul_f32 v76, v76, v24
v_rcp_f32 v21, v21
MM a[48:51],v[48:51],a[192:195]
TR v[32:33],v8,8192
v_mul_f32 v77, v77, v25
v_rcp_f32 v22, v22
MM a[48:51],v[52:55],a[208:211]
v_mul_f32 v78, v78, v26
v_rcp_f32 v23, v23
MM a[52:55],v[48:51],a[196:199]
TR v[34:35],v8,8704
v_mul_f32 v79, v79, v27
v_mul_f32 v76, v76, v20
MM a[52:55],v[52:55],a[212:215]
v_mul_f32 v77, v77, v21
v_mul_f32 v78, v78, v22
v_mul_f32 v79, v79, v23
v_cvt_pk_bf16_f32 v76, v76, v77
MM a[56:59],v[48:51],a[200:203]
TR v[36:37],v8,12288
v_cvt_pk_bf16_f32 v77, v78, v79
v_mul_f32 v20, s87, v92
v_mul_f32 v21, s87, v93
MM a[56:59],v[52:55],a[216:219]
v_mul_f32 v22, s87, v94
v_mul_f32 v23, s87, v95
v_exp_f32 v20, v20
MM a[60:63],v[48:51],a[204:207]
TR v[38:39],v8,12800
v_accvgpr_read_b32 v24, a28
v_exp_f32 v21, v21
v_accvgpr_read_b32 v25, a29
MM a[60:63],v[52:55],a[220:223]
s_waitcnt lgkmcnt(4)
v_exp_f32 v22, v22
v_accvgpr_read_b32 v26, a30
v_exp_f32 v23, v23
MM a[48:51],v[56:59],a[224:227]
TR v[40:41],v8,16384
v_accvgpr_read_b32 v27, a31
v_add_f32 v20, 1.0, v20
v_add_f32 v21, 1.0, v21
MM a[48:51],v[60:63],a[240:243]
v_add_f32 v22, 1.0, v22
v_add_f32 v23, 1.0, v23
v_rcp_f32 v20, v20
MM a[52:55],v[56:59],a[228:231]
TR v[42:43],v8,16896
v_mul_f32 v92, v92, v24
v_rcp_f32 v21, v21
MM a[52:55],v[60:63],a[244:247]
v_mul_f32 v93, v93, v25
v_rcp_f32 v22, v22
MM a[56:59],v[56:59],a[232:235]
TR v[44:45],v8,20480
v_mul_f32 v94, v94, v26
v_rcp_f32 v23, v23
MM a[56:59],v[60:63],a[248:251]
v_mul_f32 v95, v95, v27
v_mul_f32 v92, v92, v20
MM a[60:63],v[56:59],a[236:239]
TR v[46:47],v8,20992
v_mul_f32 v93, v93, v21
v_mul_f32 v94, v94, v22
v_mul_f32 v95, v95, v23
MM a[60:63],v[60:63],a[252:255]
s_waitcnt lgkmcnt(4)
v_cvt_pk_bf16_f32 v78, v92, v93
v_cvt_pk_bf16_f32 v79, v94, v95
buffer_store_dwordx4 v[76:79], v3, s[56:59], s84 offen offset:1024 sc0 sc1
MM v[128:131],v[32:35],a[160:163]
TR v[48:49],v8,24576
MM v[128:131],v[36:39],a[176:179]
MM v[132:135],v[32:35],a[164:167]
TR v[50:51],v8,25088
MM v[132:135],v[36:39],a[180:183]
MM v[136:139],v[32:35],a[168:171]
TR v[52:53],v8,28672
MM v[136:139],v[36:39],a[184:187]
MM v[140:143],v[32:35],a[172:175]
TR v[54:55],v8,29184
s_add_u32 s84, s83, 16384
v_pk_mul_f32 v[20:21], v[96:97], s[86:87] op_sel:[0,1] op_sel_hi:[1,1]
v_pk_mul_f32 v[22:23], v[98:99], s[86:87] op_sel:[0,1] op_sel_hi:[1,1]
v_pk_mul_f32 v[24:25], v[112:113], s[86:87] op_sel:[0,1] op_sel_hi:[1,1]
v_pk_mul_f32 v[26:27], v[114:115], s[86:87] op_sel:[0,1] op_sel_hi:[1,1]
v_exp_f32 v20, v20
v_accvgpr_read_b32 v80, a32
MM v[140:143],v[36:39],a[188:191]
s_waitcnt lgkmcnt(4)
v_exp_f32 v21, v21
v_accvgpr_read_b32 v81, a33
MM v[128:131],v[40:43],a[192:195]
TR v[56:57],v9,8192
v_exp_f32 v22, v22
v_accvgpr_read_b32 v82, a34
MM v[128:131],v[44:47],a[208:211]
v_exp_f32 v23, v23
v_accvgpr_read_b32 v83, a35
MM v[132:135],v[40:43],a[196:199]
TR v[58:59],v9,8704
v_exp_f32 v24, v24
v_accvgpr_read_b32 v84, a48
MM v[132:135],v[44:47],a[212:215]
v_exp_f32 v25, v25
v_accvgpr_read_b32 v85, a49
MM v[136:139],v[40:43],a[200:203]
TR v[60:61],v9,12288
v_exp_f32 v26, v26
v_accvgpr_read_b32 v86, a50
MM v[136:139],v[44:47],a[216:219]
v_exp_f32 v27, v27
v_accvgpr_read_b32 v87, a51
v_pk_mul_f32 v[96:97], v[96:97], v[80:81]
v_pk_mul_f32 v[98:99], v[98:99], v[82:83]
v_pk_mul_f32 v[112:113], v[112:113], v[84:85]
v_pk_mul_f32 v[114:115], v[114:115], v[86:87]
v_pk_add_f32 v[20:21], v[20:21], s[52:53]
v_pk_add_f32 v[22:23], v[22:23], s[52:53]
v_pk_add_f32 v[24:25], v[24:25], s[52:53]
v_pk_add_f32 v[26:27], v[26:27], s[52:53]
MM v[140:143],v[40:43],a[204:207]
TR v[62:63],v9,12800
v_rcp_f32 v20, v20
MM v[140:143],v[44:47],a[220:223]
s_waitcnt lgkmcnt(4)
v_rcp_f32 v21, v21
MM v[128:131],v[48:51],a[224:227]
TR v[32:33],v9,16384
v_rcp_f32 v22, v22
MM v[128:131],v[52:55],a[240:243]
v_rcp_f32 v23, v23
MM v[132:135],v[48:51],a[228:231]
TR v[34:35],v9,16896
v_rcp_f32 v24, v24
v_rcp_f32 v25, v25
MM v[132:135],v[52:55],a[244:247]
v_rcp_f32 v26, v26
MM v[136:139],v[48:51],a[232:235]
TR v[36:37],v9,20480
v_rcp_f32 v27, v27
v_pk_mul_f32 v[96:97], v[96:97], v[20:21]
v_pk_mul_f32 v[98:99], v[98:99], v[22:23]
v_pk_mul_f32 v[112:113], v[112:113], v[24:25]
v_pk_mul_f32 v[114:115], v[114:115], v[26:27]
v_pk_mul_f32 v[20:21], v[100:101], s[86:87] op_sel:[0,1] op_sel_hi:[1,1]
v_pk_mul_f32 v[22:23], v[102:103], s[86:87] op_sel:[0,1] op_sel_hi:[1,1]
v_pk_mul_f32 v[24:25], v[116:117], s[86:87] op_sel:[0,1] op_sel_hi:[1,1]
v_pk_mul_f32 v[26:27], v[118:119], s[86:87] op_sel:[0,1] op_sel_hi:[1,1]
MM v[136:139],v[52:55],a[248:251]
v_cvt_pk_bf16_f32 v96, v96, v97
MM v[140:143],v[48:51],a[236:239]
TR v[38:39],v9,20992
v_cvt_pk_bf16_f32 v97, v98, v99
v_cvt_pk_bf16_f32 v98, v112, v113
MM v[140:143],v[52:55],a[252:255]
s_waitcnt lgkmcnt(4)
v_cvt_pk_bf16_f32 v99, v114, v115
buffer_store_dwordx4 v[96:99], v2, s[56:59], s84 offen offset:0 sc0 sc1
MM v[144:147],v[56:59],a[160:163]
TR v[40:41],v9,24576
v_exp_f32 v20, v20
v_accvgpr_read_b32 v80, a36
MM v[144:147],v[60:63],a[176:179]
v_exp_f32 v21, v21
v_accvgpr_read_b32 v81, a37
MM v[148:151],v[56:59],a[164:167]
TR v[42:43],v9,25088
v_exp_f32 v22, v22
v_accvgpr_read_b32 v82, a38
MM v[148:151],v[60:63],a[180:183]
v_exp_f32 v23, v23
v_accvgpr_read_b32 v83, a39
MM v[152:155],v[56:59],a[168:171]
TR v[44:45],v9,28672
v_exp_f32 v24, v24
v_accvgpr_read_b32 v84, a52
MM v[152:155],v[60:63],a[184:187]
v_exp_f32 v25, v25
v_accvgpr_read_b32 v85, a53
MM v[156:159],v[56:59],a[172:175]
TR v[46:47],v9,29184
v_exp_f32 v26, v26
v_accvgpr_read_b32 v86, a54
MM v[156:159],v[60:63],a[188:191]
s_waitcnt lgkmcnt(4)
v_exp_f32 v27, v27
v_accvgpr_read_b32 v87, a55
v_pk_mul_f32 v[100:101], v[100:101], v[80:81]
v_pk_mul_f32 v[102:103], v[102:103], v[82:83]
v_pk_mul_f32 v[116:117], v[116:117], v[84:85]
v_pk_mul_f32 v[118:119], v[118:119], v[86:87]
v_pk_add_f32 v[20:21], v[20:21], s[52:53]
v_pk_add_f32 v[22:23], v[22:23], s[52:53]
v_pk_add_f32 v[24:25], v[24:25], s[52:53]
v_pk_add_f32 v[26:27], v[26:27], s[52:53]
v_rcp_f32 v20, v20
MM v[144:147],v[32:35],a[192:195]
TR v[48:49],v10,8192
v_rcp_f32 v21, v21
MM v[144:147],v[36:39],a[208:211]
v_rcp_f32 v22, v22
MM v[148:151],v[32:35],a[196:199]
TR v[50:51],v10,8704
v_rcp_f32 v23, v23
MM v[148:151],v[36:39],a[212:215]
v_rcp_f32 v24, v24
MM v[152:155],v[32:35],a[200:203]
TR v[52:53],v10,12288
v_rcp_f32 v25, v25
MM v[152:155],v[36:39],a[216:219]
v_rcp_f32 v26, v26
MM v[156:159],v[32:35],a[204:207]
TR v[54:55],v10,12800
v_rcp_f32 v27, v27
v_pk_mul_f32 v[100:101], v[100:101], v[20:21]
v_pk_mul_f32 v[102:103], v[102:103], v[22:23]
v_pk_mul_f32 v[116:117], v[116:117], v[24:25]
v_pk_mul_f32 v[118:119], v[118:119], v[26:27]
v_pk_mul_f32 v[20:21], v[104:105], s[86:87] op_sel:[0,1] op_sel_hi:[1,1]
v_pk_mul_f32 v[22:23], v[106:107], s[86:87] op_sel:[0,1] op_sel_hi:[1,1]
v_pk_mul_f32 v[24:25], v[120:121], s[86:87] op_sel:[0,1] op_sel_hi:[1,1]
v_pk_mul_f32 v[26:27], v[122:123], s[86:87] op_sel:[0,1] op_sel_hi:[1,1]
MM v[156:159],v[36:39],a[220:223]
s_waitcnt lgkmcnt(4)
v_cvt_pk_bf16_f32 v100, v100, v101
MM v[144:147],v[40:43],a[224:227]
TR v[56:57],v10,16384
v_cvt_pk_bf16_f32 v101, v102, v103
v_cvt_pk_bf16_f32 v102, v116, v117
MM v[144:147],v[44:47],a[240:243]
v_cvt_pk_bf16_f32 v103, v118, v119
s_waitcnt vmcnt(1)
s_barrier
MM v[148:151],v[40:43],a[228:231]
TR v[58:59],v10,16896
s_cmp_lg_u32 s24, 0
s_cbranch_scc1 Ls26
v_mov_b32 v31, 1
s_mov_b64 exec, 1
global_atomic_add v30, v31, s[22:23] offset:0 sc1
s_mov_b64 exec, -1
Ls26:
MM v[148:151],v[44:47],a[244:247]
MM v[152:155],v[40:43],a[232:235]
TR v[60:61],v10,20480
MM v[152:155],v[44:47],a[248:251]
buffer_store_dwordx4 v[100:103], v2, s[56:59], s84 offen offset:1024 sc0 sc1
v_exp_f32 v20, v20
MM v[156:159],v[40:43],a[236:239]
TR v[62:63],v10,20992
v_accvgpr_read_b32 v80, a40
v_exp_f32 v21, v21
MM v[156:159],v[44:47],a[252:255]
s_waitcnt lgkmcnt(4)
v_accvgpr_read_b32 v81, a41
v_exp_f32 v22, v22
MM v[160:163],v[48:51],a[160:163]
TR v[32:33],v10,24576
v_accvgpr_read_b32 v82, a42
s_add_u32 m0, s78, 0
s_nop 0
buffer_load_dwordx4 v28, s[32:35], s72 offen lds
MM v[160:163],v[52:55],a[176:179]
MM v[164:167],v[48:51],a[164:167]
TR v[34:35],v10,25088
v_exp_f32 v23, v23
v_accvgpr_read_b32 v83, a43
MM v[164:167],v[52:55],a[180:183]
v_exp_f32 v24, v24
v_accvgpr_read_b32 v84, a56
MM v[168:171],v[48:51],a[168:171]
TR v[36:37],v10,28672
v_exp_f32 v25, v25
v_accvgpr_read_b32 v85, a57
MM v[168:171],v[52:55],a[184:187]
v_exp_f32 v26, v26
s_add_u32 m0, s78, 16384
s_nop 0
buffer_load_dwordx4 v28, s[44:47], s72 offen lds
MM v[172:175],v[48:51],a[172:175]
TR v[38:39],v10,29184
MM v[172:175],v[52:55],a[188:191]
s_waitcnt lgkmcnt(4)
v_accvgpr_read_b32 v86, a58
v_exp_f32 v27, v27
MM v[160:163],v[56:59],a[192:195]
TR v[40:41],v11,8192
v_accvgpr_read_b32 v87, a59
v_pk_mul_f32 v[104:105], v[104:105], v[80:81]
v_pk_mul_f32 v[106:107], v[106:107], v[82:83]
v_pk_mul_f32 v[120:121], v[120:121], v[84:85]
v_pk_mul_f32 v[122:123], v[122:123], v[86:87]
v_pk_add_f32 v[20:21], v[20:21], s[52:53]
v_pk_add_f32 v[22:23], v[22:23], s[52:53]
v_pk_add_f32 v[24:25], v[24:25], s[52:53]
v_pk_add_f32 v[26:27], v[26:27], s[52:53]
v_rcp_f32 v20, v20
MM v[160:163],v[60:63],a[208:211]
v_rcp_f32 v21, v21
MM v[164:167],v[56:59],a[196:199]
TR v[42:43],v11,8704
s_add_u32 m0, s78, 1024
s_nop 0
buffer_load_dwordx4 v28, s[32:35], s96 offen lds
MM v[164:167],v[60:63],a[212:215]
v_rcp_f32 v22, v22
MM v[168:171],v[56:59],a[200:203]
TR v[44:45],v11,12288
v_rcp_f32 v23, v23
MM v[168:171],v[60:63],a[216:219]
v_rcp_f32 v24, v24
MM v[172:175],v[56:59],a[204:207]
TR v[46:47],v11,12800
v_rcp_f32 v25, v25
MM v[172:175],v[60:63],a[220:223]
s_waitcnt lgkmcnt(4)
v_rcp_f32 v26, v26
MM v[160:163],v[32:35],a[224:227]
TR v[48:49],v11,16384
v_rcp_f32 v27, v27
v_pk_mul_f32 v[104:105], v[104:105], v[20:21]
v_pk_mul_f32 v[106:107], v[106:107], v[22:23]
v_pk_mul_f32 v[120:121], v[120:121], v[24:25]
v_pk_mul_f32 v[122:123], v[122:123], v[26:27]
v_pk_mul_f32 v[20:21], v[108:109], s[86:87] op_sel:[0,1] op_sel_hi:[1,1]
v_pk_mul_f32 v[22:23], v[110:111], s[86:87] op_sel:[0,1] op_sel_hi:[1,1]
v_pk_mul_f32 v[24:25], v[124:125], s[86:87] op_sel:[0,1] op_sel_hi:[1,1]
v_pk_mul_f32 v[26:27], v[126:127], s[86:87] op_sel:[0,1] op_sel_hi:[1,1]
MM v[160:163],v[36:39],a[240:243]
s_add_u32 m0, s78, 17408
s_nop 0
buffer_load_dwordx4 v28, s[44:47], s96 offen lds
MM v[164:167],v[32:35],a[228:231]
TR v[50:51],v11,16896
MM v[164:167],v[36:39],a[244:247]
v_cvt_pk_bf16_f32 v104, v104, v105
v_cvt_pk_bf16_f32 v105, v106, v107
MM v[168:171],v[32:35],a[232:235]
TR v[52:53],v11,20480
v_cvt_pk_bf16_f32 v106, v120, v121
v_cvt_pk_bf16_f32 v107, v122, v123
MM v[168:171],v[36:39],a[248:251]
buffer_store_dwordx4 v[104:107], v3, s[56:59], s84 offen offset:0 sc0 sc1
v_exp_f32 v20, v20
MM v[172:175],v[32:35],a[236:239]
TR v[54:55],v11,20992
s_add_u32 m0, s78, 2048
s_nop 0
buffer_load_dwordx4 v28, s[32:35], s97 offen lds
MM v[172:175],v[36:39],a[252:255]
s_waitcnt lgkmcnt(4)
v_accvgpr_read_b32 v80, a44
v_exp_f32 v21, v21
MM v[176:179],v[40:43],a[160:163]
TR v[56:57],v11,24576
v_accvgpr_read_b32 v81, a45
v_exp_f32 v22, v22
MM v[176:179],v[44:47],a[176:179]
v_accvgpr_read_b32 v82, a46
v_exp_f32 v23, v23
MM v[180:183],v[40:43],a[164:167]
TR v[58:59],v11,25088
v_accvgpr_read_b32 v83, a47
s_add_u32 m0, s78, 18432
s_nop 0
buffer_load_dwordx4 v28, s[44:47], s97 offen lds
MM v[180:183],v[44:47],a[180:183]
MM v[184:187],v[40:43],a[168:171]
TR v[60:61],v11,28672
v_exp_f32 v24, v24
v_accvgpr_read_b32 v84, a60
MM v[184:187],v[44:47],a[184:187]
v_exp_f32 v25, v25
v_accvgpr_read_b32 v85, a61
MM v[188:191],v[40:43],a[172:175]
TR v[62:63],v11,29184
v_exp_f32 v26, v26
v_accvgpr_read_b32 v86, a62
MM v[188:191],v[44:47],a[188:191]
s_waitcnt lgkmcnt(4)
s_add_u32 m0, s78, 3072
s_nop 0
buffer_load_dwordx4 v28, s[32:35], s98 offen lds
MM v[176:179],v[48:51],a[192:195]
TR v[32:33],v8,40960
v_exp_f32 v27, v27
MM v[176:179],v[52:55],a[208:211]
v_accvgpr_read_b32 v87, a63
v_pk_mul_f32 v[108:109], v[108:109], v[80:81]
v_pk_mul_f32 v[110:111], v[110:111], v[82:83]
v_pk_mul_f32 v[124:125], v[124:125], v[84:85]
v_pk_mul_f32 v[126:127], v[126:127], v[86:87]
v_pk_add_f32 v[20:21], v[20:21], s[52:53]
v_pk_add_f32 v[22:23], v[22:23], s[52:53]
v_pk_add_f32 v[24:25], v[24:25], s[52:53]
v_pk_add_f32 v[26:27], v[26:27], s[52:53]
v_rcp_f32 v20, v20
MM v[180:183],v[48:51],a[196:199]
TR v[34:35],v8,41472
v_rcp_f32 v21, v21
MM v[180:183],v[52:55],a[212:215]
v_rcp_f32 v22, v22
MM v[184:187],v[48:51],a[200:203]
TR v[36:37],v8,45056
v_rcp_f32 v23, v23
MM v[184:187],v[52:55],a[216:219]
s_add_u32 m0, s78, 19456
s_nop 0
buffer_load_dwordx4 v28, s[44:47], s98 offen lds
MM v[188:191],v[48:51],a[204:207]
TR v[38:39],v8,45568
v_rcp_f32 v24, v24
MM v[188:191],v[52:55],a[220:223]
s_waitcnt lgkmcnt(4)
v_rcp_f32 v25, v25
MM v[176:179],v[56:59],a[224:227]
TR v[40:41],v8,49152
v_rcp_f32 v26, v26
MM v[176:179],v[60:63],a[240:243]
v_rcp_f32 v27, v27
v_pk_mul_f32 v[108:109], v[108:109], v[20:21]
v_pk_mul_f32 v[110:111], v[110:111], v[22:23]
v_pk_mul_f32 v[124:125], v[124:125], v[24:25]
v_pk_mul_f32 v[126:127], v[126:127], v[26:27]
MM v[180:183],v[56:59],a[228:231]
TR v[42:43],v8,49664
v_cvt_pk_bf16_f32 v108, v108, v109
MM v[180:183],v[60:63],a[244:247]
s_lshr_b64 s[48:49], s[48:49], 4
s_and_b32 s72, s48, 15
s_lshl_b32 s72, s72, 16
s_add_u32 s72, s72, s75
s_add_u32 s96, s72, 16384
s_add_u32 s97, s72, 32768
s_add_u32 s98, s72, 49152
MM v[184:187],v[56:59],a[232:235]
TR v[44:45],v8,53248
MM v[184:187],v[60:63],a[248:251]
MM v[188:191],v[56:59],a[236:239]
TR v[46:47],v8,53760
v_cvt_pk_bf16_f32 v109, v110, v111
v_cvt_pk_bf16_f32 v110, v124, v125
MM v[188:191],v[60:63],a[252:255]
s_waitcnt lgkmcnt(4)
v_cvt_pk_bf16_f32 v111, v126, v127
buffer_store_dwordx4 v[108:111], v3, s[56:59], s84 offen offset:1024 sc0 sc1
MM v[192:195],v[32:35],a[160:163]
TR v[48:49],v8,57344
MM v[192:195],v[36:39],a[176:179]
MM v[196:199],v[32:35],a[164:167]
TR v[50:51],v8,57856
MM v[196:199],v[36:39],a[180:183]
MM v[200:203],v[32:35],a[168:171]
TR v[52:53],v8,61440
MM v[200:203],v[36:39],a[184:187]
MM v[204:207],v[32:35],a[172:175]
TR v[54:55],v8,61952
v_pk_mul_f32 v[20:21], v[128:129], s[86:87] op_sel:[0,0] op_sel_hi:[1,0]
v_pk_mul_f32 v[22:23], v[130:131], s[86:87] op_sel:[0,0] op_sel_hi:[1,0]
v_pk_mul_f32 v[24:25], v[132:133], s[86:87] op_sel:[0,0] op_sel_hi:[1,0]
v_pk_mul_f32 v[26:27], v[134:135], s[86:87] op_sel:[0,0] op_sel_hi:[1,0]
v_exp_f32_e64 v20, v20 clamp
v_max_f32 v128, s88, v128
v_exp_f32_e64 v21, v21 clamp
MM v[204:207],v[36:39],a[188:191]
s_waitcnt lgkmcnt(4)
v_max_f32 v129, s88, v129
s_add_u32 m0, s78, 32768
s_nop 0
buffer_load_dwordx4 v28, s[32:35], s72 offen lds
MM v[192:195],v[40:43],a[192:195]
TR v[56:57],v9,40960
v_exp_f32_e64 v22, v22 clamp
MM v[192:195],v[44:47],a[208:211]
v_max_f32 v130, s88, v130
v_exp_f32_e64 v23, v23 clamp
MM v[196:199],v[40:43],a[196:199]
TR v[58:59],v9,41472
v_max_f32 v131, s88, v131
s_add_u32 m0, s78, 49152
s_nop 0
buffer_load_dwordx4 v28, s[44:47], s72 offen lds
MM v[196:199],v[44:47],a[212:215]
v_exp_f32_e64 v24, v24 clamp
MM v[200:203],v[40:43],a[200:203]
TR v[60:61],v9,45056
v_max_f32 v132, s88, v132
v_exp_f32_e64 v25, v25 clamp
MM v[200:203],v[44:47],a[216:219]
v_max_f32 v133, s88, v133
s_add_u32 m0, s78, 33792
s_nop 0
buffer_load_dwordx4 v28, s[32:35], s96 offen lds
MM v[204:207],v[40:43],a[204:207]
TR v[62:63],v9,45568
v_exp_f32_e64 v26, v26 clamp
MM v[204:207],v[44:47],a[220:223]
s_waitcnt lgkmcnt(4)
v_max_f32 v134, s88, v134
v_exp_f32_e64 v27, v27 clamp
MM v[192:195],v[48:51],a[224:227]
TR v[32:33],v9,49152
v_max_f32 v135, s88, v135
v_pk_add_f32 v[128:129], v[128:129], v[20:21]
v_pk_add_f32 v[130:131], v[130:131], v[22:23]
v_pk_add_f32 v[132:133], v[132:133], v[24:25]
v_pk_add_f32 v[134:135], v[134:135], v[26:27]
v_pk_mul_f32 v[20:21], v[136:137], s[86:87] op_sel:[0,0] op_sel_hi:[1,0]
v_pk_mul_f32 v[22:23], v[138:139], s[86:87] op_sel:[0,0] op_sel_hi:[1,0]
v_pk_mul_f32 v[24:25], v[140:141], s[86:87] op_sel:[0,0] op_sel_hi:[1,0]
v_pk_mul_f32 v[26:27], v[142:143], s[86:87] op_sel:[0,0] op_sel_hi:[1,0]
s_add_u32 m0, s78, 50176
s_nop 0
buffer_load_dwordx4 v28, s[44:47], s96 offen lds
MM v[192:195],v[52:55],a[240:243]
v_cvt_pk_bf16_f32 v128, v128, v129
MM v[196:199],v[48:51],a[228:231]
TR v[34:35],v9,49664
v_cvt_pk_bf16_f32 v129, v130, v131
v_cvt_pk_bf16_f32 v132, v132, v133
v_cvt_pk_bf16_f32 v133, v134, v135
MM v[196:199],v[52:55],a[244:247]
s_add_u32 m0, s78, 34816
s_nop 0
buffer_load_dwordx4 v28, s[32:35], s97 offen lds
MM v[200:203],v[48:51],a[232:235]
TR v[36:37],v9,53248
v_exp_f32_e64 v20, v20 clamp
MM v[200:203],v[52:55],a[248:251]
v_max_f32 v136, s88, v136
v_exp_f32_e64 v21, v21 clamp
v_max_f32 v137, s88, v137
MM v[204:207],v[48:51],a[236:239]
TR v[38:39],v9,53760
s_add_u32 m0, s78, 51200
s_nop 0
buffer_load_dwordx4 v28, s[44:47], s97 offen lds
MM v[204:207],v[52:55],a[252:255]
s_waitcnt lgkmcnt(4)
v_exp_f32_e64 v22, v22 clamp
v_max_f32 v138, s88, v138
MM v[208:211],v[56:59],a[160:163]
TR v[40:41],v9,57344
v_exp_f32_e64 v23, v23 clamp
v_max_f32 v139, s88, v139
MM v[208:211],v[60:63],a[176:179]
v_exp_f32_e64 v24, v24 clamp
s_add_u32 m0, s78, 35840
s_nop 0
buffer_load_dwordx4 v28, s[32:35], s98 offen lds
MM v[212:215],v[56:59],a[164:167]
TR v[42:43],v9,57856
v_max_f32 v140, s88, v140
MM v[212:215],v[60:63],a[180:183]
v_exp_f32_e64 v25, v25 clamp
v_max_f32 v141, s88, v141
MM v[216:219],v[56:59],a[168:171]
TR v[44:45],v9,61440
v_exp_f32_e64 v26, v26 clamp
s_add_u32 m0, s78, 52224
s_nop 0
buffer_load_dwordx4 v28, s[44:47], s98 offen lds
MM v[216:219],v[60:63],a[184:187]
v_max_f32 v142, s88, v142
MM v[220:223],v[56:59],a[172:175]
TR v[46:47],v9,61952
v_exp_f32_e64 v27, v27 clamp
v_max_f32 v143, s88, v143
v_pk_add_f32 v[136:137], v[136:137], v[20:21]
v_pk_add_f32 v[138:139], v[138:139], v[22:23]
v_pk_add_f32 v[140:141], v[140:141], v[24:25]
v_pk_add_f32 v[142:143], v[142:143], v[26:27]
MM v[220:223],v[60:63],a[188:191]
s_waitcnt lgkmcnt(4)
s_lshr_b64 s[48:49], s[48:49], 4
s_and_b32 s72, s48, 15
s_lshl_b32 s72, s72, 16
s_add_u32 s72, s72, s75
s_add_u32 s96, s72, 16384
s_add_u32 s97, s72, 32768
s_add_u32 s98, s72, 49152
MM v[208:211],v[32:35],a[192:195]
TR v[48:49],v12,8192
MM v[208:211],v[36:39],a[208:211]
v_cvt_pk_bf16_f32 v136, v136, v137
v_cvt_pk_bf16_f32 v137, v138, v139
MM v[212:215],v[32:35],a[196:199]
TR v[50:51],v12,8704
v_cvt_pk_bf16_f32 v140, v140, v141
v_cvt_pk_bf16_f32 v141, v142, v143
MM v[212:215],v[36:39],a[212:215]
global_load_dword v29, v30, s[22:23] sc1
v_pk_mul_f32 v[20:21], v[144:145], s[86:87] op_sel:[0,0] op_sel_hi:[1,0]
v_pk_mul_f32 v[22:23], v[146:147], s[86:87] op_sel:[0,0] op_sel_hi:[1,0]
v_pk_mul_f32 v[24:25], v[148:149], s[86:87] op_sel:[0,0] op_sel_hi:[1,0]
v_pk_mul_f32 v[26:27], v[150:151], s[86:87] op_sel:[0,0] op_sel_hi:[1,0]
v_exp_f32_e64 v20, v20 clamp
MM v[216:219],v[32:35],a[200:203]
TR v[52:53],v12,12288
v_max_f32 v144, s88, v144
v_exp_f32_e64 v21, v21 clamp
v_max_f32 v145, s88, v145
MM v[216:219],v[36:39],a[216:219]
v_exp_f32_e64 v22, v22 clamp
v_max_f32 v146, s88, v146
MM v[220:223],v[32:35],a[204:207]
TR v[54:55],v12,12800
v_exp_f32_e64 v23, v23 clamp
v_max_f32 v147, s88, v147
MM v[220:223],v[36:39],a[220:223]
s_waitcnt lgkmcnt(4)
v_exp_f32_e64 v24, v24 clamp
v_max_f32 v148, s88, v148
v_exp_f32_e64 v25, v25 clamp
MM v[208:211],v[40:43],a[224:227]
TR v[56:57],v12,16384
v_max_f32 v149, s88, v149
v_exp_f32_e64 v26, v26 clamp
MM v[208:211],v[44:47],a[240:243]
v_max_f32 v150, s88, v150
v_exp_f32_e64 v27, v27 clamp
v_max_f32 v151, s88, v151
v_pk_add_f32 v[144:145], v[144:145], v[20:21]
v_pk_add_f32 v[146:147], v[146:147], v[22:23]
v_pk_add_f32 v[148:149], v[148:149], v[24:25]
v_pk_add_f32 v[150:151], v[150:151], v[26:27]
v_pk_mul_f32 v[20:21], v[152:153], s[86:87] op_sel:[0,0] op_sel_hi:[1,0]
v_pk_mul_f32 v[22:23], v[154:155], s[86:87] op_sel:[0,0] op_sel_hi:[1,0]
v_pk_mul_f32 v[24:25], v[156:157], s[86:87] op_sel:[0,0] op_sel_hi:[1,0]
v_pk_mul_f32 v[26:27], v[158:159], s[86:87] op_sel:[0,0] op_sel_hi:[1,0]
MM v[212:215],v[40:43],a[228:231]
TR v[58:59],v12,16896
v_cvt_pk_bf16_f32 v130, v144, v145
v_cvt_pk_bf16_f32 v131, v146, v147
MM v[212:215],v[44:47],a[244:247]
v_cvt_pk_bf16_f32 v134, v148, v149
v_cvt_pk_bf16_f32 v135, v150, v151
MM v[216:219],v[40:43],a[232:235]
TR v[60:61],v12,20480
v_exp_f32_e64 v20, v20 clamp
v_max_f32 v152, s88, v152
v_exp_f32_e64 v21, v21 clamp
MM v[216:219],v[44:47],a[248:251]
v_max_f32 v153, s88, v153
v_exp_f32_e64 v22, v22 clamp
MM v[220:223],v[40:43],a[236:239]
TR v[62:63],v12,20992
v_max_f32 v154, s88, v154
v_exp_f32_e64 v23, v23 clamp
v_max_f32 v155, s88, v155
MM v[220:223],v[44:47],a[252:255]
s_waitcnt lgkmcnt(4)
v_exp_f32_e64 v24, v24 clamp
v_max_f32 v156, s88, v156
MM a[64:67],v[48:51],a[160:163]
TR v[32:33],v12,24576
v_exp_f32_e64 v25, v25 clamp
v_max_f32 v157, s88, v157
MM a[64:67],v[52:55],a[176:179]
v_exp_f32_e64 v26, v26 clamp
v_max_f32 v158, s88, v158
v_exp_f32_e64 v27, v27 clamp
MM a[68:71],v[48:51],a[164:167]
TR v[34:35],v12,25088
v_max_f32 v159, s88, v159
v_pk_add_f32 v[152:153], v[152:153], v[20:21]
v_pk_add_f32 v[154:155], v[154:155], v[22:23]
v_pk_add_f32 v[156:157], v[156:157], v[24:25]
v_pk_add_f32 v[158:159], v[158:159], v[26:27]
v_cvt_pk_bf16_f32 v138, v152, v153
MM a[68:71],v[52:55],a[180:183]
v_cvt_pk_bf16_f32 v139, v154, v155
v_cvt_pk_bf16_f32 v142, v156, v157
v_cvt_pk_bf16_f32 v143, v158, v159
MM a[72:75],v[48:51],a[168:171]
TR v[36:37],v12,28672
s_waitcnt vmcnt(9)
s_barrier
MM a[72:75],v[52:55],a[184:187]
s_cmp_lg_u32 s24, 0
s_cbranch_scc1 Ls29
v_mov_b32 v31, 1
s_mov_b64 exec, 1
global_atomic_add v30, v31, s[22:23] offset:1024 sc1
s_mov_b64 exec, -1
Ls29:
v_pk_mul_f32 v[20:21], v[160:161], s[86:87] op_sel:[0,0] op_sel_hi:[1,0]
v_pk_mul_f32 v[22:23], v[162:163], s[86:87] op_sel:[0,0] op_sel_hi:[1,0]
v_pk_mul_f32 v[24:25], v[164:165], s[86:87] op_sel:[0,0] op_sel_hi:[1,0]
v_pk_mul_f32 v[26:27], v[166:167], s[86:87] op_sel:[0,0] op_sel_hi:[1,0]
MM a[76:79],v[48:51],a[172:175]
TR v[38:39],v12,29184
MM a[76:79],v[52:55],a[188:191]
s_waitcnt lgkmcnt(4)
v_exp_f32_e64 v20, v20 clamp
MM a[64:67],v[56:59],a[192:195]
TR v[40:41],v13,8192
v_max_f32 v160, s88, v160
v_exp_f32_e64 v21, v21 clamp
v_max_f32 v161, s88, v161
MM a[64:67],v[60:63],a[208:211]
v_exp_f32_e64 v22, v22 clamp
v_max_f32 v162, s88, v162
MM a[68:71],v[56:59],a[196:199]
TR v[42:43],v13,8704
s_waitcnt vmcnt(0)
v_exp_f32_e64 v23, v23 clamp
MM a[68:71],v[60:63],a[212:215]
v_max_f32 v163, s88, v163
v_exp_f32_e64 v24, v24 clamp
v_max_f32 v164, s88, v164
MM a[72:75],v[56:59],a[200:203]
TR v[44:45],v13,12288
v_readfirstlane_b32 s30, v29
s_nop 0
s_cmp_ge_u32 s30, 16
s_cbranch_scc1 Ld28
s_mov_b32 s31, 262144
Lp27:
global_load_dword v29, v30, s[22:23] offset:0 sc1
s_waitcnt vmcnt(0)
v_readfirstlane_b32 s30, v29
s_nop 0
s_cmp_ge_u32 s30, 16
s_cbranch_scc1 Ld28
s_sleep 4
s_sub_u32 s31, s31, 1
s_cmp_lg_u32 s31, 0
s_cbranch_scc1 Lp27
Ld28:
MM a[72:75],v[60:63],a[216:219]
MM a[76:79],v[56:59],a[204:207]
TR v[46:47],v13,12800
v_exp_f32_e64 v25, v25 clamp
v_max_f32 v165, s88, v165
MM a[76:79],v[60:63],a[220:223]
s_waitcnt lgkmcnt(4)
v_exp_f32_e64 v26, v26 clamp
v_max_f32 v166, s88, v166
MM a[64:67],v[32:35],a[224:227]
TR v[48:49],v13,16384
buffer_load_dwordx4 a[0:3], v2, s[36:39], s73 offen offset:0 sc1
v_exp_f32_e64 v27, v27 clamp
v_max_f32 v167, s88, v167
v_pk_add_f32 v[160:161], v[160:161], v[20:21]
v_pk_add_f32 v[162:163], v[162:163], v[22:23]
v_pk_add_f32 v[164:165], v[164:165], v[24:25]
v_pk_add_f32 v[166:167], v[166:167], v[26:27]
v_pk_mul_f32 v[20:21], v[168:169], s[86:87] op_sel:[0,0] op_sel_hi:[1,0]
v_pk_mul_f32 v[22:23], v[170:171], s[86:87] op_sel:[0,0] op_sel_hi:[1,0]
v_pk_mul_f32 v[24:25], v[172:173], s[86:87] op_sel:[0,0] op_sel_hi:[1,0]
v_pk_mul_f32 v[26:27], v[174:175], s[86:87] op_sel:[0,0] op_sel_hi:[1,0]
MM a[64:67],v[36:39],a[240:243]
v_cvt_pk_bf16_f32 v160, v160, v161
buffer_load_dwordx4 a[4:7], v2, s[36:39], s73 offen offset:1024 sc1
MM a[68:71],v[32:35],a[228:231]
TR v[50:51],v13,16896
v_cvt_pk_bf16_f32 v161, v162, v163
v_cvt_pk_bf16_f32 v164, v164, v165
v_cvt_pk_bf16_f32 v165, v166, v167
MM a[68:71],v[36:39],a[244:247]
v_exp_f32_e64 v20, v20 clamp
buffer_load_dwordx4 a[8:11], v2, s[36:39], s73 offen offset:2048 sc1
MM a[72:75],v[32:35],a[232:235]
TR v[52:53],v13,20480
v_max_f32 v168, s88, v168
v_exp_f32_e64 v21, v21 clamp
MM a[72:75],v[36:39],a[248:251]
v_max_f32 v169, s88, v169
v_exp_f32_e64 v22, v22 clamp
buffer_load_dwordx4 a[12:15], v2, s[36:39], s73 offen offset:3072 sc1
MM a[76:79],v[32:35],a[236:239]
TR v[54:55],v13,20992
v_max_f32 v170, s88, v170
v_exp_f32_e64 v23, v23 clamp
MM a[76:79],v[36:39],a[252:255]
s_waitcnt lgkmcnt(4)
v_max_f32 v171, s88, v171
v_exp_f32_e64 v24, v24 clamp
MM a[80:83],v[40:43],a[160:163]
TR v[56:57],v13,24576
buffer_load_dwordx4 a[16:19], v2, s[36:39], s76 offen offset:0 sc1
v_max_f32 v172, s88, v172
v_exp_f32_e64 v25, v25 clamp
MM a[80:83],v[44:47],a[176:179]
v_max_f32 v173, s88, v173
v_exp_f32_e64 v26, v26 clamp
MM a[84:87],v[40:43],a[164:167]
TR v[58:59],v13,25088
buffer_load_dwordx4 a[20:23], v2, s[36:39], s76 offen offset:1024 sc1
v_max_f32 v174, s88, v174
v_exp_f32_e64 v27, v27 clamp
MM a[84:87],v[44:47],a[180:183]
v_max_f32 v175, s88, v175
v_pk_add_f32 v[168:169], v[168:169], v[20:21]
v_pk_add_f32 v[170:171], v[170:171], v[22:23]
v_pk_add_f32 v[172:173], v[172:173], v[24:25]
v_pk_add_f32 v[174:175], v[174:175], v[26:27]
buffer_load_dwordx4 a[24:27], v2, s[36:39], s76 offen offset:2048 sc1
MM a[88:91],v[40:43],a[168:171]
TR v[60:61],v13,28672
v_cvt_pk_bf16_f32 v168, v168, v169
v_cvt_pk_bf16_f32 v169, v170, v171
MM a[88:91],v[44:47],a[184:187]
v_cvt_pk_bf16_f32 v172, v172, v173
v_cvt_pk_bf16_f32 v173, v174, v175
buffer_load_dwordx4 a[28:31], v2, s[36:39], s76 offen offset:3072 sc1
v_pk_mul_f32 v[20:21], v[176:177], s[86:87] op_sel:[0,0] op_sel_hi:[1,0]
v_pk_mul_f32 v[22:23], v[178:179], s[86:87] op_sel:[0,0] op_sel_hi:[1,0]
v_pk_mul_f32 v[24:25], v[180:181], s[86:87] op_sel:[0,0] op_sel_hi:[1,0]
v_pk_mul_f32 v[26:27], v[182:183], s[86:87] op_sel:[0,0] op_sel_hi:[1,0]
MM a[92:95],v[40:43],a[172:175]
TR v[62:63],v13,29184
v_exp_f32_e64 v20, v20 clamp
v_max_f32 v176, s88, v176
MM a[92:95],v[44:47],a[188:191]
s_waitcnt lgkmcnt(4)
v_exp_f32_e64 v21, v21 clamp
v_max_f32 v177, s88, v177
v_exp_f32_e64 v22, v22 clamp
MM a[80:83],v[48:51],a[192:195]
TR v[32:33],v10,40960
v_max_f32 v178, s88, v178
v_exp_f32_e64 v23, v23 clamp
MM a[80:83],v[52:55],a[208:211]
s_add_u32 s73, s73, 8192
s_add_u32 s76, s76, 8192
MM a[84:87],v[48:51],a[196:199]
TR v[34:35],v10,41472
v_max_f32 v179, s88, v179
v_exp_f32_e64 v24, v24 clamp
v_max_f32 v180, s88, v180
MM a[84:87],v[52:55],a[212:215]
v_exp_f32_e64 v25, v25 clamp
buffer_load_dwordx4 a[32:35], v2, s[36:39], s73 offen offset:0 sc1
MM a[88:91],v[48:51],a[200:203]
TR v[36:37],v10,45056
v_max_f32 v181, s88, v181
v_exp_f32_e64 v26, v26 clamp
v_max_f32 v182, s88, v182
MM a[88:91],v[52:55],a[216:219]
v_exp_f32_e64 v27, v27 clamp
buffer_load_dwordx4 a[36:39], v2, s[36:39], s73 offen offset:1024 sc1
MM a[92:95],v[48:51],a[204:207]
TR v[38:39],v10,45568
v_max_f32 v183, s88, v183
v_pk_add_f32 v[176:177], v[176:177], v[20:21]
v_pk_add_f32 v[178:179], v[178:179], v[22:23]
v_pk_add_f32 v[180:181], v[180:181], v[24:25]
v_pk_add_f32 v[182:183], v[182:183], v[26:27]
v_pk_mul_f32 v[20:21], v[184:185], s[86:87] op_sel:[0,0] op_sel_hi:[1,0]
v_pk_mul_f32 v[22:23], v[186:187], s[86:87] op_sel:[0,0] op_sel_hi:[1,0]
v_pk_mul_f32 v[24:25], v[188:189], s[86:87] op_sel:[0,0] op_sel_hi:[1,0]
v_pk_mul_f32 v[26:27], v[190:191], s[86:87] op_sel:[0,0] op_sel_hi:[1,0]
v_cvt_pk_bf16_f32 v162, v176, v177
MM a[92:95],v[52:55],a[220:223]
s_waitcnt lgkmcnt(4)
v_cvt_pk_bf16_f32 v163, v178, v179
buffer_load_dwordx4 a[40:43], v2, s[36:39], s73 offen offset:2048 sc1
v_cvt_pk_bf16_f32 v166, v180, v181
MM a[80:83],v[56:59],a[224:227]
TR v[40:41],v10,49152
v_cvt_pk_bf16_f32 v167, v182, v183
v_exp_f32_e64 v20, v20 clamp
MM a[80:83],v[60:63],a[240:243]
v_max_f32 v184, s88, v184
buffer_load_dwordx4 a[44:47], v2, s[36:39], s73 offen offset:3072 sc1
v_exp_f32_e64 v21, v21 clamp
MM a[84:87],v[56:59],a[228:231]
TR v[42:43],v10,49664
v_max_f32 v185, s88, v185
v_exp_f32_e64 v22, v22 clamp
MM a[84:87],v[60:63],a[244:247]
v_max_f32 v186, s88, v186
buffer_load_dwordx4 a[48:51], v2, s[36:39], s76 offen offset:0 sc1
MM a[88:91],v[56:59],a[232:235]
TR v[44:45],v10,53248
v_exp_f32_e64 v23, v23 clamp
v_max_f32 v187, s88, v187
v_exp_f32_e64 v24, v24 clamp
MM a[88:91],v[60:63],a[248:251]
v_max_f32 v188, s88, v188
buffer_load_dwordx4 a[52:55], v2, s[36:39], s76 offen offset:1024 sc1
MM a[92:95],v[56:59],a[236:239]
TR v[46:47],v10,53760
v_exp_f32_e64 v25, v25 clamp
v_max_f32 v189, s88, v189
v_exp_f32_e64 v26, v26 clamp
MM a[92:95],v[60:63],a[252:255]
s_waitcnt lgkmcnt(4)
v_max_f32 v190, s88, v190
buffer_load_dwordx4 a[56:59], v2, s[36:39], s76 offen offset:2048 sc1
MM v[224:227],v[32:35],a[160:163]
TR v[48:49],v10,57344
v_exp_f32_e64 v27, v27 clamp
v_max_f32 v191, s88, v191
v_pk_add_f32 v[184:185], v[184:185], v[20:21]
v_pk_add_f32 v[186:187], v[186:187], v[22:23]
v_pk_add_f32 v[188:189], v[188:189], v[24:25]
v_pk_add_f32 v[190:191], v[190:191], v[26:27]
MM v[224:227],v[36:39],a[176:179]
v_cvt_pk_bf16_f32 v170, v184, v185
buffer_load_dwordx4 a[60:63], v2, s[36:39], s76 offen offset:3072 sc1
v_cvt_pk_bf16_f32 v171, v186, v187
MM v[228:231],v[32:35],a[164:167]
TR v[50:51],v10,57856
v_cvt_pk_bf16_f32 v174, v188, v189
v_cvt_pk_bf16_f32 v175, v190, v191
MM v[228:231],v[36:39],a[180:183]
s_add_u32 s73, s73, 8192
s_add_u32 s76, s76, 8192
MM v[232:235],v[32:35],a[168:171]
TR v[52:53],v10,61440
MM v[232:235],v[36:39],a[184:187]
MM v[236:239],v[32:35],a[172:175]
TR v[54:55],v10,61952
s_add_u32 s84, s83, 81920
v_mul_f32 v20, s87, v192
v_mul_f32 v21, s87, v193
v_mul_f32 v22, s87, v194
MM v[236:239],v[36:39],a[188:191]
s_waitcnt lgkmcnt(4)
v_mul_f32 v23, s87, v195
v_exp_f32 v20, v20
v_accvgpr_read_b32 v24, a64
v_exp_f32 v21, v21
MM v[224:227],v[40:43],a[192:195]
TR v[56:57],v11,40960
v_accvgpr_read_b32 v25, a65
v_exp_f32 v22, v22
v_accvgpr_read_b32 v26, a66
MM v[224:227],v[44:47],a[208:211]
v_exp_f32 v23, v23
global_load_dword v17, v16, s[20:21] sc1
v_accvgpr_read_b32 v27, a67
v_add_f32 v20, 1.0, v20
MM v[228:231],v[40:43],a[196:199]
TR v[58:59],v11,41472
v_add_f32 v21, 1.0, v21
v_add_f32 v22, 1.0, v22
v_add_f32 v23, 1.0, v23
MM v[228:231],v[44:47],a[212:215]
v_rcp_f32 v20, v20
v_mul_f32 v192, v192, v24
v_rcp_f32 v21, v21
MM v[232:235],v[40:43],a[200:203]
TR v[60:61],v11,45056
v_mul_f32 v193, v193, v25
v_rcp_f32 v22, v22
MM v[232:235],v[44:47],a[216:219]
v_mul_f32 v194, v194, v26
v_rcp_f32 v23, v23
MM v[236:239],v[40:43],a[204:207]
TR v[62:63],v11,45568
v_mul_f32 v195, v195, v27
v_mul_f32 v192, v192, v20
v_mul_f32 v193, v193, v21
MM v[236:239],v[44:47],a[220:223]
s_waitcnt lgkmcnt(4)
v_mul_f32 v194, v194, v22
v_mul_f32 v195, v195, v23
v_cvt_pk_bf16_f32 v192, v192, v193
v_cvt_pk_bf16_f32 v193, v194, v195
MM v[224:227],v[48:51],a[224:227]
TR v[32:33],v11,49152
v_mul_f32 v20, s87, v208
v_mul_f32 v21, s87, v209
v_mul_f32 v22, s87, v210
MM v[224:227],v[52:55],a[240:243]
v_mul_f32 v23, s87, v211
v_exp_f32 v20, v20
v_accvgpr_read_b32 v24, a80
v_exp_f32 v21, v21
MM v[228:231],v[48:51],a[228:231]
TR v[34:35],v11,49664
v_accvgpr_read_b32 v25, a81
v_exp_f32 v22, v22
v_accvgpr_read_b32 v26, a82
MM v[228:231],v[52:55],a[244:247]
v_exp_f32 v23, v23
v_accvgpr_read_b32 v27, a83
v_add_f32 v20, 1.0, v20
v_add_f32 v21, 1.0, v21
MM v[232:235],v[48:51],a[232:235]
TR v[36:37],v11,53248
v_add_f32 v22, 1.0, v22
v_add_f32 v23, 1.0, v23
v_rcp_f32 v20, v20
MM v[232:235],v[52:55],a[248:251]
v_mul_f32 v208, v208, v24
v_rcp_f32 v21, v21
MM v[236:239],v[48:51],a[236:239]
TR v[38:39],v11,53760
v_mul_f32 v209, v209, v25
v_rcp_f32 v22, v22
MM v[236:239],v[52:55],a[252:255]
s_waitcnt lgkmcnt(4)
v_mul_f32 v210, v210, v26
v_rcp_f32 v23, v23
v_mul_f32 v211, v211, v27
MM v[240:243],v[56:59],a[160:163]
TR v[40:41],v11,57344
v_mul_f32 v208, v208, v20
v_mul_f32 v209, v209, v21
v_mul_f32 v210, v210, v22
MM v[240:243],v[60:63],a[176:179]
v_mul_f32 v211, v211, v23
v_cvt_pk_bf16_f32 v194, v208, v209
v_cvt_pk_bf16_f32 v195, v210, v211
buffer_store_dwordx4 v[192:195], v2, s[56:59], s84 offen offset:0 sc0 sc1
MM v[244:247],v[56:59],a[164:167]
TR v[42:43],v11,57856
v_mul_f32 v20, s87, v196
v_mul_f32 v21, s87, v197
v_mul_f32 v22, s87, v198
MM v[244:247],v[60:63],a[180:183]
v_mul_f32 v23, s87, v199
v_exp_f32 v20, v20
v_accvgpr_read_b32 v24, a68
v_exp_f32 v21, v21
MM v[248:251],v[56:59],a[168:171]
TR v[44:45],v11,61440
v_accvgpr_read_b32 v25, a69
v_exp_f32 v22, v22
v_accvgpr_read_b32 v26, a70
MM v[248:251],v[60:63],a[184:187]
v_exp_f32 v23, v23
s_waitcnt vmcnt(1)
v_readfirstlane_b32 s30, v17
s_nop 0
s_cmp_ge_u32 s30, 8
s_cbranch_scc1 Ld31
s_mov_b32 s31, 262144
Lp30:
global_load_dword v17, v16, s[20:21] offset:0 sc1
s_waitcnt vmcnt(0)
v_readfirstlane_b32 s30, v17
s_nop 0
s_cmp_ge_u32 s30, 8
s_cbranch_scc1 Ld31
s_sleep 1
s_sub_u32 s31, s31, 1
s_cmp_lg_u32 s31, 0
s_cbranch_scc1 Lp30
Ld31:
MM v[252:255],v[56:59],a[172:175]
TR v[46:47],v11,61952
MM v[252:255],v[60:63],a[188:191]
s_waitcnt lgkmcnt(4)
v_accvgpr_read_b32 v27, a71
v_add_f32 v20, 1.0, v20
v_add_f32 v21, 1.0, v21
v_add_f32 v22, 1.0, v22
MM v[240:243],v[32:35],a[192:195]
TR v[48:49],v14,8192
v_add_f32 v23, 1.0, v23
s_mov_b32 s10, 0
buffer_load_dwordx4 v[64:67], v18, s[60:63], s10 offen sc1
MM v[240:243],v[36:39],a[208:211]
v_rcp_f32 v20, v20
v_mul_f32 v196, v196, v24
v_rcp_f32 v21, v21
MM v[244:247],v[32:35],a[196:199]
TR v[50:51],v14,8704
v_mul_f32 v197, v197, v25
v_rcp_f32 v22, v22
MM v[244:247],v[36:39],a[212:215]
buffer_load_dwordx4 v[68:71], v18, s[60:63], s10 offen offset:1024 sc1
v_mul_f32 v198, v198, v26
v_rcp_f32 v23, v23
MM v[248:251],v[32:35],a[200:203]
TR v[52:53],v14,12288
v_mul_f32 v199, v199, v27
v_mul_f32 v196, v196, v20
MM v[248:251],v[36:39],a[216:219]
v_mul_f32 v197, v197, v21
buffer_load_dwordx4 v[72:75], v19, s[60:63], s10 offen sc1
v_mul_f32 v198, v198, v22
v_mul_f32 v199, v199, v23
MM v[252:255],v[32:35],a[204:207]
TR v[54:55],v14,12800
v_cvt_pk_bf16_f32 v196, v196, v197
v_cvt_pk_bf16_f32 v197, v198, v199
v_mul_f32 v20, s87, v212
MM v[252:255],v[36:39],a[220:223]
s_waitcnt lgkmcnt(4)
s_mov_b32 s10, 8448
buffer_load_dwordx4 v[76:79], v18, s[60:63], s10 offen sc1
v_mul_f32 v21, s87, v213
v_mul_f32 v22, s87, v214
MM v[240:243],v[40:43],a[224:227]
TR v[56:57],v14,16384
v_mul_f32 v23, s87, v215
v_exp_f32 v20, v20
buffer_load_dwordx4 v[80:83], v18, s[60:63], s10 offen offset:1024 sc1
MM v[240:243],v[44:47],a[240:243]
v_accvgpr_read_b32 v24, a84
v_exp_f32 v21, v21
v_accvgpr_read_b32 v25, a85
v_exp_f32 v22, v22
MM v[244:247],v[40:43],a[228:231]
TR v[58:59],v14,16896
v_accvgpr_read_b32 v26, a86
buffer_load_dwordx4 v[84:87], v19, s[60:63], s10 offen sc1
v_exp_f32 v23, v23
MM v[244:247],v[44:47],a[244:247]
v_accvgpr_read_b32 v27, a87
v_add_f32 v20, 1.0, v20
v_add_f32 v21, 1.0, v21
v_add_f32 v22, 1.0, v22
MM v[248:251],v[40:43],a[232:235]
TR v[60:61],v14,20480
s_mov_b32 s10, 16896
buffer_load_dwordx4 v[88:91], v18, s[60:63], s10 offen sc1
v_add_f32 v23, 1.0, v23
MM v[248:251],v[44:47],a[248:251]
v_rcp_f32 v20, v20
v_mul_f32 v212, v212, v24
v_rcp_f32 v21, v21
MM v[252:255],v[40:43],a[236:239]
TR v[62:63],v14,20992
v_mul_f32 v213, v213, v25
buffer_load_dwordx4 v[92:95], v18, s[60:63], s10 offen offset:1024 sc1
MM v[252:255],v[44:47],a[252:255]
s_waitcnt lgkmcnt(4)
v_rcp_f32 v22, v22
v_mul_f32 v214, v214, v26
v_rcp_f32 v23, v23
MM a[96:99],v[48:51],a[160:163]
TR v[32:33],v14,24576
v_mul_f32 v215, v215, v27
v_mul_f32 v212, v212, v20
MM a[96:99],v[52:55],a[176:179]
buffer_load_dwordx4 v[96:99], v19, s[60:63], s10 offen sc1
v_mul_f32 v213, v213, v21
v_mul_f32 v214, v214, v22
v_mul_f32 v215, v215, v23
MM a[100:103],v[48:51],a[164:167]
TR v[34:35],v14,25088
v_cvt_pk_bf16_f32 v198, v212, v213
s_mov_b32 s10, 25344
buffer_load_dwordx4 v[100:103], v18, s[60:63], s10 offen sc1
MM a[100:103],v[52:55],a[180:183]
v_cvt_pk_bf16_f32 v199, v214, v215
buffer_store_dwordx4 v[196:199], v2, s[56:59], s84 offen offset:1024 sc0 sc1
v_mul_f32 v20, s87, v200
v_mul_f32 v21, s87, v201
MM a[104:107],v[48:51],a[168:171]
TR v[36:37],v14,28672
v_mul_f32 v22, s87, v202
buffer_load_dwordx4 v[104:107], v18, s[60:63], s10 offen offset:1024 sc1
v_mul_f32 v23, s87, v203
v_exp_f32 v20, v20
MM a[104:107],v[52:55],a[184:187]
v_accvgpr_read_b32 v24, a72
v_exp_f32 v21, v21
v_accvgpr_read_b32 v25, a73
MM a[108:111],v[48:51],a[172:175]
TR v[38:39],v14,29184
buffer_load_dwordx4 v[108:111], v19, s[60:63], s10 offen sc1
v_exp_f32 v22, v22
v_accvgpr_read_b32 v26, a74
v_exp_f32 v23, v23
MM a[108:111],v[52:55],a[188:191]
s_waitcnt lgkmcnt(4)
v_accvgpr_read_b32 v27, a75
v_add_f32 v20, 1.0, v20
s_mov_b32 s10, 33792
buffer_load_dwordx4 v[112:115], v18, s[60:63], s10 offen sc1
MM a[96:99],v[56:59],a[192:195]
TR v[40:41],v15,8192
v_add_f32 v21, 1.0, v21
v_add_f32 v22, 1.0, v22
v_add_f32 v23, 1.0, v23
MM a[96:99],v[60:63],a[208:211]
v_rcp_f32 v20, v20
v_mul_f32 v200, v200, v24
MM a[100:103],v[56:59],a[196:199]
TR v[42:43],v15,8704
buffer_load_dwordx4 v[116:119], v18, s[60:63], s10 offen offset:1024 sc1
v_rcp_f32 v21, v21
v_mul_f32 v201, v201, v25
MM a[100:103],v[60:63],a[212:215]
v_rcp_f32 v22, v22
v_mul_f32 v202, v202, v26
MM a[104:107],v[56:59],a[200:203]
TR v[44:45],v15,12288
buffer_load_dwordx4 v[120:123], v19, s[60:63], s10 offen sc1
v_rcp_f32 v23, v23
v_mul_f32 v203, v203, v27
MM a[104:107],v[60:63],a[216:219]
v_mul_f32 v200, v200, v20
v_mul_f32 v201, v201, v21
v_mul_f32 v202, v202, v22
MM a[108:111],v[56:59],a[204:207]
TR v[46:47],v15,12800
s_mov_b32 s10, 42240
buffer_load_dwordx4 v[124:127], v18, s[60:63], s10 offen sc1
v_mul_f32 v203, v203, v23
v_cvt_pk_bf16_f32 v200, v200, v201
MM a[108:111],v[60:63],a[220:223]
s_waitcnt lgkmcnt(4)
v_cvt_pk_bf16_f32 v201, v202, v203
v_mul_f32 v20, s87, v216
v_mul_f32 v21, s87, v217
MM a[96:99],v[32:35],a[224:227]
TR v[48:49],v15,16384
buffer_load_dwordx4 v[144:147], v18, s[60:63], s10 offen offset:1024 sc1
v_mul_f32 v22, s87, v218
v_mul_f32 v23, s87, v219
v_exp_f32 v20, v20
MM a[96:99],v[36:39],a[240:243]
v_accvgpr_read_b32 v24, a88
v_exp_f32 v21, v21
buffer_load_dwordx4 v[148:151], v19, s[60:63], s10 offen sc1
MM a[100:103],v[32:35],a[228:231]
TR v[50:51],v15,16896
v_accvgpr_read_b32 v25, a89
v_exp_f32 v22, v22
v_accvgpr_read_b32 v26, a90
v_exp_f32 v23, v23
MM a[100:103],v[36:39],a[244:247]
v_accvgpr_read_b32 v27, a91
s_mov_b32 s10, 50688
buffer_load_dwordx4 v[152:155], v18, s[60:63], s10 offen sc1
MM a[104:107],v[32:35],a[232:235]
TR v[52:53],v15,20480
v_add_f32 v20, 1.0, v20
v_add_f32 v21, 1.0, v21
v_add_f32 v22, 1.0, v22
v_add_f32 v23, 1.0, v23
MM a[104:107],v[36:39],a[248:251]
buffer_load_dwordx4 v[156:159], v18, s[60:63], s10 offen offset:1024 sc1
v_rcp_f32 v20, v20
MM a[108:111],v[32:35],a[236:239]
TR v[54:55],v15,20992
v_mul_f32 v216, v216, v24
v_rcp_f32 v21, v21
v_mul_f32 v217, v217, v25
MM a[108:111],v[36:39],a[252:255]
s_waitcnt lgkmcnt(4)
v_rcp_f32 v22, v22
buffer_load_dwordx4 v[176:179], v19, s[60:63], s10 offen sc1
MM a[112:115],v[40:43],a[160:163]
TR v[56:57],v15,24576
v_mul_f32 v218, v218, v26
v_rcp_f32 v23, v23
v_mul_f32 v219, v219, v27
MM a[112:115],v[44:47],a[176:179]
v_mul_f32 v216, v216, v20
v_mul_f32 v217, v217, v21
s_mov_b32 s10, 59136
buffer_load_dwordx4 v[180:183], v18, s[60:63], s10 offen sc1
MM a[116:119],v[40:43],a[164:167]
TR v[58:59],v15,25088
v_mul_f32 v218, v218, v22
v_mul_f32 v219, v219, v23
v_cvt_pk_bf16_f32 v202, v216, v217
MM a[116:119],v[44:47],a[180:183]
v_cvt_pk_bf16_f32 v203, v218, v219
buffer_store_dwordx4 v[200:203], v3, s[56:59], s84 offen offset:0 sc0 sc1
buffer_load_dwordx4 v[184:187], v18, s[60:63], s10 offen offset:1024 sc1
MM a[120:123],v[40:43],a[168:171]
TR v[60:61],v15,28672
v_mul_f32 v20, s87, v204
v_mul_f32 v21, s87, v205
v_mul_f32 v22, s87, v206
v_mul_f32 v23, s87, v207
MM a[120:123],v[44:47],a[184:187]
v_exp_f32 v20, v20
buffer_load_dwordx4 v[188:191], v19, s[60:63], s10 offen sc1
v_accvgpr_read_b32 v24, a76
MM a[124:127],v[40:43],a[172:175]
TR v[62:63],v15,29184
v_exp_f32 v21, v21
v_accvgpr_read_b32 v25, a77
v_exp_f32 v22, v22
v_accvgpr_read_b32 v26, a78
MM a[124:127],v[44:47],a[188:191]
s_waitcnt lgkmcnt(4)
v_exp_f32 v23, v23
v_accvgpr_read_b32 v27, a79
v_add_f32 v20, 1.0, v20
MM a[112:115],v[48:51],a[192:195]
v_add_f32 v21, 1.0, v21
v_add_f32 v22, 1.0, v22
v_add_f32 v23, 1.0, v23
v_rcp_f32 v20, v20
MM a[112:115],v[52:55],a[208:211]
v_mul_f32 v204, v204, v24
v_rcp_f32 v21, v21
MM a[116:119],v[48:51],a[196:199]
v_mul_f32 v205, v205, v25
v_rcp_f32 v22, v22
MM a[116:119],v[52:55],a[212:215]
v_mul_f32 v206, v206, v26
v_rcp_f32 v23, v23
MM a[120:123],v[48:51],a[200:203]
v_mul_f32 v207, v207, v27
v_mul_f32 v204, v204, v20
v_mul_f32 v205, v205, v21
v_mul_f32 v206, v206, v22
MM a[120:123],v[52:55],a[216:219]
v_mul_f32 v207, v207, v23
v_cvt_pk_bf16_f32 v204, v204, v205
v_cvt_pk_bf16_f32 v205, v206, v207
MM a[124:127],v[48:51],a[204:207]
v_mul_f32 v20, s87, v220
v_mul_f32 v21, s87, v221
v_mul_f32 v22, s87, v222
v_mul_f32 v23, s87, v223
MM a[124:127],v[52:55],a[220:223]
s_waitcnt lgkmcnt(0)
v_exp_f32 v20, v20
v_accvgpr_read_b32 v24, a92
v_exp_f32 v21, v21
MM a[112:115],v[56:59],a[224:227]
v_accvgpr_read_b32 v25, a93
v_exp_f32 v22, v22
v_accvgpr_read_b32 v26, a94
v_exp_f32 v23, v23
MM a[112:115],v[60:63],a[240:243]
v_accvgpr_read_b32 v27, a95
v_add_f32 v20, 1.0, v20
v_add_f32 v21, 1.0, v21
MM a[116:119],v[56:59],a[228:231]
v_add_f32 v22, 1.0, v22
v_add_f32 v23, 1.0, v23
v_rcp_f32 v20, v20
MM a[116:119],v[60:63],a[244:247]
v_mul_f32 v220, v220, v24
v_rcp_f32 v21, v21
MM a[120:123],v[56:59],a[232:235]
v_mul_f32 v221, v221, v25
v_rcp_f32 v22, v22
v_mul_f32 v222, v222, v26
MM a[120:123],v[60:63],a[248:251]
v_rcp_f32 v23, v23
v_mul_f32 v223, v223, v27
MM a[124:127],v[56:59],a[236:239]
v_mul_f32 v220, v220, v20
v_mul_f32 v221, v221, v21
v_mul_f32 v222, v222, v22
v_mul_f32 v223, v223, v23
MM a[124:127],v[60:63],a[252:255]
v_cvt_pk_bf16_f32 v206, v220, v221
v_cvt_pk_bf16_f32 v207, v222, v223
buffer_store_dwordx4 v[204:207], v3, s[56:59], s84 offen offset:1024 sc0 sc1
global_load_dword v29, v30, s[22:23] offset:1024 sc1
s_add_u32 s84, s83, 98304
v_mov_b32 v36, s87
v_mov_b32 v37, s87
v_mov_b32 v38, 1.0
v_mov_b32 v39, 1.0
v_pk_mul_f32 v[20:21], v[224:225], v[36:37]
v_pk_mul_f32 v[22:23], v[226:227], v[36:37]
v_exp_f32 v20, v20
s_waitcnt vmcnt(2)
v_pk_add_f32 v[64:65], v[64:65], v[112:113]
v_pk_add_f32 v[66:67], v[66:67], v[114:115]
v_pk_add_f32 v[68:69], v[68:69], v[116:117]
v_pk_add_f32 v[70:71], v[70:71], v[118:119]
v_pk_add_f32 v[72:73], v[72:73], v[120:121]
v_pk_add_f32 v[74:75], v[74:75], v[122:123]
v_pk_add_f32 v[76:77], v[76:77], v[124:125]
v_pk_add_f32 v[78:79], v[78:79], v[126:127]
v_pk_add_f32 v[80:81], v[80:81], v[144:145]
v_pk_add_f32 v[82:83], v[82:83], v[146:147]
v_pk_add_f32 v[84:85], v[84:85], v[148:149]
v_pk_add_f32 v[86:87], v[86:87], v[150:151]
v_pk_add_f32 v[88:89], v[88:89], v[152:153]
v_pk_add_f32 v[90:91], v[90:91], v[154:155]
v_pk_add_f32 v[92:93], v[92:93], v[156:157]
v_pk_add_f32 v[94:95], v[94:95], v[158:159]
v_pk_add_f32 v[96:97], v[96:97], v[176:177]
v_pk_add_f32 v[98:99], v[98:99], v[178:179]
v_pk_add_f32 v[100:101], v[100:101], v[180:181]
v_pk_add_f32 v[102:103], v[102:103], v[182:183]
v_pk_add_f32 v[104:105], v[104:105], v[184:185]
v_pk_add_f32 v[106:107], v[106:107], v[186:187]
v_pk_add_f32 v[108:109], v[108:109], v[188:189]
v_pk_add_f32 v[110:111], v[110:111], v[190:191]
v_pk_add_f32 v[64:65], v[64:65], v[88:89]
v_pk_add_f32 v[66:67], v[66:67], v[90:91]
v_pk_add_f32 v[68:69], v[68:69], v[92:93]
v_pk_add_f32 v[70:71], v[70:71], v[94:95]
v_pk_add_f32 v[72:73], v[72:73], v[96:97]
v_pk_add_f32 v[74:75], v[74:75], v[98:99]
v_pk_add_f32 v[76:77], v[76:77], v[100:101]
v_pk_add_f32 v[78:79], v[78:79], v[102:103]
v_pk_add_f32 v[80:81], v[80:81], v[104:105]
v_pk_add_f32 v[82:83], v[82:83], v[106:107]
v_pk_add_f32 v[84:85], v[84:85], v[108:109]
v_pk_add_f32 v[86:87], v[86:87], v[110:111]
v_pk_add_f32 v[64:65], v[64:65], v[76:77]
v_pk_add_f32 v[66:67], v[66:67], v[78:79]
v_pk_add_f32 v[68:69], v[68:69], v[80:81]
v_pk_add_f32 v[70:71], v[70:71], v[82:83]
v_pk_add_f32 v[72:73], v[72:73], v[84:85]
v_pk_add_f32 v[74:75], v[74:75], v[86:87]
v_cvt_pk_bf16_f32 v40, v64, v65
v_cvt_pk_bf16_f32 v41, v66, v67
v_cvt_pk_bf16_f32 v42, v68, v69
v_cvt_pk_bf16_f32 v43, v70, v71
v_cvt_pk_bf16_f32 v44, v72, v73
v_cvt_pk_bf16_f32 v45, v74, v75
s_lshl_b32 s30, s24, 10
s_add_u32 s30, s30, 0x20000
v_add_u32 v18, s30, v2
ds_write_b128 v18, v[40:43]
s_lshr_b32 s30, s24, 1
s_lshl_b32 s30, s30, 10
s_and_b32 s31, s24, 1
s_lshl_b32 s31, s31, 3
s_add_u32 s30, s30, s31
s_add_u32 s30, s30, 0x21000
v_add_u32 v19, s30, v2
ds_write_b64 v19, v[44:45]
v_add_u32 v18, 0x20000, v2
v_accvgpr_read_b32 v24, a96
v_exp_f32 v21, v21
v_accvgpr_read_b32 v25, a97
v_exp_f32 v22, v22
v_accvgpr_read_b32 v26, a98
v_exp_f32 v23, v23
v_accvgpr_read_b32 v27, a99
v_pk_mul_f32 v[224:225], v[224:225], v[24:25]
v_pk_mul_f32 v[226:227], v[226:227], v[26:27]
v_pk_add_f32 v[20:21], v[20:21], v[38:39]
v_pk_add_f32 v[22:23], v[22:23], v[38:39]
v_rcp_f32 v20, v20
v_rcp_f32 v21, v21
v_rcp_f32 v22, v22
v_rcp_f32 v23, v23
v_pk_mul_f32 v[224:225], v[224:225], v[20:21]
v_pk_mul_f32 v[226:227], v[226:227], v[22:23]
v_cvt_pk_bf16_f32 v224, v224, v225
v_cvt_pk_bf16_f32 v225, v226, v227
v_pk_mul_f32 v[20:21], v[240:241], v[36:37]
v_pk_mul_f32 v[22:23], v[242:243], v[36:37]
v_exp_f32 v20, v20
v_accvgpr_read_b32 v24, a112
v_exp_f32 v21, v21
v_accvgpr_read_b32 v25, a113
v_exp_f32 v22, v22
v_accvgpr_read_b32 v26, a114
v_exp_f32 v23, v23
s_waitcnt lgkmcnt(0)
s_barrier
ds_read_b128 v[40:43], v18 offset:0
ds_read_b128 v[44:47], v18 offset:1024
ds_read_b128 v[48:51], v18 offset:2048
ds_read_b128 v[52:55], v18 offset:3072
ds_read_b128 v[56:59], v18 offset:4096
ds_read_b128 v[60:63], v18 offset:5120
v_accvgpr_read_b32 v27, a115
v_pk_mul_f32 v[240:241], v[240:241], v[24:25]
v_pk_mul_f32 v[242:243], v[242:243], v[26:27]
v_pk_add_f32 v[20:21], v[20:21], v[38:39]
v_pk_add_f32 v[22:23], v[22:23], v[38:39]
v_rcp_f32 v20, v20
v_rcp_f32 v21, v21
v_rcp_f32 v22, v22
v_rcp_f32 v23, v23
v_pk_mul_f32 v[240:241], v[240:241], v[20:21]
v_pk_mul_f32 v[242:243], v[242:243], v[22:23]
v_cvt_pk_bf16_f32 v226, v240, v241
v_cvt_pk_bf16_f32 v227, v242, v243
buffer_store_dwordx4 v[224:227], v2, s[56:59], s84 offen offset:0 sc0 sc1
v_pk_mul_f32 v[20:21], v[228:229], v[36:37]
v_pk_mul_f32 v[22:23], v[230:231], v[36:37]
v_exp_f32 v20, v20
v_accvgpr_read_b32 v24, a100
v_exp_f32 v21, v21
v_accvgpr_read_b32 v25, a101
v_exp_f32 v22, v22
v_accvgpr_read_b32 v26, a102
v_exp_f32 v23, v23
v_accvgpr_read_b32 v27, a103
v_pk_mul_f32 v[228:229], v[228:229], v[24:25]
v_pk_mul_f32 v[230:231], v[230:231], v[26:27]
v_pk_add_f32 v[20:21], v[20:21], v[38:39]
v_pk_add_f32 v[22:23], v[22:23], v[38:39]
s_waitcnt lgkmcnt(0)
v_mfma_f32_16x16x32_bf16 v[144:147], v[56:59], v[128:131], 0
v_mfma_f32_16x16x32_bf16 v[148:151], v[56:59], v[132:135], 0
v_mfma_f32_16x16x32_bf16 v[152:155], v[56:59], v[136:139], 0
v_mfma_f32_16x16x32_bf16 v[156:159], v[56:59], v[140:143], 0
v_mfma_f32_16x16x32_bf16 v[176:179], v[60:63], v[160:163], 0
v_mfma_f32_16x16x32_bf16 v[180:183], v[60:63], v[164:167], 0
v_mfma_f32_16x16x32_bf16 v[184:187], v[60:63], v[168:171], 0
v_mfma_f32_16x16x32_bf16 v[188:191], v[60:63], v[172:175], 0
v_mfma_f32_16x16x32_bf16 v[64:67], v[40:43], v[128:131], 0
v_mfma_f32_16x16x32_bf16 v[68:71], v[44:47], v[128:131], 0
v_mfma_f32_16x16x32_bf16 v[72:75], v[40:43], v[132:135], 0
v_add_f32 v144, s88, v144
v_add_f32 v148, s88, v148
v_mfma_f32_16x16x32_bf16 v[76:79], v[44:47], v[132:135], 0
v_add_f32 v152, s88, v152
v_add_f32 v156, s88, v156
v_mfma_f32_16x16x32_bf16 v[80:83], v[40:43], v[136:139], 0
v_add_f32 v176, s88, v176
v_add_f32 v180, s88, v180
v_mfma_f32_16x16x32_bf16 v[84:87], v[44:47], v[136:139], 0
v_add_f32 v184, s88, v184
v_add_f32 v188, s88, v188
v_mfma_f32_16x16x32_bf16 v[88:91], v[40:43], v[140:143], 0
v_rcp_f32 v144, v144
v_rcp_f32 v148, v148
v_mfma_f32_16x16x32_bf16 v[92:95], v[44:47], v[140:143], 0
v_rcp_f32 v152, v152
v_rcp_f32 v156, v156
v_mfma_f32_16x16x32_bf16 v[96:99], v[48:51], v[160:163], 0
v_rcp_f32 v176, v176
v_rcp_f32 v180, v180
v_mfma_f32_16x16x32_bf16 v[100:103], v[52:55], v[160:163], 0
v_rcp_f32 v184, v184
v_rcp_f32 v188, v188
v_mfma_f32_16x16x32_bf16 v[104:107], v[48:51], v[164:167], 0
v_mov_b32 v145, v144
v_mov_b32 v149, v148
v_mfma_f32_16x16x32_bf16 v[108:111], v[52:55], v[164:167], 0
v_mov_b32 v153, v152
v_mov_b32 v157, v156
v_mfma_f32_16x16x32_bf16 v[112:115], v[48:51], v[168:171], 0
v_mov_b32 v177, v176
v_mov_b32 v181, v180
v_mfma_f32_16x16x32_bf16 v[116:119], v[52:55], v[168:171], 0
v_mov_b32 v185, v184
v_mov_b32 v189, v188
v_mfma_f32_16x16x32_bf16 v[120:123], v[48:51], v[172:175], 0
v_mfma_f32_16x16x32_bf16 v[124:127], v[52:55], v[172:175], 0
v_rcp_f32 v20, v20
v_rcp_f32 v21, v21
v_pk_mul_f32 v[64:65], v[64:65], v[144:145]
v_rcp_f32 v22, v22
v_rcp_f32 v23, v23
v_pk_mul_f32 v[66:67], v[66:67], v[144:145]
v_pk_mul_f32 v[228:229], v[228:229], v[20:21]
v_pk_mul_f32 v[230:231], v[230:231], v[22:23]
v_pk_mul_f32 v[68:69], v[68:69], v[144:145]
v_cvt_pk_bf16_f32 v228, v228, v229
v_pk_mul_f32 v[70:71], v[70:71], v[144:145]
v_cvt_pk_bf16_f32 v229, v230, v231
v_pk_mul_f32 v[20:21], v[244:245], v[36:37]
v_cvt_pk_bf16_f32 v64, v64, v65
v_pk_mul_f32 v[22:23], v[246:247], v[36:37]
v_exp_f32 v20, v20
v_cvt_pk_bf16_f32 v65, v66, v67
v_accvgpr_read_b32 v24, a116
v_cvt_pk_bf16_f32 v66, v68, v69
v_exp_f32 v21, v21
v_accvgpr_read_b32 v25, a117
v_cvt_pk_bf16_f32 v67, v70, v71
v_exp_f32 v22, v22
v_accvgpr_read_b32 v26, a118
buffer_store_dwordx4 v[64:67], v2, s[56:59], s85 offen offset:0 sc0 sc1
v_exp_f32 v23, v23
v_pk_mul_f32 v[72:73], v[72:73], v[148:149]
v_accvgpr_read_b32 v27, a119
v_pk_mul_f32 v[244:245], v[244:245], v[24:25]
v_pk_mul_f32 v[74:75], v[74:75], v[148:149]
v_pk_mul_f32 v[246:247], v[246:247], v[26:27]
v_pk_add_f32 v[20:21], v[20:21], v[38:39]
v_pk_mul_f32 v[76:77], v[76:77], v[148:149]
v_pk_add_f32 v[22:23], v[22:23], v[38:39]
v_pk_mul_f32 v[78:79], v[78:79], v[148:149]
v_rcp_f32 v20, v20
v_rcp_f32 v21, v21
v_cvt_pk_bf16_f32 v72, v72, v73
v_rcp_f32 v22, v22
v_rcp_f32 v23, v23
v_cvt_pk_bf16_f32 v73, v74, v75
v_pk_mul_f32 v[244:245], v[244:245], v[20:21]
v_cvt_pk_bf16_f32 v74, v76, v77
v_pk_mul_f32 v[246:247], v[246:247], v[22:23]
v_cvt_pk_bf16_f32 v230, v244, v245
v_cvt_pk_bf16_f32 v75, v78, v79
v_cvt_pk_bf16_f32 v231, v246, v247
buffer_store_dwordx4 v[228:231], v2, s[56:59], s84 offen offset:1024 sc0 sc1
buffer_store_dwordx4 v[72:75], v2, s[56:59], s85 offen offset:1024 sc0 sc1
v_pk_mul_f32 v[20:21], v[232:233], v[36:37]
v_pk_mul_f32 v[80:81], v[80:81], v[152:153]
v_pk_mul_f32 v[22:23], v[234:235], v[36:37]
v_exp_f32 v20, v20
v_pk_mul_f32 v[82:83], v[82:83], v[152:153]
v_accvgpr_read_b32 v24, a104
v_exp_f32 v21, v21
v_pk_mul_f32 v[84:85], v[84:85], v[152:153]
v_accvgpr_read_b32 v25, a105
v_pk_mul_f32 v[86:87], v[86:87], v[152:153]
v_exp_f32 v22, v22
v_accvgpr_read_b32 v26, a106
v_cvt_pk_bf16_f32 v80, v80, v81
v_exp_f32 v23, v23
v_accvgpr_read_b32 v27, a107
v_cvt_pk_bf16_f32 v81, v82, v83
v_pk_mul_f32 v[232:233], v[232:233], v[24:25]
v_pk_mul_f32 v[234:235], v[234:235], v[26:27]
v_cvt_pk_bf16_f32 v82, v84, v85
v_pk_add_f32 v[20:21], v[20:21], v[38:39]
v_cvt_pk_bf16_f32 v83, v86, v87
v_pk_add_f32 v[22:23], v[22:23], v[38:39]
v_rcp_f32 v20, v20
buffer_store_dwordx4 v[80:83], v3, s[56:59], s85 offen offset:0 sc0 sc1
v_rcp_f32 v21, v21
v_rcp_f32 v22, v22
v_pk_mul_f32 v[88:89], v[88:89], v[156:157]
v_rcp_f32 v23, v23
v_pk_mul_f32 v[90:91], v[90:91], v[156:157]
v_pk_mul_f32 v[232:233], v[232:233], v[20:21]
v_pk_mul_f32 v[234:235], v[234:235], v[22:23]
v_pk_mul_f32 v[92:93], v[92:93], v[156:157]
v_cvt_pk_bf16_f32 v232, v232, v233
v_cvt_pk_bf16_f32 v233, v234, v235
v_pk_mul_f32 v[94:95], v[94:95], v[156:157]
v_pk_mul_f32 v[20:21], v[248:249], v[36:37]
v_cvt_pk_bf16_f32 v88, v88, v89
v_pk_mul_f32 v[22:23], v[250:251], v[36:37]
v_exp_f32 v20, v20
v_cvt_pk_bf16_f32 v89, v90, v91
v_accvgpr_read_b32 v24, a120
v_exp_f32 v21, v21
v_cvt_pk_bf16_f32 v90, v92, v93
v_accvgpr_read_b32 v25, a121
v_cvt_pk_bf16_f32 v91, v94, v95
v_exp_f32 v22, v22
v_accvgpr_read_b32 v26, a122
buffer_store_dwordx4 v[88:91], v3, s[56:59], s85 offen offset:1024 sc0 sc1
v_exp_f32 v23, v23
v_accvgpr_read_b32 v27, a123
v_pk_mul_f32 v[96:97], v[96:97], v[176:177]
v_pk_mul_f32 v[248:249], v[248:249], v[24:25]
v_pk_mul_f32 v[98:99], v[98:99], v[176:177]
v_pk_mul_f32 v[250:251], v[250:251], v[26:27]
v_pk_add_f32 v[20:21], v[20:21], v[38:39]
v_pk_mul_f32 v[100:101], v[100:101], v[176:177]
v_pk_add_f32 v[22:23], v[22:23], v[38:39]
v_rcp_f32 v20, v20
v_pk_mul_f32 v[102:103], v[102:103], v[176:177]
v_rcp_f32 v21, v21
v_cvt_pk_bf16_f32 v96, v96, v97
v_rcp_f32 v22, v22
v_rcp_f32 v23, v23
v_cvt_pk_bf16_f32 v97, v98, v99
v_pk_mul_f32 v[248:249], v[248:249], v[20:21]
v_pk_mul_f32 v[250:251], v[250:251], v[22:23]
v_cvt_pk_bf16_f32 v98, v100, v101
v_cvt_pk_bf16_f32 v234, v248, v249
v_cvt_pk_bf16_f32 v99, v102, v103
v_cvt_pk_bf16_f32 v235, v250, v251
buffer_store_dwordx4 v[232:235], v3, s[56:59], s84 offen offset:0 sc0 sc1
buffer_store_dwordx4 v[96:99], v2, s[56:59], s85 offen offset:2048 sc0 sc1
v_pk_mul_f32 v[20:21], v[236:237], v[36:37]
v_pk_mul_f32 v[22:23], v[238:239], v[36:37]
v_pk_mul_f32 v[104:105], v[104:105], v[180:181]
v_exp_f32 v20, v20
v_pk_mul_f32 v[106:107], v[106:107], v[180:181]
v_accvgpr_read_b32 v24, a108
v_exp_f32 v21, v21
v_pk_mul_f32 v[108:109], v[108:109], v[180:181]
v_accvgpr_read_b32 v25, a109
v_exp_f32 v22, v22
v_pk_mul_f32 v[110:111], v[110:111], v[180:181]
v_accvgpr_read_b32 v26, a110
v_exp_f32 v23, v23
v_cvt_pk_bf16_f32 v104, v104, v105
v_accvgpr_read_b32 v27, a111
v_cvt_pk_bf16_f32 v105, v106, v107
v_pk_mul_f32 v[236:237], v[236:237], v[24:25]
v_pk_mul_f32 v[238:239], v[238:239], v[26:27]
v_cvt_pk_bf16_f32 v106, v108, v109
v_pk_add_f32 v[20:21], v[20:21], v[38:39]
v_pk_add_f32 v[22:23], v[22:23], v[38:39]
v_cvt_pk_bf16_f32 v107, v110, v111
v_rcp_f32 v20, v20
buffer_store_dwordx4 v[104:107], v2, s[56:59], s85 offen offset:3072 sc0 sc1
v_rcp_f32 v21, v21
v_rcp_f32 v22, v22
v_pk_mul_f32 v[112:113], v[112:113], v[184:185]
v_rcp_f32 v23, v23
v_pk_mul_f32 v[236:237], v[236:237], v[20:21]
v_pk_mul_f32 v[114:115], v[114:115], v[184:185]
v_pk_mul_f32 v[238:239], v[238:239], v[22:23]
v_pk_mul_f32 v[116:117], v[116:117], v[184:185]
v_cvt_pk_bf16_f32 v236, v236, v237
v_cvt_pk_bf16_f32 v237, v238, v239
v_pk_mul_f32 v[118:119], v[118:119], v[184:185]
v_pk_mul_f32 v[20:21], v[252:253], v[36:37]
v_pk_mul_f32 v[22:23], v[254:255], v[36:37]
v_cvt_pk_bf16_f32 v112, v112, v113
v_exp_f32 v20, v20
v_cvt_pk_bf16_f32 v113, v114, v115
v_accvgpr_read_b32 v24, a124
v_exp_f32 v21, v21
v_cvt_pk_bf16_f32 v114, v116, v117
v_accvgpr_read_b32 v25, a125
v_exp_f32 v22, v22
v_cvt_pk_bf16_f32 v115, v118, v119
v_accvgpr_read_b32 v26, a126
buffer_store_dwordx4 v[112:115], v3, s[56:59], s85 offen offset:2048 sc0 sc1
v_exp_f32 v23, v23
v_accvgpr_read_b32 v27, a127
v_pk_mul_f32 v[120:121], v[120:121], v[188:189]
v_pk_mul_f32 v[252:253], v[252:253], v[24:25]
v_pk_mul_f32 v[254:255], v[254:255], v[26:27]
v_pk_mul_f32 v[122:123], v[122:123], v[188:189]
v_pk_add_f32 v[20:21], v[20:21], v[38:39]
v_pk_mul_f32 v[124:125], v[124:125], v[188:189]
v_pk_add_f32 v[22:23], v[22:23], v[38:39]
v_rcp_f32 v20, v20
v_pk_mul_f32 v[126:127], v[126:127], v[188:189]
v_rcp_f32 v21, v21
v_rcp_f32 v22, v22
v_cvt_pk_bf16_f32 v120, v120, v121
v_rcp_f32 v23, v23
v_cvt_pk_bf16_f32 v121, v122, v123
v_pk_mul_f32 v[252:253], v[252:253], v[20:21]
v_pk_mul_f32 v[254:255], v[254:255], v[22:23]
v_cvt_pk_bf16_f32 v122, v124, v125
v_cvt_pk_bf16_f32 v238, v252, v253
v_cvt_pk_bf16_f32 v239, v254, v255
v_cvt_pk_bf16_f32 v123, v126, v127
buffer_store_dwordx4 v[236:239], v3, s[56:59], s84 offen offset:1024 sc0 sc1
buffer_store_dwordx4 v[120:123], v3, s[56:59], s85 offen offset:3072 sc0 sc1
v_lshrrev_b32 v12, 2, v1
v_bfe_u32 v13, v1, 3, 2
v_and_b32 v14, 3, v1
v_xor_b32 v15, 0, v13
v_lshlrev_b32 v15, 5, v15
v_lshl_add_u32 v15, v12, 7, v15
v_lshl_add_u32 v4, v14, 3, v15
v_add_u32 v8, 0x10000, v4
v_xor_b32 v15, 1, v13
v_lshlrev_b32 v15, 5, v15
v_lshl_add_u32 v15, v12, 7, v15
v_lshl_add_u32 v5, v14, 3, v15
v_add_u32 v9, 0x10000, v5
v_xor_b32 v15, 2, v13
v_lshlrev_b32 v15, 5, v15
v_lshl_add_u32 v15, v12, 7, v15
v_lshl_add_u32 v6, v14, 3, v15
v_add_u32 v10, 0x10000, v6
v_xor_b32 v15, 3, v13
v_lshlrev_b32 v15, 5, v15
v_lshl_add_u32 v15, v12, 7, v15
v_lshl_add_u32 v7, v14, 3, v15
v_add_u32 v11, 0x10000, v7
s_mov_b32 s51, 1
v_mov_b64 v[192:193], 0
v_mov_b64 v[194:195], 0
v_mov_b64 v[196:197], 0
v_mov_b64 v[198:199], 0
v_mov_b64 v[200:201], 0
v_mov_b64 v[202:203], 0
v_mov_b64 v[204:205], 0
v_mov_b64 v[206:207], 0
v_mov_b64 v[208:209], 0
v_mov_b64 v[210:211], 0
v_mov_b64 v[212:213], 0
v_mov_b64 v[214:215], 0
v_mov_b64 v[216:217], 0
v_mov_b64 v[218:219], 0
v_mov_b64 v[220:221], 0
v_mov_b64 v[222:223], 0
v_mov_b64 v[224:225], 0
v_mov_b64 v[226:227], 0
v_mov_b64 v[228:229], 0
v_mov_b64 v[230:231], 0
v_mov_b64 v[232:233], 0
v_mov_b64 v[234:235], 0
v_mov_b64 v[236:237], 0
v_mov_b64 v[238:239], 0
v_mov_b64 v[240:241], 0
v_mov_b64 v[242:243], 0
v_mov_b64 v[244:245], 0
v_mov_b64 v[246:247], 0
v_mov_b64 v[248:249], 0
v_mov_b64 v[250:251], 0
v_mov_b64 v[252:253], 0
v_mov_b64 v[254:255], 0
v_mov_b32 v24, s92
v_add_u32 v26, 256, v24
v_add_u32 v27, 512, v24
s_and_b32 s30, s25, 4
s_lshl_b32 s30, s30, 6
v_add_u32 v24, s30, v26
s_waitcnt vmcnt(12)
v_readfirstlane_b32 s30, v29
s_nop 0
s_cmp_ge_u32 s30, 16
s_cbranch_scc1 Ld33
s_mov_b32 s31, 262144
Lp32:
global_load_dword v29, v30, s[22:23] offset:1024 sc1
s_waitcnt vmcnt(0)
v_readfirstlane_b32 s30, v29
s_nop 0
s_cmp_ge_u32 s30, 16
s_cbranch_scc1 Ld33
s_sleep 4
s_sub_u32 s31, s31, 1
s_cmp_lg_u32 s31, 0
s_cbranch_scc1 Lp32
Ld33:
s_barrier
s_branch L2_start
L2_start:
TR v[32:33],v4,0
TR v[34:35],v4,2048
TR v[36:37],v4,4096
TR v[38:39],v4,6144
TR v[40:41],v4,8192
TR v[42:43],v4,10240
TR v[44:45],v4,12288
TR v[46:47],v4,14336
TR v[48:49],v5,0
TR v[50:51],v5,2048
TR v[52:53],v5,4096
TR v[54:55],v5,6144
s_waitcnt lgkmcnt(8)
.p2align 6
L2_loop:
MM v[192:195],v[32:35],a[0:3]
TR v[56:57],v5,8192
MM v[192:195],v[36:39],a[8:11]
TR v[58:59],v5,10240
s_add_u32 m0, s78, 65536
MM v[196:199],v[32:35],a[4:7]
TR v[60:61],v5,12288
buffer_load_dwordx4 v28, s[32:35], s72 offen lds
MM v[196:199],v[36:39],a[12:15]
TR v[62:63],v5,14336
s_waitcnt lgkmcnt(8)
MM v[192:195],v[40:43],a[16:19]
TR v[32:33],v6,0
buffer_load_dwordx4 a[64:67], v2, s[36:39], s73 offen offset:0 sc1
MM v[192:195],v[44:47],a[24:27]
TR v[34:35],v6,2048
MM v[196:199],v[40:43],a[20:23]
TR v[36:37],v6,4096
s_add_u32 m0, s78, 81920
MM v[196:199],v[44:47],a[28:31]
TR v[38:39],v6,6144
s_waitcnt lgkmcnt(8)
buffer_load_dwordx4 v28, s[44:47], s72 offen lds
MM v[200:203],v[48:51],a[0:3]
TR v[40:41],v6,8192
MM v[200:203],v[52:55],a[8:11]
TR v[42:43],v6,10240
MM v[204:207],v[48:51],a[4:7]
TR v[44:45],v6,12288
buffer_load_dwordx4 a[68:71], v2, s[36:39], s73 offen offset:1024 sc1
MM v[204:207],v[52:55],a[12:15]
TR v[46:47],v6,14336
s_waitcnt lgkmcnt(8)
MM v[200:203],v[56:59],a[16:19]
TR v[48:49],v7,0
s_add_u32 m0, s78, 66560
MM v[200:203],v[60:63],a[24:27]
TR v[50:51],v7,2048
buffer_load_dwordx4 v28, s[32:35], s96 offen lds
MM v[204:207],v[56:59],a[20:23]
TR v[52:53],v7,4096
MM v[204:207],v[60:63],a[28:31]
TR v[54:55],v7,6144
s_waitcnt lgkmcnt(8)
MM v[208:211],v[32:35],a[0:3]
TR v[56:57],v7,8192
buffer_load_dwordx4 a[72:75], v2, s[36:39], s73 offen offset:2048 sc1
MM v[208:211],v[36:39],a[8:11]
TR v[58:59],v7,10240
MM v[212:215],v[32:35],a[4:7]
TR v[60:61],v7,12288
s_add_u32 m0, s78, 82944
MM v[212:215],v[36:39],a[12:15]
TR v[62:63],v7,14336
s_waitcnt lgkmcnt(8)
buffer_load_dwordx4 v28, s[44:47], s96 offen lds
MM v[208:211],v[40:43],a[16:19]
TR v[32:33],v4,16384
MM v[208:211],v[44:47],a[24:27]
TR v[34:35],v4,18432
MM v[212:215],v[40:43],a[20:23]
TR v[36:37],v4,20480
buffer_load_dwordx4 a[76:79], v2, s[36:39], s73 offen offset:3072 sc1
MM v[212:215],v[44:47],a[28:31]
TR v[38:39],v4,22528
s_waitcnt lgkmcnt(8)
MM v[216:219],v[48:51],a[0:3]
TR v[40:41],v4,24576
s_add_u32 m0, s78, 67584
MM v[216:219],v[52:55],a[8:11]
TR v[42:43],v4,26624
buffer_load_dwordx4 v28, s[32:35], s97 offen lds
MM v[220:223],v[48:51],a[4:7]
TR v[44:45],v4,28672
MM v[220:223],v[52:55],a[12:15]
TR v[46:47],v4,30720
s_waitcnt lgkmcnt(8)
MM v[216:219],v[56:59],a[16:19]
TR v[48:49],v5,16384
buffer_load_dwordx4 a[80:83], v2, s[36:39], s76 offen offset:0 sc1
MM v[216:219],v[60:63],a[24:27]
TR v[50:51],v5,18432
MM v[220:223],v[56:59],a[20:23]
TR v[52:53],v5,20480
s_add_u32 m0, s78, 83968
MM v[220:223],v[60:63],a[28:31]
TR v[54:55],v5,22528
s_waitcnt lgkmcnt(8)
buffer_load_dwordx4 v28, s[44:47], s97 offen lds
MM v[224:227],v[32:35],a[0:3]
TR v[56:57],v5,24576
MM v[224:227],v[36:39],a[8:11]
TR v[58:59],v5,26624
MM v[228:231],v[32:35],a[4:7]
TR v[60:61],v5,28672
buffer_load_dwordx4 a[84:87], v2, s[36:39], s76 offen offset:1024 sc1
MM v[228:231],v[36:39],a[12:15]
TR v[62:63],v5,30720
s_waitcnt lgkmcnt(8)
MM v[224:227],v[40:43],a[16:19]
TR v[32:33],v6,16384
s_add_u32 m0, s78, 68608
MM v[224:227],v[44:47],a[24:27]
TR v[34:35],v6,18432
buffer_load_dwordx4 v28, s[32:35], s98 offen lds
MM v[228:231],v[40:43],a[20:23]
TR v[36:37],v6,20480
MM v[228:231],v[44:47],a[28:31]
TR v[38:39],v6,22528
s_waitcnt lgkmcnt(8)
MM v[232:235],v[48:51],a[0:3]
TR v[40:41],v6,24576
buffer_load_dwordx4 a[88:91], v2, s[36:39], s76 offen offset:2048 sc1
MM v[232:235],v[52:55],a[8:11]
TR v[42:43],v6,26624
MM v[236:239],v[48:51],a[4:7]
TR v[44:45],v6,28672
s_add_u32 m0, s78, 84992
MM v[236:239],v[52:55],a[12:15]
TR v[46:47],v6,30720
s_waitcnt lgkmcnt(8)
buffer_load_dwordx4 v28, s[44:47], s98 offen lds
MM v[232:235],v[56:59],a[16:19]
TR v[48:49],v7,16384
MM v[232:235],v[60:63],a[24:27]
TR v[50:51],v7,18432
MM v[236:239],v[56:59],a[20:23]
TR v[52:53],v7,20480
buffer_load_dwordx4 a[92:95], v2, s[36:39], s76 offen offset:3072 sc1
MM v[236:239],v[60:63],a[28:31]
TR v[54:55],v7,22528
s_waitcnt lgkmcnt(8)
s_add_u32 s99, s99, 1
s_add_u32 s73, s73, s66
MM v[240:243],v[32:35],a[0:3]
TR v[56:57],v7,24576
s_cmp_eq_u32 s99, 14
s_cselect_b32 s75, s64, s75
s_cselect_b32 s73, s65, s73
s_cselect_b32 s66, s68, s66
s_add_u32 s76, s73, 4096
MM v[240:243],v[36:39],a[8:11]
TR v[58:59],v7,26624
s_lshr_b64 s[48:49], s[48:49], 4
s_and_b32 s72, s48, 15
MM v[244:247],v[32:35],a[4:7]
TR v[60:61],v7,28672
s_lshl_b32 s72, s72, 16
s_add_u32 s72, s72, s75
MM v[244:247],v[36:39],a[12:15]
TR v[62:63],v7,30720
s_waitcnt lgkmcnt(8)
s_waitcnt vmcnt(16)
s_barrier
s_add_u32 s96, s72, 16384
s_add_u32 s97, s72, 32768
MM v[240:243],v[40:43],a[16:19]
TR v[32:33],v4,32768
s_add_u32 s98, s72, 49152
s_lshl_b32 s30, s24, 2
s_add_u32 s30, s30, s80
s_cmp_lg_u32 s30, 3
s_cbranch_scc1 Lg34
v_mov_b32 v25, 1
s_mov_b64 exec, 1
global_atomic_add v24, v25, s[22:23] sc1
s_mov_b64 exec, -1
Lg34:
MM v[240:243],v[44:47],a[24:27]
TR v[34:35],v4,34816
MM v[244:247],v[40:43],a[20:23]
TR v[36:37],v4,36864
MM v[244:247],v[44:47],a[28:31]
TR v[38:39],v4,38912
s_waitcnt lgkmcnt(8)
MM v[248:251],v[48:51],a[0:3]
TR v[40:41],v4,40960
global_load_dword v29, v30, s[22:23] offset:768 sc1
MM v[248:251],v[52:55],a[8:11]
TR v[42:43],v4,43008
MM v[252:255],v[48:51],a[4:7]
TR v[44:45],v4,45056
MM v[252:255],v[52:55],a[12:15]
TR v[46:47],v4,47104
s_waitcnt lgkmcnt(8)
MM v[248:251],v[56:59],a[16:19]
TR v[48:49],v5,32768
MM v[248:251],v[60:63],a[24:27]
TR v[50:51],v5,34816
MM v[252:255],v[56:59],a[20:23]
TR v[52:53],v5,36864
MM v[252:255],v[60:63],a[28:31]
TR v[54:55],v5,38912
s_waitcnt lgkmcnt(8)
s_cmp_ge_u32 s99, s67
s_cbranch_scc1 L2_fin1
MM v[192:195],v[32:35],a[32:35]
TR v[56:57],v5,40960
MM v[192:195],v[36:39],a[40:43]
TR v[58:59],v5,43008
s_add_u32 m0, s78, 98304
MM v[196:199],v[32:35],a[36:39]
TR v[60:61],v5,45056
buffer_load_dwordx4 v28, s[32:35], s72 offen lds
MM v[196:199],v[36:39],a[44:47]
TR v[62:63],v5,47104
s_waitcnt lgkmcnt(8)
MM v[192:195],v[40:43],a[48:51]
TR v[32:33],v6,32768
buffer_load_dwordx4 a[96:99], v2, s[36:39], s73 offen offset:0 sc1
MM v[192:195],v[44:47],a[56:59]
TR v[34:35],v6,34816
MM v[196:199],v[40:43],a[52:55]
TR v[36:37],v6,36864
s_add_u32 m0, s78, 114688
MM v[196:199],v[44:47],a[60:63]
TR v[38:39],v6,38912
s_waitcnt lgkmcnt(8)
buffer_load_dwordx4 v28, s[44:47], s72 offen lds
MM v[200:203],v[48:51],a[32:35]
TR v[40:41],v6,40960
MM v[200:203],v[52:55],a[40:43]
TR v[42:43],v6,43008
MM v[204:207],v[48:51],a[36:39]
TR v[44:45],v6,45056
buffer_load_dwordx4 a[100:103], v2, s[36:39], s73 offen offset:1024 sc1
MM v[204:207],v[52:55],a[44:47]
TR v[46:47],v6,47104
s_waitcnt lgkmcnt(8)
MM v[200:203],v[56:59],a[48:51]
TR v[48:49],v7,32768
s_add_u32 m0, s78, 99328
MM v[200:203],v[60:63],a[56:59]
TR v[50:51],v7,34816
buffer_load_dwordx4 v28, s[32:35], s96 offen lds
MM v[204:207],v[56:59],a[52:55]
TR v[52:53],v7,36864
MM v[204:207],v[60:63],a[60:63]
TR v[54:55],v7,38912
s_waitcnt lgkmcnt(8)
MM v[208:211],v[32:35],a[32:35]
TR v[56:57],v7,40960
buffer_load_dwordx4 a[104:107], v2, s[36:39], s73 offen offset:2048 sc1
MM v[208:211],v[36:39],a[40:43]
TR v[58:59],v7,43008
MM v[212:215],v[32:35],a[36:39]
TR v[60:61],v7,45056
s_add_u32 m0, s78, 115712
MM v[212:215],v[36:39],a[44:47]
TR v[62:63],v7,47104
s_waitcnt lgkmcnt(8)
buffer_load_dwordx4 v28, s[44:47], s96 offen lds
MM v[208:211],v[40:43],a[48:51]
TR v[32:33],v4,49152
MM v[208:211],v[44:47],a[56:59]
TR v[34:35],v4,51200
MM v[212:215],v[40:43],a[52:55]
TR v[36:37],v4,53248
buffer_load_dwordx4 a[108:111], v2, s[36:39], s73 offen offset:3072 sc1
MM v[212:215],v[44:47],a[60:63]
TR v[38:39],v4,55296
s_waitcnt lgkmcnt(8)
MM v[216:219],v[48:51],a[32:35]
TR v[40:41],v4,57344
s_add_u32 m0, s78, 100352
MM v[216:219],v[52:55],a[40:43]
TR v[42:43],v4,59392
buffer_load_dwordx4 v28, s[32:35], s97 offen lds
MM v[220:223],v[48:51],a[36:39]
TR v[44:45],v4,61440
MM v[220:223],v[52:55],a[44:47]
TR v[46:47],v4,63488
s_waitcnt lgkmcnt(8)
MM v[216:219],v[56:59],a[48:51]
TR v[48:49],v5,49152
buffer_load_dwordx4 a[112:115], v2, s[36:39], s76 offen offset:0 sc1
MM v[216:219],v[60:63],a[56:59]
TR v[50:51],v5,51200
MM v[220:223],v[56:59],a[52:55]
TR v[52:53],v5,53248
s_add_u32 m0, s78, 116736
MM v[220:223],v[60:63],a[60:63]
TR v[54:55],v5,55296
s_waitcnt lgkmcnt(8)
buffer_load_dwordx4 v28, s[44:47], s97 offen lds
MM v[224:227],v[32:35],a[32:35]
TR v[56:57],v5,57344
MM v[224:227],v[36:39],a[40:43]
TR v[58:59],v5,59392
MM v[228:231],v[32:35],a[36:39]
TR v[60:61],v5,61440
buffer_load_dwordx4 a[116:119], v2, s[36:39], s76 offen offset:1024 sc1
MM v[228:231],v[36:39],a[44:47]
TR v[62:63],v5,63488
s_waitcnt lgkmcnt(8)
MM v[224:227],v[40:43],a[48:51]
TR v[32:33],v6,49152
s_add_u32 m0, s78, 101376
MM v[224:227],v[44:47],a[56:59]
TR v[34:35],v6,51200
buffer_load_dwordx4 v28, s[32:35], s98 offen lds
MM v[228:231],v[40:43],a[52:55]
TR v[36:37],v6,53248
MM v[228:231],v[44:47],a[60:63]
TR v[38:39],v6,55296
s_waitcnt lgkmcnt(8)
MM v[232:235],v[48:51],a[32:35]
TR v[40:41],v6,57344
buffer_load_dwordx4 a[120:123], v2, s[36:39], s76 offen offset:2048 sc1
MM v[232:235],v[52:55],a[40:43]
TR v[42:43],v6,59392
MM v[236:239],v[48:51],a[36:39]
TR v[44:45],v6,61440
s_add_u32 m0, s78, 117760
MM v[236:239],v[52:55],a[44:47]
TR v[46:47],v6,63488
s_waitcnt lgkmcnt(8)
buffer_load_dwordx4 v28, s[44:47], s98 offen lds
MM v[232:235],v[56:59],a[48:51]
TR v[48:49],v7,49152
MM v[232:235],v[60:63],a[56:59]
TR v[50:51],v7,51200
MM v[236:239],v[56:59],a[52:55]
TR v[52:53],v7,53248
buffer_load_dwordx4 a[124:127], v2, s[36:39], s76 offen offset:3072 sc1
MM v[236:239],v[60:63],a[60:63]
TR v[54:55],v7,55296
s_waitcnt lgkmcnt(8)
s_add_u32 s99, s99, 1
s_add_u32 s73, s73, s66
MM v[240:243],v[32:35],a[32:35]
TR v[56:57],v7,57344
s_cmp_eq_u32 s99, 14
s_cselect_b32 s75, s64, s75
s_cselect_b32 s73, s65, s73
s_cselect_b32 s66, s68, s66
s_add_u32 s76, s73, 4096
MM v[240:243],v[36:39],a[40:43]
TR v[58:59],v7,59392
s_lshr_b64 s[48:49], s[48:49], 4
s_and_b32 s72, s48, 15
MM v[244:247],v[32:35],a[36:39]
TR v[60:61],v7,61440
s_lshl_b32 s72, s72, 16
s_add_u32 s72, s72, s75
MM v[244:247],v[36:39],a[44:47]
TR v[62:63],v7,63488
s_waitcnt lgkmcnt(8)
s_waitcnt vmcnt(16)
s_barrier
s_add_u32 s96, s72, 16384
s_add_u32 s97, s72, 32768
MM v[240:243],v[40:43],a[48:51]
TR v[32:33],v8,0
s_add_u32 s98, s72, 49152
MM v[240:243],v[44:47],a[56:59]
TR v[34:35],v8,2048
MM v[244:247],v[40:43],a[52:55]
TR v[36:37],v8,4096
MM v[244:247],v[44:47],a[60:63]
TR v[38:39],v8,6144
s_waitcnt lgkmcnt(8)
MM v[248:251],v[48:51],a[32:35]
TR v[40:41],v8,8192
MM v[248:251],v[52:55],a[40:43]
TR v[42:43],v8,10240
MM v[252:255],v[48:51],a[36:39]
TR v[44:45],v8,12288
MM v[252:255],v[52:55],a[44:47]
TR v[46:47],v8,14336
s_waitcnt lgkmcnt(8)
MM v[248:251],v[56:59],a[48:51]
TR v[48:49],v9,0
MM v[248:251],v[60:63],a[56:59]
TR v[50:51],v9,2048
MM v[252:255],v[56:59],a[52:55]
TR v[52:53],v9,4096
v_readfirstlane_b32 s30, v29
s_nop 0
s_cmp_ge_u32 s30, 16
s_cbranch_scc1 Ld36
s_mov_b32 s31, 262144
Lp35:
global_load_dword v29, v30, s[22:23] offset:768 sc1
s_waitcnt vmcnt(0)
v_readfirstlane_b32 s30, v29
s_nop 0
s_cmp_ge_u32 s30, 16
s_cbranch_scc1 Ld36
s_sleep 2
s_sub_u32 s31, s31, 1
s_cmp_lg_u32 s31, 0
s_cbranch_scc1 Lp35
Ld36:
MM v[252:255],v[60:63],a[60:63]
TR v[54:55],v9,6144
s_waitcnt lgkmcnt(8)
MM v[192:195],v[32:35],a[64:67]
TR v[56:57],v9,8192
MM v[192:195],v[36:39],a[72:75]
TR v[58:59],v9,10240
s_add_u32 m0, s78, 0
MM v[196:199],v[32:35],a[68:71]
TR v[60:61],v9,12288
buffer_load_dwordx4 v28, s[32:35], s72 offen lds
MM v[196:199],v[36:39],a[76:79]
TR v[62:63],v9,14336
s_waitcnt lgkmcnt(8)
MM v[192:195],v[40:43],a[80:83]
TR v[32:33],v10,0
buffer_load_dwordx4 a[0:3], v2, s[36:39], s73 offen offset:0 sc1
MM v[192:195],v[44:47],a[88:91]
TR v[34:35],v10,2048
MM v[196:199],v[40:43],a[84:87]
TR v[36:37],v10,4096
s_add_u32 m0, s78, 16384
MM v[196:199],v[44:47],a[92:95]
TR v[38:39],v10,6144
s_waitcnt lgkmcnt(8)
buffer_load_dwordx4 v28, s[44:47], s72 offen lds
MM v[200:203],v[48:51],a[64:67]
TR v[40:41],v10,8192
MM v[200:203],v[52:55],a[72:75]
TR v[42:43],v10,10240
MM v[204:207],v[48:51],a[68:71]
TR v[44:45],v10,12288
buffer_load_dwordx4 a[4:7], v2, s[36:39], s73 offen offset:1024 sc1
MM v[204:207],v[52:55],a[76:79]
TR v[46:47],v10,14336
s_waitcnt lgkmcnt(8)
MM v[200:203],v[56:59],a[80:83]
TR v[48:49],v11,0
s_add_u32 m0, s78, 1024
MM v[200:203],v[60:63],a[88:91]
TR v[50:51],v11,2048
buffer_load_dwordx4 v28, s[32:35], s96 offen lds
MM v[204:207],v[56:59],a[84:87]
TR v[52:53],v11,4096
MM v[204:207],v[60:63],a[92:95]
TR v[54:55],v11,6144
s_waitcnt lgkmcnt(8)
MM v[208:211],v[32:35],a[64:67]
TR v[56:57],v11,8192
buffer_load_dwordx4 a[8:11], v2, s[36:39], s73 offen offset:2048 sc1
MM v[208:211],v[36:39],a[72:75]
TR v[58:59],v11,10240
MM v[212:215],v[32:35],a[68:71]
TR v[60:61],v11,12288
s_add_u32 m0, s78, 17408
MM v[212:215],v[36:39],a[76:79]
TR v[62:63],v11,14336
s_waitcnt lgkmcnt(8)
buffer_load_dwordx4 v28, s[44:47], s96 offen lds
MM v[208:211],v[40:43],a[80:83]
TR v[32:33],v8,16384
MM v[208:211],v[44:47],a[88:91]
TR v[34:35],v8,18432
MM v[212:215],v[40:43],a[84:87]
TR v[36:37],v8,20480
buffer_load_dwordx4 a[12:15], v2, s[36:39], s73 offen offset:3072 sc1
MM v[212:215],v[44:47],a[92:95]
TR v[38:39],v8,22528
s_waitcnt lgkmcnt(8)
MM v[216:219],v[48:51],a[64:67]
TR v[40:41],v8,24576
s_add_u32 m0, s78, 2048
MM v[216:219],v[52:55],a[72:75]
TR v[42:43],v8,26624
buffer_load_dwordx4 v28, s[32:35], s97 offen lds
MM v[220:223],v[48:51],a[68:71]
TR v[44:45],v8,28672
MM v[220:223],v[52:55],a[76:79]
TR v[46:47],v8,30720
s_waitcnt lgkmcnt(8)
MM v[216:219],v[56:59],a[80:83]
TR v[48:49],v9,16384
buffer_load_dwordx4 a[16:19], v2, s[36:39], s76 offen offset:0 sc1
MM v[216:219],v[60:63],a[88:91]
TR v[50:51],v9,18432
MM v[220:223],v[56:59],a[84:87]
TR v[52:53],v9,20480
s_add_u32 m0, s78, 18432
MM v[220:223],v[60:63],a[92:95]
TR v[54:55],v9,22528
s_waitcnt lgkmcnt(8)
buffer_load_dwordx4 v28, s[44:47], s97 offen lds
MM v[224:227],v[32:35],a[64:67]
TR v[56:57],v9,24576
MM v[224:227],v[36:39],a[72:75]
TR v[58:59],v9,26624
MM v[228:231],v[32:35],a[68:71]
TR v[60:61],v9,28672
buffer_load_dwordx4 a[20:23], v2, s[36:39], s76 offen offset:1024 sc1
MM v[228:231],v[36:39],a[76:79]
TR v[62:63],v9,30720
s_waitcnt lgkmcnt(8)
MM v[224:227],v[40:43],a[80:83]
TR v[32:33],v10,16384
s_add_u32 m0, s78, 3072
MM v[224:227],v[44:47],a[88:91]
TR v[34:35],v10,18432
buffer_load_dwordx4 v28, s[32:35], s98 offen lds
MM v[228:231],v[40:43],a[84:87]
TR v[36:37],v10,20480
MM v[228:231],v[44:47],a[92:95]
TR v[38:39],v10,22528
s_waitcnt lgkmcnt(8)
MM v[232:235],v[48:51],a[64:67]
TR v[40:41],v10,24576
buffer_load_dwordx4 a[24:27], v2, s[36:39], s76 offen offset:2048 sc1
MM v[232:235],v[52:55],a[72:75]
TR v[42:43],v10,26624
MM v[236:239],v[48:51],a[68:71]
TR v[44:45],v10,28672
s_add_u32 m0, s78, 19456
MM v[236:239],v[52:55],a[76:79]
TR v[46:47],v10,30720
s_waitcnt lgkmcnt(8)
buffer_load_dwordx4 v28, s[44:47], s98 offen lds
MM v[232:235],v[56:59],a[80:83]
TR v[48:49],v11,16384
MM v[232:235],v[60:63],a[88:91]
TR v[50:51],v11,18432
MM v[236:239],v[56:59],a[84:87]
TR v[52:53],v11,20480
buffer_load_dwordx4 a[28:31], v2, s[36:39], s76 offen offset:3072 sc1
MM v[236:239],v[60:63],a[92:95]
TR v[54:55],v11,22528
s_waitcnt lgkmcnt(8)
s_add_u32 s99, s99, 1
s_add_u32 s73, s73, s66
MM v[240:243],v[32:35],a[64:67]
TR v[56:57],v11,24576
s_cmp_eq_u32 s99, 14
s_cselect_b32 s75, s64, s75
s_cselect_b32 s73, s65, s73
s_cselect_b32 s66, s68, s66
s_add_u32 s76, s73, 4096
MM v[240:243],v[36:39],a[72:75]
TR v[58:59],v11,26624
s_lshr_b64 s[48:49], s[48:49], 4
s_and_b32 s72, s48, 15
MM v[244:247],v[32:35],a[68:71]
TR v[60:61],v11,28672
s_lshl_b32 s72, s72, 16
s_add_u32 s72, s72, s75
MM v[244:247],v[36:39],a[76:79]
TR v[62:63],v11,30720
s_waitcnt lgkmcnt(8)
s_waitcnt vmcnt(16)
s_barrier
s_add_u32 s96, s72, 16384
s_add_u32 s97, s72, 32768
MM v[240:243],v[40:43],a[80:83]
TR v[32:33],v8,32768
s_add_u32 s98, s72, 49152
MM v[240:243],v[44:47],a[88:91]
TR v[34:35],v8,34816
MM v[244:247],v[40:43],a[84:87]
TR v[36:37],v8,36864
MM v[244:247],v[44:47],a[92:95]
TR v[38:39],v8,38912
s_waitcnt lgkmcnt(8)
MM v[248:251],v[48:51],a[64:67]
TR v[40:41],v8,40960
global_load_dword v25, v26, s[22:23] sc1
MM v[248:251],v[52:55],a[72:75]
TR v[42:43],v8,43008
MM v[252:255],v[48:51],a[68:71]
TR v[44:45],v8,45056
MM v[252:255],v[52:55],a[76:79]
TR v[46:47],v8,47104
s_waitcnt lgkmcnt(8)
MM v[248:251],v[56:59],a[80:83]
TR v[48:49],v9,32768
MM v[248:251],v[60:63],a[88:91]
TR v[50:51],v9,34816
MM v[252:255],v[56:59],a[84:87]
TR v[52:53],v9,36864
MM v[252:255],v[60:63],a[92:95]
TR v[54:55],v9,38912
s_waitcnt lgkmcnt(8)
s_cmp_ge_u32 s99, s67
s_cbranch_scc1 L2_fin3
MM v[192:195],v[32:35],a[96:99]
TR v[56:57],v9,40960
MM v[192:195],v[36:39],a[104:107]
TR v[58:59],v9,43008
s_add_u32 m0, s78, 32768
MM v[196:199],v[32:35],a[100:103]
TR v[60:61],v9,45056
buffer_load_dwordx4 v28, s[32:35], s72 offen lds
MM v[196:199],v[36:39],a[108:111]
TR v[62:63],v9,47104
s_waitcnt lgkmcnt(8)
MM v[192:195],v[40:43],a[112:115]
TR v[32:33],v10,32768
buffer_load_dwordx4 a[32:35], v2, s[36:39], s73 offen offset:0 sc1
MM v[192:195],v[44:47],a[120:123]
TR v[34:35],v10,34816
MM v[196:199],v[40:43],a[116:119]
TR v[36:37],v10,36864
s_add_u32 m0, s78, 49152
MM v[196:199],v[44:47],a[124:127]
TR v[38:39],v10,38912
s_waitcnt lgkmcnt(8)
buffer_load_dwordx4 v28, s[44:47], s72 offen lds
MM v[200:203],v[48:51],a[96:99]
TR v[40:41],v10,40960
MM v[200:203],v[52:55],a[104:107]
TR v[42:43],v10,43008
MM v[204:207],v[48:51],a[100:103]
TR v[44:45],v10,45056
buffer_load_dwordx4 a[36:39], v2, s[36:39], s73 offen offset:1024 sc1
MM v[204:207],v[52:55],a[108:111]
TR v[46:47],v10,47104
s_waitcnt lgkmcnt(8)
MM v[200:203],v[56:59],a[112:115]
TR v[48:49],v11,32768
s_add_u32 m0, s78, 33792
MM v[200:203],v[60:63],a[120:123]
TR v[50:51],v11,34816
buffer_load_dwordx4 v28, s[32:35], s96 offen lds
MM v[204:207],v[56:59],a[116:119]
TR v[52:53],v11,36864
MM v[204:207],v[60:63],a[124:127]
TR v[54:55],v11,38912
s_waitcnt lgkmcnt(8)
MM v[208:211],v[32:35],a[96:99]
TR v[56:57],v11,40960
buffer_load_dwordx4 a[40:43], v2, s[36:39], s73 offen offset:2048 sc1
MM v[208:211],v[36:39],a[104:107]
TR v[58:59],v11,43008
MM v[212:215],v[32:35],a[100:103]
TR v[60:61],v11,45056
s_add_u32 m0, s78, 50176
MM v[212:215],v[36:39],a[108:111]
TR v[62:63],v11,47104
s_waitcnt lgkmcnt(8)
buffer_load_dwordx4 v28, s[44:47], s96 offen lds
MM v[208:211],v[40:43],a[112:115]
TR v[32:33],v8,49152
MM v[208:211],v[44:47],a[120:123]
TR v[34:35],v8,51200
MM v[212:215],v[40:43],a[116:119]
TR v[36:37],v8,53248
buffer_load_dwordx4 a[44:47], v2, s[36:39], s73 offen offset:3072 sc1
MM v[212:215],v[44:47],a[124:127]
TR v[38:39],v8,55296
s_waitcnt lgkmcnt(8)
MM v[216:219],v[48:51],a[96:99]
TR v[40:41],v8,57344
s_add_u32 m0, s78, 34816
MM v[216:219],v[52:55],a[104:107]
TR v[42:43],v8,59392
buffer_load_dwordx4 v28, s[32:35], s97 offen lds
MM v[220:223],v[48:51],a[100:103]
TR v[44:45],v8,61440
MM v[220:223],v[52:55],a[108:111]
TR v[46:47],v8,63488
s_waitcnt lgkmcnt(8)
MM v[216:219],v[56:59],a[112:115]
TR v[48:49],v9,49152
buffer_load_dwordx4 a[48:51], v2, s[36:39], s76 offen offset:0 sc1
MM v[216:219],v[60:63],a[120:123]
TR v[50:51],v9,51200
MM v[220:223],v[56:59],a[116:119]
TR v[52:53],v9,53248
s_add_u32 m0, s78, 51200
MM v[220:223],v[60:63],a[124:127]
TR v[54:55],v9,55296
s_waitcnt lgkmcnt(8)
buffer_load_dwordx4 v28, s[44:47], s97 offen lds
MM v[224:227],v[32:35],a[96:99]
TR v[56:57],v9,57344
MM v[224:227],v[36:39],a[104:107]
TR v[58:59],v9,59392
MM v[228:231],v[32:35],a[100:103]
TR v[60:61],v9,61440
buffer_load_dwordx4 a[52:55], v2, s[36:39], s76 offen offset:1024 sc1
MM v[228:231],v[36:39],a[108:111]
TR v[62:63],v9,63488
s_waitcnt lgkmcnt(8)
MM v[224:227],v[40:43],a[112:115]
TR v[32:33],v10,49152
s_add_u32 m0, s78, 35840
MM v[224:227],v[44:47],a[120:123]
TR v[34:35],v10,51200
buffer_load_dwordx4 v28, s[32:35], s98 offen lds
MM v[228:231],v[40:43],a[116:119]
TR v[36:37],v10,53248
MM v[228:231],v[44:47],a[124:127]
TR v[38:39],v10,55296
s_waitcnt lgkmcnt(8)
MM v[232:235],v[48:51],a[96:99]
TR v[40:41],v10,57344
buffer_load_dwordx4 a[56:59], v2, s[36:39], s76 offen offset:2048 sc1
MM v[232:235],v[52:55],a[104:107]
TR v[42:43],v10,59392
MM v[236:239],v[48:51],a[100:103]
TR v[44:45],v10,61440
s_add_u32 m0, s78, 52224
MM v[236:239],v[52:55],a[108:111]
TR v[46:47],v10,63488
s_waitcnt lgkmcnt(8)
buffer_load_dwordx4 v28, s[44:47], s98 offen lds
MM v[232:235],v[56:59],a[112:115]
TR v[48:49],v11,49152
MM v[232:235],v[60:63],a[120:123]
TR v[50:51],v11,51200
MM v[236:239],v[56:59],a[116:119]
TR v[52:53],v11,53248
buffer_load_dwordx4 a[60:63], v2, s[36:39], s76 offen offset:3072 sc1
MM v[236:239],v[60:63],a[124:127]
TR v[54:55],v11,55296
s_waitcnt lgkmcnt(8)
s_add_u32 s99, s99, 1
s_add_u32 s73, s73, s66
MM v[240:243],v[32:35],a[96:99]
TR v[56:57],v11,57344
s_cmp_eq_u32 s99, 14
s_cselect_b32 s75, s64, s75
s_cselect_b32 s73, s65, s73
s_cselect_b32 s66, s68, s66
s_add_u32 s76, s73, 4096
MM v[240:243],v[36:39],a[104:107]
TR v[58:59],v11,59392
s_lshr_b64 s[48:49], s[48:49], 4
s_and_b32 s72, s48, 15
MM v[244:247],v[32:35],a[100:103]
TR v[60:61],v11,61440
s_lshl_b32 s72, s72, 16
s_add_u32 s72, s72, s75
MM v[244:247],v[36:39],a[108:111]
TR v[62:63],v11,63488
s_waitcnt lgkmcnt(8)
s_waitcnt vmcnt(16)
s_barrier
s_add_u32 s96, s72, 16384
s_add_u32 s97, s72, 32768
MM v[240:243],v[40:43],a[112:115]
TR v[32:33],v4,0
s_add_u32 s98, s72, 49152
MM v[240:243],v[44:47],a[120:123]
TR v[34:35],v4,2048
MM v[244:247],v[40:43],a[116:119]
TR v[36:37],v4,4096
MM v[244:247],v[44:47],a[124:127]
TR v[38:39],v4,6144
s_waitcnt lgkmcnt(8)
MM v[248:251],v[48:51],a[96:99]
TR v[40:41],v4,8192
MM v[248:251],v[52:55],a[104:107]
TR v[42:43],v4,10240
MM v[252:255],v[48:51],a[100:103]
TR v[44:45],v4,12288
MM v[252:255],v[52:55],a[108:111]
TR v[46:47],v4,14336
s_waitcnt lgkmcnt(8)
MM v[248:251],v[56:59],a[112:115]
TR v[48:49],v5,0
MM v[248:251],v[60:63],a[120:123]
TR v[50:51],v5,2048
MM v[252:255],v[56:59],a[116:119]
TR v[52:53],v5,4096
MM v[252:255],v[60:63],a[124:127]
TR v[54:55],v5,6144
s_waitcnt lgkmcnt(8)
v_readfirstlane_b32 s30, v25
s_nop 0
s_cmp_ge_u32 s30, 16
s_cbranch_scc1 Ld38
s_mov_b32 s31, 262144
Lp37:
global_load_dword v25, v26, s[22:23] offset:0 sc1
s_waitcnt vmcnt(0)
v_readfirstlane_b32 s30, v25
s_nop 0
s_cmp_ge_u32 s30, 16
s_cbranch_scc1 Ld38
s_sleep 1
s_sub_u32 s31, s31, 1
s_cmp_lg_u32 s31, 0
s_cbranch_scc1 Lp37
Ld38:
v_mov_b32 v26, v27
s_mov_b32 s80, 0
s_branch L2_loop
L2_fin1:
s_add_u32 s32, s8, s79
s_addc_u32 s33, s9, 0
s_sub_u32 s34, 2097152, s79
s_lshl_b32 s72, s24, 16
s_mov_b32 s75, 0
MM v[192:195],v[32:35],a[32:35]
TR v[56:57],v5,40960
s_add_u32 s98, s75, 0
s_and_b32 s98, s98, 3
s_lshl_b32 s97, s98, 19
s_add_u32 s97, s97, s72
s_lshl_b32 s98, s98, 14
s_add_u32 m0, s78, 98304
s_add_u32 s96, s97, 0
v_mov_b32 v27, s93
MM v[192:195],v[36:39],a[40:43]
TR v[58:59],v5,43008
buffer_load_dwordx4 v28, s[32:35], s96 offen lds
v_xor_b32 v26, 128, v27
MM v[196:199],v[32:35],a[36:39]
TR v[60:61],v5,45056
s_mov_b32 s3, 0xffff0000
MM v[196:199],v[36:39],a[44:47]
TR v[62:63],v5,47104
s_waitcnt lgkmcnt(8)
s_add_u32 m0, s78, 99328
s_add_u32 s96, s97, 16384
v_and_b32 v16, 15, v1
MM v[192:195],v[40:43],a[48:51]
TR v[32:33],v4,49152
buffer_load_dwordx4 v28, s[32:35], s96 offen lds
MM v[192:195],v[44:47],a[56:59]
TR v[34:35],v4,51200
v_lshlrev_b32 v16, 11, v16
MM v[196:199],v[40:43],a[52:55]
TR v[36:37],v4,53248
v_bfe_u32 v17, v1, 4, 1
MM v[196:199],v[44:47],a[60:63]
TR v[38:39],v4,55296
s_waitcnt lgkmcnt(8)
s_add_u32 m0, s78, 100352
s_add_u32 s96, s97, 32768
v_lshl_add_u32 v16, v17, 5, v16
MM v[200:203],v[48:51],a[32:35]
TR v[40:41],v4,57344
buffer_load_dwordx4 v28, s[32:35], s96 offen lds
v_lshrrev_b32 v17, 5, v1
MM v[200:203],v[52:55],a[40:43]
TR v[42:43],v4,59392
MM v[204:207],v[48:51],a[36:39]
TR v[44:45],v4,61440
s_add_u32 m0, s78, 101376
s_add_u32 s96, s97, 49152
v_lshl_add_u32 v16, v17, 4, v16
MM v[204:207],v[52:55],a[44:47]
TR v[46:47],v4,63488
s_waitcnt lgkmcnt(8)
buffer_load_dwordx4 v28, s[32:35], s96 offen lds
v_add_u32 v16, s94, v16
MM v[200:203],v[56:59],a[48:51]
TR v[48:49],v5,49152
v_add_u32 v17, 32768, v16
MM v[200:203],v[60:63],a[56:59]
TR v[50:51],v5,51200
MM v[204:207],v[56:59],a[52:55]
TR v[52:53],v5,53248
s_add_u32 m0, s78, 114688
s_add_u32 s96, s97, 262144
v_add_u32 v160, 0x20000, v4
MM v[204:207],v[60:63],a[60:63]
TR v[54:55],v5,55296
s_waitcnt lgkmcnt(8)
buffer_load_dwordx4 v28, s[32:35], s96 offen lds
v_add_u32 v161, 0x20000, v5
MM v[224:227],v[32:35],a[32:35]
TR v[56:57],v5,57344
v_add_u32 v162, 0x20000, v6
MM v[224:227],v[36:39],a[40:43]
TR v[58:59],v5,59392
v_add_u32 v163, 0x20000, v7
MM v[228:231],v[32:35],a[36:39]
TR v[60:61],v5,61440
s_add_u32 m0, s78, 115712
s_add_u32 s96, s97, 278528
MM v[228:231],v[36:39],a[44:47]
TR v[62:63],v5,63488
s_waitcnt lgkmcnt(8)
buffer_load_dwordx4 v28, s[32:35], s96 offen lds
v_mov_b32 v64, 0
MM v[224:227],v[40:43],a[48:51]
TR v[32:33],v6,49152
v_mov_b32 v65, 0
MM v[224:227],v[44:47],a[56:59]
TR v[34:35],v6,51200
s_add_u32 m0, s78, 116736
s_add_u32 s96, s97, 294912
v_mov_b32 v66, 0
MM v[228:231],v[40:43],a[52:55]
TR v[36:37],v6,53248
buffer_load_dwordx4 v28, s[32:35], s96 offen lds
v_mov_b32 v67, 0
MM v[228:231],v[44:47],a[60:63]
TR v[38:39],v6,55296
s_waitcnt lgkmcnt(8)
MM v[232:235],v[48:51],a[32:35]
TR v[40:41],v6,57344
v_mov_b32 v68, 0
MM v[232:235],v[52:55],a[40:43]
TR v[42:43],v6,59392
s_add_u32 m0, s78, 117760
s_add_u32 s96, s97, 311296
v_mov_b32 v69, 0
MM v[236:239],v[48:51],a[36:39]
TR v[44:45],v6,61440
buffer_load_dwordx4 v28, s[32:35], s96 offen lds
v_mov_b32 v70, 0
MM v[236:239],v[52:55],a[44:47]
TR v[46:47],v6,63488
s_waitcnt lgkmcnt(8)
MM v[232:235],v[56:59],a[48:51]
TR v[48:49],v7,49152
s_add_u32 s73, s98, 229376
v_mov_b32 v71, 0
MM v[232:235],v[60:63],a[56:59]
TR v[50:51],v7,51200
buffer_load_dwordx4 a[96:99], v2, s[36:39], s73 offen offset:0 sc1
v_mov_b32 v72, 0
MM v[236:239],v[56:59],a[52:55]
TR v[52:53],v7,53248
v_mov_b32 v73, 0
MM v[236:239],v[60:63],a[60:63]
TR v[54:55],v7,55296
s_waitcnt lgkmcnt(8)
v_mov_b32 v74, 0
MM v[240:243],v[32:35],a[32:35]
TR v[56:57],v7,57344
MM v[240:243],v[36:39],a[40:43]
TR v[58:59],v7,59392
buffer_load_dwordx4 a[100:103], v2, s[36:39], s73 offen offset:1024 sc1
v_mov_b32 v75, 0
MM v[244:247],v[32:35],a[36:39]
TR v[60:61],v7,61440
v_mov_b32 v76, 0
MM v[244:247],v[36:39],a[44:47]
TR v[62:63],v7,63488
s_waitcnt lgkmcnt(8)
s_waitcnt vmcnt(10)
s_barrier
v_mov_b32 v77, 0
MM v[240:243],v[40:43],a[48:51]
TR v[32:33],v8,16384
MM v[240:243],v[44:47],a[56:59]
TR v[34:35],v8,18432
buffer_load_dwordx4 a[104:107], v2, s[36:39], s73 offen offset:2048 sc1
v_mov_b32 v78, 0
MM v[244:247],v[40:43],a[52:55]
TR v[36:37],v8,20480
v_mov_b32 v79, 0
MM v[244:247],v[44:47],a[60:63]
TR v[38:39],v8,22528
s_waitcnt lgkmcnt(8)
v_mov_b32 v80, 0
MM v[248:251],v[48:51],a[32:35]
TR v[40:41],v8,24576
buffer_load_dwordx4 a[108:111], v2, s[36:39], s73 offen offset:3072 sc1
v_mov_b32 v81, 0
MM v[248:251],v[52:55],a[40:43]
TR v[42:43],v8,26624
MM v[252:255],v[48:51],a[36:39]
TR v[44:45],v8,28672
v_mov_b32 v82, 0
MM v[252:255],v[52:55],a[44:47]
TR v[46:47],v8,30720
s_waitcnt lgkmcnt(8)
s_add_u32 s73, s98, 233472
v_mov_b32 v83, 0
MM v[248:251],v[56:59],a[48:51]
TR v[48:49],v9,16384
buffer_load_dwordx4 a[112:115], v2, s[36:39], s73 offen offset:0 sc1
v_mov_b32 v84, 0
MM v[248:251],v[60:63],a[56:59]
TR v[50:51],v9,18432
v_mov_b32 v85, 0
MM v[252:255],v[56:59],a[52:55]
TR v[52:53],v9,20480
MM v[252:255],v[60:63],a[60:63]
TR v[54:55],v9,22528
s_waitcnt lgkmcnt(8)
buffer_load_dwordx4 a[116:119], v2, s[36:39], s73 offen offset:1024 sc1
v_mov_b32 v86, 0
MM v[224:227],v[32:35],a[64:67]
TR v[56:57],v9,24576
v_mov_b32 v87, 0
MM v[224:227],v[36:39],a[72:75]
TR v[58:59],v9,26624
v_mov_b32 v88, 0
MM v[228:231],v[32:35],a[68:71]
TR v[60:61],v9,28672
MM v[228:231],v[36:39],a[76:79]
TR v[62:63],v9,30720
s_waitcnt lgkmcnt(8)
buffer_load_dwordx4 a[120:123], v2, s[36:39], s73 offen offset:2048 sc1
v_mov_b32 v89, 0
MM v[224:227],v[40:43],a[80:83]
TR v[32:33],v10,16384
v_mov_b32 v90, 0
MM v[224:227],v[44:47],a[88:91]
TR v[34:35],v10,18432
v_mov_b32 v91, 0
MM v[228:231],v[40:43],a[84:87]
TR v[36:37],v10,20480
v_mov_b32 v92, 0
MM v[228:231],v[44:47],a[92:95]
TR v[38:39],v10,22528
s_waitcnt lgkmcnt(8)
buffer_load_dwordx4 a[124:127], v2, s[36:39], s73 offen offset:3072 sc1
MM v[232:235],v[48:51],a[64:67]
TR v[40:41],v10,24576
v_mov_b32 v93, 0
MM v[232:235],v[52:55],a[72:75]
TR v[42:43],v10,26624
s_add_u32 s73, s98, 237568
v_mov_b32 v94, 0
MM v[236:239],v[48:51],a[68:71]
TR v[44:45],v10,28672
buffer_load_dwordx4 a[0:3], v2, s[36:39], s73 offen offset:0 sc1
v_mov_b32 v95, 0
MM v[236:239],v[52:55],a[76:79]
TR v[46:47],v10,30720
s_waitcnt lgkmcnt(8)
MM v[232:235],v[56:59],a[80:83]
TR v[48:49],v11,16384
MM v[232:235],v[60:63],a[88:91]
TR v[50:51],v11,18432
MM v[236:239],v[56:59],a[84:87]
TR v[52:53],v11,20480
buffer_load_dwordx4 a[4:7], v2, s[36:39], s73 offen offset:1024 sc1
v_cvt_pk_bf16_f32 v224, v224, v225
MM v[236:239],v[60:63],a[92:95]
TR v[54:55],v11,22528
s_waitcnt lgkmcnt(8)
v_cvt_pk_bf16_f32 v225, v226, v227
MM v[240:243],v[32:35],a[64:67]
TR v[56:57],v11,24576
v_cvt_pk_bf16_f32 v226, v228, v229
MM v[240:243],v[36:39],a[72:75]
TR v[58:59],v11,26624
buffer_load_dwordx4 a[8:11], v2, s[36:39], s73 offen offset:2048 sc1
v_cvt_pk_bf16_f32 v227, v230, v231
MM v[244:247],v[32:35],a[68:71]
TR v[60:61],v11,28672
buffer_store_dwordx4 v[224:227], v2, s[40:43], s74 offen offset:0 sc0 sc1
MM v[244:247],v[36:39],a[76:79]
TR v[62:63],v11,30720
s_waitcnt lgkmcnt(8)
MM v[240:243],v[40:43],a[80:83]
TR v[32:33],v6,32768
MM v[240:243],v[44:47],a[88:91]
TR v[34:35],v6,34816
buffer_load_dwordx4 a[12:15], v2, s[36:39], s73 offen offset:3072 sc1
MM v[244:247],v[40:43],a[84:87]
TR v[36:37],v6,36864
v_cvt_pk_bf16_f32 v232, v232, v233
MM v[244:247],v[44:47],a[92:95]
TR v[38:39],v6,38912
s_waitcnt lgkmcnt(8)
v_cvt_pk_bf16_f32 v233, v234, v235
MM v[248:251],v[48:51],a[64:67]
TR v[40:41],v6,40960
s_add_u32 s73, s98, 241664
v_cvt_pk_bf16_f32 v234, v236, v237
MM v[248:251],v[52:55],a[72:75]
TR v[42:43],v6,43008
buffer_load_dwordx4 a[16:19], v2, s[36:39], s73 offen offset:0 sc1
v_cvt_pk_bf16_f32 v235, v238, v239
MM v[252:255],v[48:51],a[68:71]
TR v[44:45],v6,45056
buffer_store_dwordx4 v[232:235], v2, s[40:43], s74 offen offset:1024 sc0 sc1
MM v[252:255],v[52:55],a[76:79]
TR v[46:47],v6,47104
s_waitcnt lgkmcnt(8)
MM v[248:251],v[56:59],a[80:83]
TR v[48:49],v7,32768
buffer_load_dwordx4 a[20:23], v2, s[36:39], s73 offen offset:1024 sc1
MM v[248:251],v[60:63],a[88:91]
TR v[50:51],v7,34816
MM v[252:255],v[56:59],a[84:87]
TR v[52:53],v7,36864
v_cvt_pk_bf16_f32 v240, v240, v241
MM v[252:255],v[60:63],a[92:95]
TR v[54:55],v7,38912
s_waitcnt lgkmcnt(8)
v_cvt_pk_bf16_f32 v241, v242, v243
MM v[208:211],v[32:35],a[32:35]
TR v[56:57],v7,40960
buffer_load_dwordx4 a[24:27], v2, s[36:39], s73 offen offset:2048 sc1
v_cvt_pk_bf16_f32 v242, v244, v245
MM v[208:211],v[36:39],a[40:43]
TR v[58:59],v7,43008
v_cvt_pk_bf16_f32 v243, v246, v247
MM v[212:215],v[32:35],a[36:39]
TR v[60:61],v7,45056
buffer_store_dwordx4 v[240:243], v2, s[40:43], s74 offen offset:2048 sc0 sc1
MM v[212:215],v[36:39],a[44:47]
TR v[62:63],v7,47104
s_waitcnt lgkmcnt(8)
buffer_load_dwordx4 a[28:31], v2, s[36:39], s73 offen offset:3072 sc1
MM v[208:211],v[40:43],a[48:51]
TR v[32:33],v8,0
MM v[208:211],v[44:47],a[56:59]
TR v[34:35],v8,2048
MM v[212:215],v[40:43],a[52:55]
TR v[36:37],v8,4096
s_add_u32 s98, s75, 1
s_and_b32 s98, s98, 3
s_lshl_b32 s97, s98, 19
s_add_u32 s97, s97, s72
s_lshl_b32 s98, s98, 14
s_add_u32 m0, s78, 0
s_add_u32 s96, s97, 0
v_cvt_pk_bf16_f32 v248, v248, v249
MM v[212:215],v[44:47],a[60:63]
TR v[38:39],v8,6144
s_waitcnt lgkmcnt(8)
buffer_load_dwordx4 v28, s[32:35], s96 offen lds
v_cvt_pk_bf16_f32 v249, v250, v251
MM v[216:219],v[48:51],a[32:35]
TR v[40:41],v8,8192
v_cvt_pk_bf16_f32 v250, v252, v253
MM v[216:219],v[52:55],a[40:43]
TR v[42:43],v8,10240
s_add_u32 m0, s78, 1024
s_add_u32 s96, s97, 16384
v_cvt_pk_bf16_f32 v251, v254, v255
MM v[220:223],v[48:51],a[36:39]
TR v[44:45],v8,12288
buffer_load_dwordx4 v28, s[32:35], s96 offen lds
buffer_store_dwordx4 v[248:251], v2, s[40:43], s74 offen offset:3072 sc0 sc1
MM v[220:223],v[52:55],a[44:47]
TR v[46:47],v8,14336
s_waitcnt lgkmcnt(8)
MM v[216:219],v[56:59],a[48:51]
TR v[48:49],v9,0
MM v[216:219],v[60:63],a[56:59]
TR v[50:51],v9,2048
s_add_u32 m0, s78, 2048
s_add_u32 s96, s97, 32768
MM v[220:223],v[56:59],a[52:55]
TR v[52:53],v9,4096
buffer_load_dwordx4 v28, s[32:35], s96 offen lds
MM v[220:223],v[60:63],a[60:63]
TR v[54:55],v9,6144
s_waitcnt lgkmcnt(8)
MM v[192:195],v[32:35],a[64:67]
TR v[56:57],v9,8192
MM v[192:195],v[36:39],a[72:75]
TR v[58:59],v9,10240
s_add_u32 m0, s78, 3072
s_add_u32 s96, s97, 49152
MM v[196:199],v[32:35],a[68:71]
TR v[60:61],v9,12288
buffer_load_dwordx4 v28, s[32:35], s96 offen lds
MM v[196:199],v[36:39],a[76:79]
TR v[62:63],v9,14336
s_waitcnt lgkmcnt(8)
MM v[192:195],v[40:43],a[80:83]
TR v[32:33],v10,0
s_add_u32 m0, s78, 16384
s_add_u32 s96, s97, 262144
MM v[192:195],v[44:47],a[88:91]
TR v[34:35],v10,2048
buffer_load_dwordx4 v28, s[32:35], s96 offen lds
MM v[196:199],v[40:43],a[84:87]
TR v[36:37],v10,4096
MM v[196:199],v[44:47],a[92:95]
TR v[38:39],v10,6144
s_waitcnt lgkmcnt(8)
MM v[200:203],v[48:51],a[64:67]
TR v[40:41],v10,8192
s_add_u32 m0, s78, 17408
s_add_u32 s96, s97, 278528
MM v[200:203],v[52:55],a[72:75]
TR v[42:43],v10,10240
buffer_load_dwordx4 v28, s[32:35], s96 offen lds
MM v[204:207],v[48:51],a[68:71]
TR v[44:45],v10,12288
MM v[204:207],v[52:55],a[76:79]
TR v[46:47],v10,14336
s_waitcnt lgkmcnt(8)
s_add_u32 m0, s78, 18432
s_add_u32 s96, s97, 294912
MM v[200:203],v[56:59],a[80:83]
TR v[48:49],v11,0
buffer_load_dwordx4 v28, s[32:35], s96 offen lds
MM v[200:203],v[60:63],a[88:91]
TR v[50:51],v11,2048
MM v[204:207],v[56:59],a[84:87]
TR v[52:53],v11,4096
MM v[204:207],v[60:63],a[92:95]
TR v[54:55],v11,6144
s_waitcnt lgkmcnt(8)
s_add_u32 m0, s78, 19456
s_add_u32 s96, s97, 311296
MM v[208:211],v[32:35],a[64:67]
TR v[56:57],v11,8192
buffer_load_dwordx4 v28, s[32:35], s96 offen lds
MM v[208:211],v[36:39],a[72:75]
TR v[58:59],v11,10240
MM v[212:215],v[32:35],a[68:71]
TR v[60:61],v11,12288
MM v[212:215],v[36:39],a[76:79]
TR v[62:63],v11,14336
s_waitcnt lgkmcnt(8)
s_waitcnt vmcnt(28)
s_barrier
s_add_u32 s73, s98, 229376
MM v[208:211],v[40:43],a[80:83]
TR v[32:33],v8,32768
buffer_load_dwordx4 a[144:147], v2, s[36:39], s73 offen offset:0 sc1
MM v[208:211],v[44:47],a[88:91]
TR v[34:35],v8,34816
MM v[212:215],v[40:43],a[84:87]
TR v[36:37],v8,36864
MM v[212:215],v[44:47],a[92:95]
TR v[38:39],v8,38912
s_waitcnt lgkmcnt(8)
buffer_load_dwordx4 a[148:151], v2, s[36:39], s73 offen offset:1024 sc1
MM v[216:219],v[48:51],a[64:67]
TR v[40:41],v8,40960
MM v[216:219],v[52:55],a[72:75]
TR v[42:43],v8,43008
MM v[220:223],v[48:51],a[68:71]
TR v[44:45],v8,45056
MM v[220:223],v[52:55],a[76:79]
TR v[46:47],v8,47104
s_waitcnt lgkmcnt(8)
buffer_load_dwordx4 a[152:155], v2, s[36:39], s73 offen offset:2048 sc1
MM v[216:219],v[56:59],a[80:83]
TR v[48:49],v9,32768
MM v[216:219],v[60:63],a[88:91]
TR v[50:51],v9,34816
MM v[220:223],v[56:59],a[84:87]
TR v[52:53],v9,36864
buffer_load_dwordx4 a[156:159], v2, s[36:39], s73 offen offset:3072 sc1
MM v[220:223],v[60:63],a[92:95]
TR v[54:55],v9,38912
s_waitcnt lgkmcnt(8)
s_waitcnt vmcnt(24)
MM v[64:67],v[32:35],a[96:99]
TR v[56:57],v9,40960
MM v[64:67],v[36:39],a[104:107]
TR v[58:59],v9,43008
s_add_u32 s73, s98, 233472
MM v[68:71],v[32:35],a[100:103]
TR v[60:61],v9,45056
buffer_load_dwordx4 a[160:163], v2, s[36:39], s73 offen offset:0 sc1
MM v[68:71],v[36:39],a[108:111]
TR v[62:63],v9,47104
s_waitcnt lgkmcnt(8)
MM v[64:67],v[40:43],a[112:115]
TR v[32:33],v10,32768
MM v[64:67],v[44:47],a[120:123]
TR v[34:35],v10,34816
buffer_load_dwordx4 a[164:167], v2, s[36:39], s73 offen offset:1024 sc1
MM v[68:71],v[40:43],a[116:119]
TR v[36:37],v10,36864
MM v[68:71],v[44:47],a[124:127]
TR v[38:39],v10,38912
s_waitcnt lgkmcnt(8)
MM v[72:75],v[48:51],a[96:99]
TR v[40:41],v10,40960
buffer_load_dwordx4 a[168:171], v2, s[36:39], s73 offen offset:2048 sc1
MM v[72:75],v[52:55],a[104:107]
TR v[42:43],v10,43008
MM v[76:79],v[48:51],a[100:103]
TR v[44:45],v10,45056
MM v[76:79],v[52:55],a[108:111]
TR v[46:47],v10,47104
s_waitcnt lgkmcnt(8)
buffer_load_dwordx4 a[172:175], v2, s[36:39], s73 offen offset:3072 sc1
MM v[72:75],v[56:59],a[112:115]
TR v[48:49],v11,32768
MM v[72:75],v[60:63],a[120:123]
TR v[50:51],v11,34816
s_add_u32 s73, s98, 237568
MM v[76:79],v[56:59],a[116:119]
TR v[52:53],v11,36864
buffer_load_dwordx4 a[176:179], v2, s[36:39], s73 offen offset:0 sc1
MM v[76:79],v[60:63],a[124:127]
TR v[54:55],v11,38912
s_waitcnt lgkmcnt(8)
MM v[80:83],v[32:35],a[96:99]
TR v[56:57],v11,40960
MM v[80:83],v[36:39],a[104:107]
TR v[58:59],v11,43008
buffer_load_dwordx4 a[180:183], v2, s[36:39], s73 offen offset:1024 sc1
MM v[84:87],v[32:35],a[100:103]
TR v[60:61],v11,45056
MM v[84:87],v[36:39],a[108:111]
TR v[62:63],v11,47104
s_waitcnt lgkmcnt(8)
s_waitcnt vmcnt(16)
s_barrier
s_cmp_lg_u32 s24, 0
s_cbranch_scc1 Lf39
v_mov_b32 v25, 1
s_mov_b64 exec, 1
global_store_dword v27, v25, s[22:23] sc0 sc1
s_mov_b64 exec, -1
Lf39:
MM v[80:83],v[40:43],a[112:115]
TR v[32:33],v8,49152
buffer_load_dwordx4 a[184:187], v2, s[36:39], s73 offen offset:2048 sc1
MM v[80:83],v[44:47],a[120:123]
TR v[34:35],v8,51200
MM v[84:87],v[40:43],a[116:119]
TR v[36:37],v8,53248
MM v[84:87],v[44:47],a[124:127]
TR v[38:39],v8,55296
s_waitcnt lgkmcnt(8)
buffer_load_dwordx4 a[188:191], v2, s[36:39], s73 offen offset:3072 sc1
MM v[88:91],v[48:51],a[96:99]
TR v[40:41],v8,57344
MM v[88:91],v[52:55],a[104:107]
TR v[42:43],v8,59392
s_add_u32 s73, s98, 241664
MM v[92:95],v[48:51],a[100:103]
TR v[44:45],v8,61440
buffer_load_dwordx4 a[192:195], v2, s[36:39], s73 offen offset:0 sc1
MM v[92:95],v[52:55],a[108:111]
TR v[46:47],v8,63488
s_waitcnt lgkmcnt(8)
MM v[88:91],v[56:59],a[112:115]
TR v[48:49],v9,49152
MM v[88:91],v[60:63],a[120:123]
TR v[50:51],v9,51200
buffer_load_dwordx4 a[196:199], v2, s[36:39], s73 offen offset:1024 sc1
MM v[92:95],v[56:59],a[116:119]
TR v[52:53],v9,53248
MM v[92:95],v[60:63],a[124:127]
TR v[54:55],v9,55296
s_waitcnt lgkmcnt(8)
s_waitcnt vmcnt(23)
MM v[64:67],v[32:35],a[0:3]
TR v[56:57],v9,57344
buffer_load_dwordx4 a[200:203], v2, s[36:39], s73 offen offset:2048 sc1
MM v[64:67],v[36:39],a[8:11]
TR v[58:59],v9,59392
MM v[68:71],v[32:35],a[4:7]
TR v[60:61],v9,61440
MM v[68:71],v[36:39],a[12:15]
TR v[62:63],v9,63488
s_waitcnt lgkmcnt(8)
buffer_load_dwordx4 a[204:207], v2, s[36:39], s73 offen offset:3072 sc1
MM v[64:67],v[40:43],a[16:19]
TR v[32:33],v10,49152
MM v[64:67],v[44:47],a[24:27]
TR v[34:35],v10,51200
s_add_u32 s98, s75, 2
s_and_b32 s98, s98, 3
s_lshl_b32 s97, s98, 19
s_add_u32 s97, s97, s72
s_lshl_b32 s98, s98, 14
s_add_u32 m0, s78, 131072
s_add_u32 s96, s97, 0
MM v[68:71],v[40:43],a[20:23]
TR v[36:37],v10,53248
buffer_load_dwordx4 v28, s[32:35], s96 offen lds
MM v[68:71],v[44:47],a[28:31]
TR v[38:39],v10,55296
s_waitcnt lgkmcnt(8)
MM v[72:75],v[48:51],a[0:3]
TR v[40:41],v10,57344
s_add_u32 m0, s78, 132096
s_add_u32 s96, s97, 16384
MM v[72:75],v[52:55],a[8:11]
TR v[42:43],v10,59392
buffer_load_dwordx4 v28, s[32:35], s96 offen lds
MM v[76:79],v[48:51],a[4:7]
TR v[44:45],v10,61440
MM v[76:79],v[52:55],a[12:15]
TR v[46:47],v10,63488
s_waitcnt lgkmcnt(8)
s_add_u32 m0, s78, 133120
s_add_u32 s96, s97, 32768
MM v[72:75],v[56:59],a[16:19]
TR v[48:49],v11,49152
buffer_load_dwordx4 v28, s[32:35], s96 offen lds
MM v[72:75],v[60:63],a[24:27]
TR v[50:51],v11,51200
MM v[76:79],v[56:59],a[20:23]
TR v[52:53],v11,53248
s_add_u32 m0, s78, 134144
s_add_u32 s96, s97, 49152
MM v[76:79],v[60:63],a[28:31]
TR v[54:55],v11,55296
s_waitcnt lgkmcnt(8)
buffer_load_dwordx4 v28, s[32:35], s96 offen lds
MM v[80:83],v[32:35],a[0:3]
TR v[56:57],v11,57344
MM v[80:83],v[36:39],a[8:11]
TR v[58:59],v11,59392
s_add_u32 m0, s78, 147456
s_add_u32 s96, s97, 262144
MM v[84:87],v[32:35],a[4:7]
TR v[60:61],v11,61440
buffer_load_dwordx4 v28, s[32:35], s96 offen lds
MM v[84:87],v[36:39],a[12:15]
TR v[62:63],v11,63488
s_waitcnt lgkmcnt(8)
s_waitcnt vmcnt(21)
s_barrier
MM v[80:83],v[40:43],a[16:19]
TR v[32:33],v4,0
s_add_u32 m0, s78, 148480
s_add_u32 s96, s97, 278528
MM v[80:83],v[44:47],a[24:27]
TR v[34:35],v4,2048
buffer_load_dwordx4 v28, s[32:35], s96 offen lds
MM v[84:87],v[40:43],a[20:23]
TR v[36:37],v4,4096
MM v[84:87],v[44:47],a[28:31]
TR v[38:39],v4,6144
s_waitcnt lgkmcnt(8)
s_add_u32 m0, s78, 149504
s_add_u32 s96, s97, 294912
MM v[88:91],v[48:51],a[0:3]
TR v[40:41],v4,8192
buffer_load_dwordx4 v28, s[32:35], s96 offen lds
MM v[88:91],v[52:55],a[8:11]
TR v[42:43],v4,10240
MM v[92:95],v[48:51],a[4:7]
TR v[44:45],v4,12288
s_add_u32 m0, s78, 150528
s_add_u32 s96, s97, 311296
MM v[92:95],v[52:55],a[12:15]
TR v[46:47],v4,14336
s_waitcnt lgkmcnt(8)
buffer_load_dwordx4 v28, s[32:35], s96 offen lds
MM v[88:91],v[56:59],a[16:19]
TR v[48:49],v5,0
MM v[88:91],v[60:63],a[24:27]
TR v[50:51],v5,2048
s_add_u32 s73, s98, 229376
MM v[92:95],v[56:59],a[20:23]
TR v[52:53],v5,4096
buffer_load_dwordx4 a[208:211], v2, s[36:39], s73 offen offset:0 sc1
MM v[92:95],v[60:63],a[28:31]
TR v[54:55],v5,6144
s_waitcnt lgkmcnt(8)
s_waitcnt vmcnt(17)
MM v[64:67],v[32:35],a[144:147]
TR v[56:57],v5,8192
global_load_dword v25, v26, s[22:23] sc1
MM v[64:67],v[36:39],a[152:155]
TR v[58:59],v5,10240
buffer_load_dwordx4 a[212:215], v2, s[36:39], s73 offen offset:1024 sc1
MM v[68:71],v[32:35],a[148:151]
TR v[60:61],v5,12288
v_accvgpr_read_b32 v12, a128
MM v[68:71],v[36:39],a[156:159]
TR v[62:63],v5,14336
s_waitcnt lgkmcnt(8)
v_accvgpr_read_b32 v13, a129
MM v[64:67],v[40:43],a[160:163]
TR v[32:33],v6,0
buffer_load_dwordx4 a[216:219], v2, s[36:39], s73 offen offset:2048 sc1
v_accvgpr_read_b32 v14, a130
MM v[64:67],v[44:47],a[168:171]
TR v[34:35],v6,2048
v_accvgpr_read_b32 v15, a131
MM v[68:71],v[40:43],a[164:167]
TR v[36:37],v6,4096
v_permlane16_swap_b32 v12, v14
MM v[68:71],v[44:47],a[172:175]
TR v[38:39],v6,6144
s_waitcnt lgkmcnt(8)
buffer_load_dwordx4 a[220:223], v2, s[36:39], s73 offen offset:3072 sc1
v_permlane16_swap_b32 v13, v15
MM v[72:75],v[48:51],a[144:147]
TR v[40:41],v6,8192
v_lshlrev_b32 v96, 16, v12
MM v[72:75],v[52:55],a[152:155]
TR v[42:43],v6,10240
s_add_u32 s73, s98, 233472
v_and_b32 v97, s3, v12
MM v[76:79],v[48:51],a[148:151]
TR v[44:45],v6,12288
buffer_load_dwordx4 a[224:227], v2, s[36:39], s73 offen offset:0 sc1
v_lshlrev_b32 v98, 16, v13
MM v[76:79],v[52:55],a[156:159]
TR v[46:47],v6,14336
s_waitcnt lgkmcnt(8)
v_and_b32 v99, s3, v13
MM v[72:75],v[56:59],a[160:163]
TR v[48:49],v7,0
v_lshlrev_b32 v104, 16, v14
MM v[72:75],v[60:63],a[168:171]
TR v[50:51],v7,2048
buffer_load_dwordx4 a[228:231], v2, s[36:39], s73 offen offset:1024 sc1
v_and_b32 v105, s3, v14
MM v[76:79],v[56:59],a[164:167]
TR v[52:53],v7,4096
v_lshlrev_b32 v106, 16, v15
MM v[76:79],v[60:63],a[172:175]
TR v[54:55],v7,6144
s_waitcnt lgkmcnt(8)
v_and_b32 v107, s3, v15
MM v[80:83],v[32:35],a[144:147]
TR v[56:57],v7,8192
buffer_load_dwordx4 a[232:235], v2, s[36:39], s73 offen offset:2048 sc1
v_accvgpr_read_b32 v12, a132
MM v[80:83],v[36:39],a[152:155]
TR v[58:59],v7,10240
v_accvgpr_read_b32 v13, a133
MM v[84:87],v[32:35],a[148:151]
TR v[60:61],v7,12288
v_accvgpr_read_b32 v14, a134
MM v[84:87],v[36:39],a[156:159]
TR v[62:63],v7,14336
s_waitcnt lgkmcnt(8)
buffer_load_dwordx4 a[236:239], v2, s[36:39], s73 offen offset:3072 sc1
v_accvgpr_read_b32 v15, a135
MM v[80:83],v[40:43],a[160:163]
TR v[32:33],v4,16384
v_permlane16_swap_b32 v12, v14
MM v[80:83],v[44:47],a[168:171]
TR v[34:35],v4,18432
s_add_u32 s73, s98, 237568
v_permlane16_swap_b32 v13, v15
MM v[84:87],v[40:43],a[164:167]
TR v[36:37],v4,20480
buffer_load_dwordx4 a[32:35], v2, s[36:39], s73 offen offset:0 sc1
v_lshlrev_b32 v100, 16, v12
MM v[84:87],v[44:47],a[172:175]
TR v[38:39],v4,22528
s_waitcnt lgkmcnt(8)
v_and_b32 v101, s3, v12
MM v[88:91],v[48:51],a[144:147]
TR v[40:41],v4,24576
v_lshlrev_b32 v102, 16, v13
MM v[88:91],v[52:55],a[152:155]
TR v[42:43],v4,26624
buffer_load_dwordx4 a[36:39], v2, s[36:39], s73 offen offset:1024 sc1
v_and_b32 v103, s3, v13
MM v[92:95],v[48:51],a[148:151]
TR v[44:45],v4,28672
v_lshlrev_b32 v108, 16, v14
MM v[92:95],v[52:55],a[156:159]
TR v[46:47],v4,30720
s_waitcnt lgkmcnt(8)
v_and_b32 v109, s3, v14
MM v[88:91],v[56:59],a[160:163]
TR v[48:49],v5,16384
buffer_load_dwordx4 a[40:43], v2, s[36:39], s73 offen offset:2048 sc1
v_lshlrev_b32 v110, 16, v15
MM v[88:91],v[60:63],a[168:171]
TR v[50:51],v5,18432
v_and_b32 v111, s3, v15
MM v[92:95],v[56:59],a[164:167]
TR v[52:53],v5,20480
MM v[92:95],v[60:63],a[172:175]
TR v[54:55],v5,22528
s_waitcnt lgkmcnt(8)
s_waitcnt vmcnt(20)
buffer_load_dwordx4 a[44:47], v2, s[36:39], s73 offen offset:3072 sc1
MM v[64:67],v[32:35],a[176:179]
TR v[56:57],v5,24576
s_waitcnt vmcnt(11)
v_readfirstlane_b32 s30, v25
s_nop 0
s_cmp_ge_u32 s30, 1
s_cbranch_scc1 Ld41
s_mov_b32 s31, 262144
Lp40:
global_load_dword v25, v26, s[22:23] offset:0 sc1
s_waitcnt vmcnt(0)
v_readfirstlane_b32 s30, v25
s_nop 0
s_cmp_ge_u32 s30, 1
s_cbranch_scc1 Ld41
s_sleep 1
s_sub_u32 s31, s31, 1
s_cmp_lg_u32 s31, 0
s_cbranch_scc1 Lp40
Ld41:
MM v[64:67],v[36:39],a[184:187]
TR v[58:59],v5,26624
s_add_u32 s73, s98, 241664
MM v[68:71],v[32:35],a[180:183]
TR v[60:61],v5,28672
buffer_load_dwordx4 a[48:51], v2, s[36:39], s73 offen offset:0 sc1
MM v[68:71],v[36:39],a[188:191]
TR v[62:63],v5,30720
s_waitcnt lgkmcnt(8)
MM v[64:67],v[40:43],a[192:195]
TR v[32:33],v6,16384
buffer_load_dwordx4 v[128:131], v2, s[40:43], s77 offen offset:0 sc1
MM v[64:67],v[44:47],a[200:203]
TR v[34:35],v6,18432
buffer_load_dwordx4 a[52:55], v2, s[36:39], s73 offen offset:1024 sc1
buffer_load_dwordx4 v[132:135], v2, s[40:43], s77 offen offset:1024 sc1
MM v[68:71],v[40:43],a[196:199]
TR v[36:37],v6,20480
buffer_load_dwordx4 v[136:139], v2, s[40:43], s77 offen offset:2048 sc1
MM v[68:71],v[44:47],a[204:207]
TR v[38:39],v6,22528
s_waitcnt lgkmcnt(8)
buffer_load_dwordx4 v[140:143], v2, s[40:43], s77 offen offset:3072 sc1
MM v[72:75],v[48:51],a[176:179]
TR v[40:41],v6,24576
buffer_load_dwordx4 a[56:59], v2, s[36:39], s73 offen offset:2048 sc1
MM v[72:75],v[52:55],a[184:187]
TR v[42:43],v6,26624
v_accvgpr_read_b32 v12, a136
v_accvgpr_read_b32 v13, a137
MM v[76:79],v[48:51],a[180:183]
TR v[44:45],v6,28672
v_accvgpr_read_b32 v14, a138
MM v[76:79],v[52:55],a[188:191]
TR v[46:47],v6,30720
s_waitcnt lgkmcnt(8)
buffer_load_dwordx4 a[60:63], v2, s[36:39], s73 offen offset:3072 sc1
v_accvgpr_read_b32 v15, a139
MM v[72:75],v[56:59],a[192:195]
TR v[48:49],v7,16384
v_permlane16_swap_b32 v12, v14
MM v[72:75],v[60:63],a[200:203]
TR v[50:51],v7,18432
s_add_u32 s98, s75, 3
s_and_b32 s98, s98, 3
s_lshl_b32 s97, s98, 19
s_add_u32 s97, s97, s72
s_lshl_b32 s98, s98, 14
s_add_u32 m0, s78, 32768
s_add_u32 s96, s97, 0
v_permlane16_swap_b32 v13, v15
MM v[76:79],v[56:59],a[196:199]
TR v[52:53],v7,20480
buffer_load_dwordx4 v28, s[32:35], s96 offen lds
v_lshlrev_b32 v112, 16, v12
MM v[76:79],v[60:63],a[204:207]
TR v[54:55],v7,22528
s_waitcnt lgkmcnt(8)
v_and_b32 v113, s3, v12
MM v[80:83],v[32:35],a[176:179]
TR v[56:57],v7,24576
s_add_u32 m0, s78, 33792
s_add_u32 s96, s97, 16384
v_lshlrev_b32 v114, 16, v13
MM v[80:83],v[36:39],a[184:187]
TR v[58:59],v7,26624
buffer_load_dwordx4 v28, s[32:35], s96 offen lds
v_and_b32 v115, s3, v13
MM v[84:87],v[32:35],a[180:183]
TR v[60:61],v7,28672
v_lshlrev_b32 v120, 16, v14
MM v[84:87],v[36:39],a[188:191]
TR v[62:63],v7,30720
s_waitcnt lgkmcnt(8)
s_waitcnt vmcnt(23)
s_barrier
s_add_u32 m0, s78, 34816
s_add_u32 s96, s97, 32768
v_and_b32 v121, s3, v14
MM v[80:83],v[40:43],a[192:195]
TR v[32:33],v160,0
buffer_load_dwordx4 v28, s[32:35], s96 offen lds
v_lshlrev_b32 v122, 16, v15
MM v[80:83],v[44:47],a[200:203]
TR v[34:35],v160,2048
v_and_b32 v123, s3, v15
MM v[84:87],v[40:43],a[196:199]
TR v[36:37],v160,4096
s_add_u32 m0, s78, 35840
s_add_u32 s96, s97, 49152
v_accvgpr_read_b32 v12, a140
v_accvgpr_read_b32 v13, a141
MM v[84:87],v[44:47],a[204:207]
TR v[38:39],v160,6144
s_waitcnt lgkmcnt(8)
buffer_load_dwordx4 v28, s[32:35], s96 offen lds
v_accvgpr_read_b32 v14, a142
MM v[88:91],v[48:51],a[176:179]
TR v[40:41],v160,8192
v_accvgpr_read_b32 v15, a143
MM v[88:91],v[52:55],a[184:187]
TR v[42:43],v160,10240
s_add_u32 m0, s78, 49152
s_add_u32 s96, s97, 262144
v_permlane16_swap_b32 v12, v14
MM v[92:95],v[48:51],a[180:183]
TR v[44:45],v160,12288
buffer_load_dwordx4 v28, s[32:35], s96 offen lds
v_permlane16_swap_b32 v13, v15
MM v[92:95],v[52:55],a[188:191]
TR v[46:47],v160,14336
s_waitcnt lgkmcnt(8)
v_lshlrev_b32 v116, 16, v12
MM v[88:91],v[56:59],a[192:195]
TR v[48:49],v161,0
s_add_u32 m0, s78, 50176
s_add_u32 s96, s97, 278528
v_and_b32 v117, s3, v12
MM v[88:91],v[60:63],a[200:203]
TR v[50:51],v161,2048
buffer_load_dwordx4 v28, s[32:35], s96 offen lds
v_lshlrev_b32 v118, 16, v13
MM v[92:95],v[56:59],a[196:199]
TR v[52:53],v161,4096
v_and_b32 v119, s3, v13
MM v[92:95],v[60:63],a[204:207]
TR v[54:55],v161,6144
s_waitcnt lgkmcnt(8)
s_waitcnt vmcnt(18)
s_add_u32 m0, s78, 51200
s_add_u32 s96, s97, 294912
v_lshlrev_b32 v124, 16, v14
MM v[64:67],v[32:35],a[208:211]
TR v[56:57],v161,8192
buffer_load_dwordx4 v28, s[32:35], s96 offen lds
v_and_b32 v125, s3, v14
MM v[64:67],v[36:39],a[216:219]
TR v[58:59],v161,10240
v_lshlrev_b32 v126, 16, v15
MM v[68:71],v[32:35],a[212:215]
TR v[60:61],v161,12288
s_add_u32 m0, s78, 52224
s_add_u32 s96, s97, 311296
v_and_b32 v127, s3, v15
MM v[68:71],v[36:39],a[220:223]
TR v[62:63],v161,14336
s_waitcnt lgkmcnt(8)
buffer_load_dwordx4 v28, s[32:35], s96 offen lds
MM v[64:67],v[40:43],a[224:227]
TR v[32:33],v162,0
s_waitcnt vmcnt(14)
v_lshlrev_b32 v20, 16, v128
v_and_b32 v21, s3, v128
MM v[64:67],v[44:47],a[232:235]
TR v[34:35],v162,2048
s_add_u32 s73, s98, 229376
v_lshlrev_b32 v22, 16, v129
v_and_b32 v23, s3, v129
MM v[68:71],v[40:43],a[228:231]
TR v[36:37],v162,4096
buffer_load_dwordx4 a[64:67], v2, s[36:39], s73 offen offset:0 sc1
v_add_f32 v192, v192, v20
v_add_f32 v193, v193, v21
MM v[68:71],v[44:47],a[236:239]
TR v[38:39],v162,6144
s_waitcnt lgkmcnt(8)
v_add_f32 v194, v194, v22
v_add_f32 v195, v195, v23
v_mul_f32 v20, s87, v192
MM v[72:75],v[48:51],a[208:211]
TR v[40:41],v162,8192
v_mul_f32 v21, s87, v193
v_mul_f32 v22, s87, v194
MM v[72:75],v[52:55],a[216:219]
TR v[42:43],v162,10240
buffer_load_dwordx4 a[68:71], v2, s[36:39], s73 offen offset:1024 sc1
v_mul_f32 v23, s87, v195
v_exp_f32 v20, v20
MM v[76:79],v[48:51],a[212:215]
TR v[44:45],v162,12288
v_exp_f32 v21, v21
v_exp_f32 v22, v22
v_exp_f32 v23, v23
MM v[76:79],v[52:55],a[220:223]
TR v[46:47],v162,14336
s_waitcnt lgkmcnt(8)
v_add_f32 v20, 1.0, v20
v_add_f32 v21, 1.0, v21
MM v[72:75],v[56:59],a[224:227]
TR v[48:49],v163,0
buffer_load_dwordx4 a[72:75], v2, s[36:39], s73 offen offset:2048 sc1
v_add_f32 v22, 1.0, v22
v_add_f32 v23, 1.0, v23
MM v[72:75],v[60:63],a[232:235]
TR v[50:51],v163,2048
v_rcp_f32 v20, v20
v_rcp_f32 v21, v21
MM v[76:79],v[56:59],a[228:231]
TR v[52:53],v163,4096
v_rcp_f32 v22, v22
MM v[76:79],v[60:63],a[236:239]
TR v[54:55],v163,6144
s_waitcnt lgkmcnt(8)
buffer_load_dwordx4 a[76:79], v2, s[36:39], s73 offen offset:3072 sc1
v_rcp_f32 v23, v23
MM v[80:83],v[32:35],a[208:211]
TR v[56:57],v163,8192
v_mul_f32 v192, v192, v20
v_mul_f32 v193, v193, v21
MM v[80:83],v[36:39],a[216:219]
TR v[58:59],v163,10240
s_add_u32 s73, s98, 233472
v_mul_f32 v194, v194, v22
v_mul_f32 v195, v195, v23
MM v[84:87],v[32:35],a[212:215]
TR v[60:61],v163,12288
buffer_load_dwordx4 a[80:83], v2, s[36:39], s73 offen offset:0 sc1
v_lshlrev_b32 v20, 16, v130
v_and_b32 v21, s3, v130
MM v[84:87],v[36:39],a[220:223]
TR v[62:63],v163,14336
s_waitcnt lgkmcnt(8)
v_lshlrev_b32 v22, 16, v131
v_and_b32 v23, s3, v131
v_add_f32 v196, v196, v20
MM v[80:83],v[40:43],a[224:227]
TR v[32:33],v160,16384
v_add_f32 v197, v197, v21
v_add_f32 v198, v198, v22
MM v[80:83],v[44:47],a[232:235]
TR v[34:35],v160,18432
buffer_load_dwordx4 a[84:87], v2, s[36:39], s73 offen offset:1024 sc1
v_add_f32 v199, v199, v23
v_mul_f32 v20, s87, v196
MM v[84:87],v[40:43],a[228:231]
TR v[36:37],v160,20480
v_mul_f32 v21, s87, v197
v_mul_f32 v22, s87, v198
v_mul_f32 v23, s87, v199
MM v[84:87],v[44:47],a[236:239]
TR v[38:39],v160,22528
s_waitcnt lgkmcnt(8)
v_exp_f32 v20, v20
v_exp_f32 v21, v21
MM v[88:91],v[48:51],a[208:211]
TR v[40:41],v160,24576
buffer_load_dwordx4 a[88:91], v2, s[36:39], s73 offen offset:2048 sc1
v_exp_f32 v22, v22
v_exp_f32 v23, v23
MM v[88:91],v[52:55],a[216:219]
TR v[42:43],v160,26624
v_add_f32 v20, 1.0, v20
v_add_f32 v21, 1.0, v21
v_add_f32 v22, 1.0, v22
MM v[92:95],v[48:51],a[212:215]
TR v[44:45],v160,28672
v_add_f32 v23, 1.0, v23
v_rcp_f32 v20, v20
MM v[92:95],v[52:55],a[220:223]
TR v[46:47],v160,30720
s_waitcnt lgkmcnt(8)
buffer_load_dwordx4 a[92:95], v2, s[36:39], s73 offen offset:3072 sc1
v_rcp_f32 v21, v21
MM v[88:91],v[56:59],a[224:227]
TR v[48:49],v161,16384
v_rcp_f32 v22, v22
MM v[88:91],v[60:63],a[232:235]
TR v[50:51],v161,18432
s_add_u32 s73, s98, 237568
v_rcp_f32 v23, v23
MM v[92:95],v[56:59],a[228:231]
TR v[52:53],v161,20480
buffer_load_dwordx4 a[96:99], v2, s[36:39], s73 offen offset:0 sc1
v_mul_f32 v196, v196, v20
v_mul_f32 v197, v197, v21
MM v[92:95],v[60:63],a[236:239]
TR v[54:55],v161,22528
s_waitcnt lgkmcnt(8)
s_waitcnt vmcnt(17)
v_mul_f32 v198, v198, v22
v_mul_f32 v199, v199, v23
MM v[64:67],v[32:35],a[32:35]
TR v[56:57],v161,24576
s_waitcnt vmcnt(21)
v_lshlrev_b32 v20, 16, v132
v_and_b32 v21, s3, v132
MM v[64:67],v[36:39],a[40:43]
TR v[58:59],v161,26624
buffer_load_dwordx4 a[100:103], v2, s[36:39], s73 offen offset:1024 sc1
v_lshlrev_b32 v22, 16, v133
v_and_b32 v23, s3, v133
MM v[68:71],v[32:35],a[36:39]
TR v[60:61],v161,28672
v_add_f32 v200, v200, v20
v_add_f32 v201, v201, v21
MM v[68:71],v[36:39],a[44:47]
TR v[62:63],v161,30720
s_waitcnt lgkmcnt(8)
v_add_f32 v202, v202, v22
v_add_f32 v203, v203, v23
v_mul_f32 v20, s87, v200
MM v[64:67],v[40:43],a[48:51]
TR v[32:33],v162,16384
buffer_load_dwordx4 a[104:107], v2, s[36:39], s73 offen offset:2048 sc1
v_mul_f32 v21, s87, v201
v_mul_f32 v22, s87, v202
MM v[64:67],v[44:47],a[56:59]
TR v[34:35],v162,18432
v_mul_f32 v23, s87, v203
v_exp_f32 v20, v20
MM v[68:71],v[40:43],a[52:55]
TR v[36:37],v162,20480
v_exp_f32 v21, v21
v_exp_f32 v22, v22
v_exp_f32 v23, v23
MM v[68:71],v[44:47],a[60:63]
TR v[38:39],v162,22528
s_waitcnt lgkmcnt(8)
buffer_load_dwordx4 a[108:111], v2, s[36:39], s73 offen offset:3072 sc1
v_add_f32 v20, 1.0, v20
v_add_f32 v21, 1.0, v21
MM v[72:75],v[48:51],a[32:35]
TR v[40:41],v162,24576
v_add_f32 v22, 1.0, v22
v_add_f32 v23, 1.0, v23
MM v[72:75],v[52:55],a[40:43]
TR v[42:43],v162,26624
s_add_u32 s73, s98, 241664
v_rcp_f32 v20, v20
v_rcp_f32 v21, v21
MM v[76:79],v[48:51],a[36:39]
TR v[44:45],v162,28672
buffer_load_dwordx4 a[112:115], v2, s[36:39], s73 offen offset:0 sc1
v_rcp_f32 v22, v22
MM v[76:79],v[52:55],a[44:47]
TR v[46:47],v162,30720
s_waitcnt lgkmcnt(8)
v_rcp_f32 v23, v23
MM v[72:75],v[56:59],a[48:51]
TR v[48:49],v163,16384
v_mul_f32 v200, v200, v20
v_mul_f32 v201, v201, v21
MM v[72:75],v[60:63],a[56:59]
TR v[50:51],v163,18432
buffer_load_dwordx4 a[116:119], v2, s[36:39], s73 offen offset:1024 sc1
v_mul_f32 v202, v202, v22
v_mul_f32 v203, v203, v23
MM v[76:79],v[56:59],a[52:55]
TR v[52:53],v163,20480
v_lshlrev_b32 v20, 16, v134
v_and_b32 v21, s3, v134
MM v[76:79],v[60:63],a[60:63]
TR v[54:55],v163,22528
s_waitcnt lgkmcnt(8)
v_lshlrev_b32 v22, 16, v135
v_and_b32 v23, s3, v135
v_add_f32 v204, v204, v20
MM v[80:83],v[32:35],a[32:35]
TR v[56:57],v163,24576
buffer_load_dwordx4 a[120:123], v2, s[36:39], s73 offen offset:2048 sc1
v_add_f32 v205, v205, v21
v_add_f32 v206, v206, v22
MM v[80:83],v[36:39],a[40:43]
TR v[58:59],v163,26624
v_add_f32 v207, v207, v23
v_mul_f32 v20, s87, v204
MM v[84:87],v[32:35],a[36:39]
TR v[60:61],v163,28672
v_mul_f32 v21, s87, v205
v_mul_f32 v22, s87, v206
v_mul_f32 v23, s87, v207
MM v[84:87],v[36:39],a[44:47]
TR v[62:63],v163,30720
s_waitcnt lgkmcnt(8)
s_waitcnt vmcnt(15)
s_barrier
buffer_load_dwordx4 a[124:127], v2, s[36:39], s73 offen offset:3072 sc1
v_exp_f32 v20, v20
v_exp_f32 v21, v21
MM v[80:83],v[40:43],a[48:51]
TR v[32:33],v4,32768
v_exp_f32 v22, v22
v_exp_f32 v23, v23
MM v[80:83],v[44:47],a[56:59]
TR v[34:35],v4,34816
v_add_f32 v20, 1.0, v20
v_add_f32 v21, 1.0, v21
v_add_f32 v22, 1.0, v22
MM v[84:87],v[40:43],a[52:55]
TR v[36:37],v4,36864
v_add_f32 v23, 1.0, v23
v_rcp_f32 v20, v20
MM v[84:87],v[44:47],a[60:63]
TR v[38:39],v4,38912
s_waitcnt lgkmcnt(8)
v_rcp_f32 v21, v21
MM v[88:91],v[48:51],a[32:35]
TR v[40:41],v4,40960
v_rcp_f32 v22, v22
MM v[88:91],v[52:55],a[40:43]
TR v[42:43],v4,43008
v_rcp_f32 v23, v23
MM v[92:95],v[48:51],a[36:39]
TR v[44:45],v4,45056
v_mul_f32 v204, v204, v20
v_mul_f32 v205, v205, v21
MM v[92:95],v[52:55],a[44:47]
TR v[46:47],v4,47104
s_waitcnt lgkmcnt(8)
v_mul_f32 v206, v206, v22
v_mul_f32 v207, v207, v23
MM v[88:91],v[56:59],a[48:51]
TR v[48:49],v5,32768
s_waitcnt vmcnt(27)
v_lshlrev_b32 v20, 16, v136
v_and_b32 v21, s3, v136
MM v[88:91],v[60:63],a[56:59]
TR v[50:51],v5,34816
v_lshlrev_b32 v22, 16, v137
v_and_b32 v23, s3, v137
MM v[92:95],v[56:59],a[52:55]
TR v[52:53],v5,36864
v_add_f32 v208, v208, v20
v_add_f32 v209, v209, v21
MM v[92:95],v[60:63],a[60:63]
TR v[54:55],v5,38912
s_waitcnt lgkmcnt(8)
s_waitcnt vmcnt(8)
v_add_f32 v210, v210, v22
v_add_f32 v211, v211, v23
v_mul_f32 v20, s87, v208
MM v[64:67],v[32:35],a[64:67]
TR v[56:57],v5,40960
v_mul_f32 v21, s87, v209
v_mul_f32 v22, s87, v210
MM v[64:67],v[36:39],a[72:75]
TR v[58:59],v5,43008
v_mul_f32 v23, s87, v211
v_exp_f32 v20, v20
MM v[68:71],v[32:35],a[68:71]
TR v[60:61],v5,45056
v_exp_f32 v21, v21
v_exp_f32 v22, v22
v_exp_f32 v23, v23
MM v[68:71],v[36:39],a[76:79]
TR v[62:63],v5,47104
s_waitcnt lgkmcnt(8)
v_add_f32 v20, 1.0, v20
v_add_f32 v21, 1.0, v21
MM v[64:67],v[40:43],a[80:83]
TR v[32:33],v6,32768
v_add_f32 v22, 1.0, v22
v_add_f32 v23, 1.0, v23
MM v[64:67],v[44:47],a[88:91]
TR v[34:35],v6,34816
v_rcp_f32 v20, v20
v_rcp_f32 v21, v21
MM v[68:71],v[40:43],a[84:87]
TR v[36:37],v6,36864
v_rcp_f32 v22, v22
MM v[68:71],v[44:47],a[92:95]
TR v[38:39],v6,38912
s_waitcnt lgkmcnt(8)
v_rcp_f32 v23, v23
MM v[72:75],v[48:51],a[64:67]
TR v[40:41],v6,40960
v_mul_f32 v208, v208, v20
v_mul_f32 v209, v209, v21
MM v[72:75],v[52:55],a[72:75]
TR v[42:43],v6,43008
v_mul_f32 v210, v210, v22
v_mul_f32 v211, v211, v23
MM v[76:79],v[48:51],a[68:71]
TR v[44:45],v6,45056
v_lshlrev_b32 v20, 16, v138
v_and_b32 v21, s3, v138
MM v[76:79],v[52:55],a[76:79]
TR v[46:47],v6,47104
s_waitcnt lgkmcnt(8)
v_lshlrev_b32 v22, 16, v139
v_and_b32 v23, s3, v139
v_add_f32 v212, v212, v20
MM v[72:75],v[56:59],a[80:83]
TR v[48:49],v7,32768
v_add_f32 v213, v213, v21
v_add_f32 v214, v214, v22
MM v[72:75],v[60:63],a[88:91]
TR v[50:51],v7,34816
v_add_f32 v215, v215, v23
v_mul_f32 v20, s87, v212
MM v[76:79],v[56:59],a[84:87]
TR v[52:53],v7,36864
v_mul_f32 v21, s87, v213
v_mul_f32 v22, s87, v214
v_mul_f32 v23, s87, v215
MM v[76:79],v[60:63],a[92:95]
TR v[54:55],v7,38912
s_waitcnt lgkmcnt(8)
v_exp_f32 v20, v20
v_exp_f32 v21, v21
MM v[80:83],v[32:35],a[64:67]
TR v[56:57],v7,40960
v_exp_f32 v22, v22
v_exp_f32 v23, v23
MM v[80:83],v[36:39],a[72:75]
TR v[58:59],v7,43008
v_add_f32 v20, 1.0, v20
v_add_f32 v21, 1.0, v21
v_add_f32 v22, 1.0, v22
MM v[84:87],v[32:35],a[68:71]
TR v[60:61],v7,45056
v_add_f32 v23, 1.0, v23
v_rcp_f32 v20, v20
MM v[84:87],v[36:39],a[76:79]
TR v[62:63],v7,47104
s_waitcnt lgkmcnt(8)
v_rcp_f32 v21, v21
MM v[80:83],v[40:43],a[80:83]
TR v[32:33],v4,49152
v_rcp_f32 v22, v22
MM v[80:83],v[44:47],a[88:91]
TR v[34:35],v4,51200
v_rcp_f32 v23, v23
MM v[84:87],v[40:43],a[84:87]
TR v[36:37],v4,53248
v_mul_f32 v212, v212, v20
v_mul_f32 v213, v213, v21
MM v[84:87],v[44:47],a[92:95]
TR v[38:39],v4,55296
s_waitcnt lgkmcnt(8)
v_mul_f32 v214, v214, v22
v_mul_f32 v215, v215, v23
MM v[88:91],v[48:51],a[64:67]
TR v[40:41],v4,57344
s_waitcnt vmcnt(26)
v_lshlrev_b32 v20, 16, v140
v_and_b32 v21, s3, v140
MM v[88:91],v[52:55],a[72:75]
TR v[42:43],v4,59392
v_lshlrev_b32 v22, 16, v141
v_and_b32 v23, s3, v141
MM v[92:95],v[48:51],a[68:71]
TR v[44:45],v4,61440
v_add_f32 v216, v216, v20
v_add_f32 v217, v217, v21
MM v[92:95],v[52:55],a[76:79]
TR v[46:47],v4,63488
s_waitcnt lgkmcnt(8)
v_add_f32 v218, v218, v22
v_add_f32 v219, v219, v23
v_mul_f32 v20, s87, v216
MM v[88:91],v[56:59],a[80:83]
TR v[48:49],v5,49152
v_mul_f32 v21, s87, v217
v_mul_f32 v22, s87, v218
MM v[88:91],v[60:63],a[88:91]
TR v[50:51],v5,51200
v_mul_f32 v23, s87, v219
v_exp_f32 v20, v20
MM v[92:95],v[56:59],a[84:87]
TR v[52:53],v5,53248
v_exp_f32 v21, v21
v_exp_f32 v22, v22
v_exp_f32 v23, v23
MM v[92:95],v[60:63],a[92:95]
TR v[54:55],v5,55296
s_waitcnt lgkmcnt(8)
s_waitcnt vmcnt(0)
v_add_f32 v20, 1.0, v20
v_add_f32 v21, 1.0, v21
MM v[64:67],v[32:35],a[96:99]
TR v[56:57],v5,57344
v_add_f32 v22, 1.0, v22
v_add_f32 v23, 1.0, v23
MM v[64:67],v[36:39],a[104:107]
TR v[58:59],v5,59392
v_rcp_f32 v20, v20
v_rcp_f32 v21, v21
MM v[68:71],v[32:35],a[100:103]
TR v[60:61],v5,61440
v_rcp_f32 v22, v22
MM v[68:71],v[36:39],a[108:111]
TR v[62:63],v5,63488
s_waitcnt lgkmcnt(8)
v_rcp_f32 v23, v23
MM v[64:67],v[40:43],a[112:115]
TR v[32:33],v6,49152
v_mul_f32 v216, v216, v20
v_mul_f32 v217, v217, v21
MM v[64:67],v[44:47],a[120:123]
TR v[34:35],v6,51200
v_mul_f32 v218, v218, v22
v_mul_f32 v219, v219, v23
MM v[68:71],v[40:43],a[116:119]
TR v[36:37],v6,53248
v_lshlrev_b32 v20, 16, v142
v_and_b32 v21, s3, v142
MM v[68:71],v[44:47],a[124:127]
TR v[38:39],v6,55296
s_waitcnt lgkmcnt(8)
v_lshlrev_b32 v22, 16, v143
v_and_b32 v23, s3, v143
v_add_f32 v220, v220, v20
MM v[72:75],v[48:51],a[96:99]
TR v[40:41],v6,57344
v_add_f32 v221, v221, v21
v_add_f32 v222, v222, v22
MM v[72:75],v[52:55],a[104:107]
TR v[42:43],v6,59392
v_add_f32 v223, v223, v23
v_mul_f32 v20, s87, v220
MM v[76:79],v[48:51],a[100:103]
TR v[44:45],v6,61440
v_mul_f32 v21, s87, v221
v_mul_f32 v22, s87, v222
v_mul_f32 v23, s87, v223
MM v[76:79],v[52:55],a[108:111]
TR v[46:47],v6,63488
s_waitcnt lgkmcnt(8)
v_exp_f32 v20, v20
v_exp_f32 v21, v21
MM v[72:75],v[56:59],a[112:115]
TR v[48:49],v7,49152
v_exp_f32 v22, v22
v_exp_f32 v23, v23
MM v[72:75],v[60:63],a[120:123]
TR v[50:51],v7,51200
v_add_f32 v20, 1.0, v20
v_add_f32 v21, 1.0, v21
v_add_f32 v22, 1.0, v22
MM v[76:79],v[56:59],a[116:119]
TR v[52:53],v7,53248
v_add_f32 v23, 1.0, v23
v_rcp_f32 v20, v20
MM v[76:79],v[60:63],a[124:127]
TR v[54:55],v7,55296
s_waitcnt lgkmcnt(8)
v_rcp_f32 v21, v21
MM v[80:83],v[32:35],a[96:99]
TR v[56:57],v7,57344
v_rcp_f32 v22, v22
MM v[80:83],v[36:39],a[104:107]
TR v[58:59],v7,59392
v_rcp_f32 v23, v23
MM v[84:87],v[32:35],a[100:103]
TR v[60:61],v7,61440
v_mul_f32 v220, v220, v20
v_mul_f32 v221, v221, v21
MM v[84:87],v[36:39],a[108:111]
TR v[62:63],v7,63488
s_waitcnt lgkmcnt(8)
v_mul_f32 v222, v222, v22
v_mul_f32 v223, v223, v23
MM v[80:83],v[40:43],a[112:115]
MM v[80:83],v[44:47],a[120:123]
MM v[84:87],v[40:43],a[116:119]
v_fmac_f32 v96, v64, v192
v_fmac_f32 v97, v65, v193
v_fmac_f32 v98, v66, v194
MM v[84:87],v[44:47],a[124:127]
s_waitcnt lgkmcnt(4)
v_fmac_f32 v99, v67, v195
v_fmac_f32 v104, v72, v200
v_fmac_f32 v105, v73, v201
MM v[88:91],v[48:51],a[96:99]
v_fmac_f32 v106, v74, v202
v_fmac_f32 v107, v75, v203
v_cvt_pk_bf16_f32 v192, v96, v97
MM v[88:91],v[52:55],a[104:107]
v_cvt_pk_bf16_f32 v193, v98, v99
v_cvt_pk_bf16_f32 v194, v104, v105
v_cvt_pk_bf16_f32 v195, v106, v107
MM v[92:95],v[48:51],a[100:103]
v_permlane16_swap_b32 v192, v194
v_permlane16_swap_b32 v193, v195
global_store_dwordx4 v16, v[192:195], s[18:19] offset:0 nt
MM v[92:95],v[52:55],a[108:111]
s_waitcnt lgkmcnt(0)
v_fmac_f32 v100, v68, v196
v_fmac_f32 v101, v69, v197
v_fmac_f32 v102, v70, v198
MM v[88:91],v[56:59],a[112:115]
v_fmac_f32 v103, v71, v199
v_fmac_f32 v108, v76, v204
v_fmac_f32 v109, v77, v205
MM v[88:91],v[60:63],a[120:123]
v_fmac_f32 v110, v78, v206
v_fmac_f32 v111, v79, v207
v_cvt_pk_bf16_f32 v196, v100, v101
MM v[92:95],v[56:59],a[116:119]
v_cvt_pk_bf16_f32 v197, v102, v103
v_cvt_pk_bf16_f32 v198, v108, v109
v_cvt_pk_bf16_f32 v199, v110, v111
MM v[92:95],v[60:63],a[124:127]
v_permlane16_swap_b32 v196, v198
v_permlane16_swap_b32 v197, v199
global_store_dwordx4 v17, v[196:199], s[18:19] offset:0 nt
v_fmac_f32 v112, v80, v208
v_fmac_f32 v113, v81, v209
v_fmac_f32 v114, v82, v210
v_fmac_f32 v115, v83, v211
v_fmac_f32 v120, v88, v216
v_fmac_f32 v121, v89, v217
v_fmac_f32 v122, v90, v218
v_fmac_f32 v123, v91, v219
v_cvt_pk_bf16_f32 v208, v112, v113
v_cvt_pk_bf16_f32 v209, v114, v115
v_cvt_pk_bf16_f32 v210, v120, v121
v_cvt_pk_bf16_f32 v211, v122, v123
s_nop 0
v_permlane16_swap_b32 v208, v210
v_permlane16_swap_b32 v209, v211
global_store_dwordx4 v16, v[208:211], s[18:19] offset:64 nt
v_fmac_f32 v116, v84, v212
v_fmac_f32 v117, v85, v213
v_fmac_f32 v118, v86, v214
v_fmac_f32 v119, v87, v215
v_fmac_f32 v124, v92, v220
v_fmac_f32 v125, v93, v221
v_fmac_f32 v126, v94, v222
v_fmac_f32 v127, v95, v223
v_cvt_pk_bf16_f32 v212, v116, v117
v_cvt_pk_bf16_f32 v213, v118, v119
v_cvt_pk_bf16_f32 v214, v124, v125
v_cvt_pk_bf16_f32 v215, v126, v127
s_nop 0
v_permlane16_swap_b32 v212, v214
v_permlane16_swap_b32 v213, v215
global_store_dwordx4 v17, v[212:215], s[18:19] offset:64 nt
s_endpgm
L2_fin3:
s_add_u32 s32, s8, s79
s_addc_u32 s33, s9, 0
s_sub_u32 s34, 2097152, s79
s_lshl_b32 s72, s24, 16
s_mov_b32 s75, 0
MM v[192:195],v[32:35],a[96:99]
TR v[56:57],v9,40960
s_add_u32 s98, s75, 0
s_and_b32 s98, s98, 3
s_lshl_b32 s97, s98, 19
s_add_u32 s97, s97, s72
s_lshl_b32 s98, s98, 14
s_add_u32 m0, s78, 32768
s_add_u32 s96, s97, 0
v_mov_b32 v27, s93
MM v[192:195],v[36:39],a[104:107]
TR v[58:59],v9,43008
buffer_load_dwordx4 v28, s[32:35], s96 offen lds
v_xor_b32 v26, 128, v27
MM v[196:199],v[32:35],a[100:103]
TR v[60:61],v9,45056
s_mov_b32 s3, 0xffff0000
MM v[196:199],v[36:39],a[108:111]
TR v[62:63],v9,47104
s_waitcnt lgkmcnt(8)
s_add_u32 m0, s78, 33792
s_add_u32 s96, s97, 16384
v_and_b32 v16, 15, v1
MM v[192:195],v[40:43],a[112:115]
TR v[32:33],v8,49152
buffer_load_dwordx4 v28, s[32:35], s96 offen lds
MM v[192:195],v[44:47],a[120:123]
TR v[34:35],v8,51200
v_lshlrev_b32 v16, 11, v16
MM v[196:199],v[40:43],a[116:119]
TR v[36:37],v8,53248
v_bfe_u32 v17, v1, 4, 1
MM v[196:199],v[44:47],a[124:127]
TR v[38:39],v8,55296
s_waitcnt lgkmcnt(8)
s_add_u32 m0, s78, 34816
s_add_u32 s96, s97, 32768
v_lshl_add_u32 v16, v17, 5, v16
MM v[200:203],v[48:51],a[96:99]
TR v[40:41],v8,57344
buffer_load_dwordx4 v28, s[32:35], s96 offen lds
v_lshrrev_b32 v17, 5, v1
MM v[200:203],v[52:55],a[104:107]
TR v[42:43],v8,59392
MM v[204:207],v[48:51],a[100:103]
TR v[44:45],v8,61440
s_add_u32 m0, s78, 35840
s_add_u32 s96, s97, 49152
v_lshl_add_u32 v16, v17, 4, v16
MM v[204:207],v[52:55],a[108:111]
TR v[46:47],v8,63488
s_waitcnt lgkmcnt(8)
buffer_load_dwordx4 v28, s[32:35], s96 offen lds
v_add_u32 v16, s94, v16
MM v[200:203],v[56:59],a[112:115]
TR v[48:49],v9,49152
v_add_u32 v17, 32768, v16
MM v[200:203],v[60:63],a[120:123]
TR v[50:51],v9,51200
MM v[204:207],v[56:59],a[116:119]
TR v[52:53],v9,53248
s_add_u32 m0, s78, 49152
s_add_u32 s96, s97, 262144
v_add_u32 v160, 0x20000, v4
MM v[204:207],v[60:63],a[124:127]
TR v[54:55],v9,55296
s_waitcnt lgkmcnt(8)
buffer_load_dwordx4 v28, s[32:35], s96 offen lds
v_add_u32 v161, 0x20000, v5
MM v[224:227],v[32:35],a[96:99]
TR v[56:57],v9,57344
v_add_u32 v162, 0x20000, v6
MM v[224:227],v[36:39],a[104:107]
TR v[58:59],v9,59392
v_add_u32 v163, 0x20000, v7
MM v[228:231],v[32:35],a[100:103]
TR v[60:61],v9,61440
s_add_u32 m0, s78, 50176
s_add_u32 s96, s97, 278528
MM v[228:231],v[36:39],a[108:111]
TR v[62:63],v9,63488
s_waitcnt lgkmcnt(8)
buffer_load_dwordx4 v28, s[32:35], s96 offen lds
v_mov_b32 v64, 0
MM v[224:227],v[40:43],a[112:115]
TR v[32:33],v10,49152
v_mov_b32 v65, 0
MM v[224:227],v[44:47],a[120:123]
TR v[34:35],v10,51200
s_add_u32 m0, s78, 51200
s_add_u32 s96, s97, 294912
v_mov_b32 v66, 0
MM v[228:231],v[40:43],a[116:119]
TR v[36:37],v10,53248
buffer_load_dwordx4 v28, s[32:35], s96 offen lds
v_mov_b32 v67, 0
MM v[228:231],v[44:47],a[124:127]
TR v[38:39],v10,55296
s_waitcnt lgkmcnt(8)
MM v[232:235],v[48:51],a[96:99]
TR v[40:41],v10,57344
v_mov_b32 v68, 0
MM v[232:235],v[52:55],a[104:107]
TR v[42:43],v10,59392
s_add_u32 m0, s78, 52224
s_add_u32 s96, s97, 311296
v_mov_b32 v69, 0
MM v[236:239],v[48:51],a[100:103]
TR v[44:45],v10,61440
buffer_load_dwordx4 v28, s[32:35], s96 offen lds
v_mov_b32 v70, 0
MM v[236:239],v[52:55],a[108:111]
TR v[46:47],v10,63488
s_waitcnt lgkmcnt(8)
MM v[232:235],v[56:59],a[112:115]
TR v[48:49],v11,49152
s_add_u32 s73, s98, 229376
v_mov_b32 v71, 0
MM v[232:235],v[60:63],a[120:123]
TR v[50:51],v11,51200
buffer_load_dwordx4 a[32:35], v2, s[36:39], s73 offen offset:0 sc1
v_mov_b32 v72, 0
MM v[236:239],v[56:59],a[116:119]
TR v[52:53],v11,53248
v_mov_b32 v73, 0
MM v[236:239],v[60:63],a[124:127]
TR v[54:55],v11,55296
s_waitcnt lgkmcnt(8)
v_mov_b32 v74, 0
MM v[240:243],v[32:35],a[96:99]
TR v[56:57],v11,57344
MM v[240:243],v[36:39],a[104:107]
TR v[58:59],v11,59392
buffer_load_dwordx4 a[36:39], v2, s[36:39], s73 offen offset:1024 sc1
v_mov_b32 v75, 0
MM v[244:247],v[32:35],a[100:103]
TR v[60:61],v11,61440
v_mov_b32 v76, 0
MM v[244:247],v[36:39],a[108:111]
TR v[62:63],v11,63488
s_waitcnt lgkmcnt(8)
s_waitcnt vmcnt(10)
s_barrier
v_mov_b32 v77, 0
MM v[240:243],v[40:43],a[112:115]
TR v[32:33],v4,16384
MM v[240:243],v[44:47],a[120:123]
TR v[34:35],v4,18432
buffer_load_dwordx4 a[40:43], v2, s[36:39], s73 offen offset:2048 sc1
v_mov_b32 v78, 0
MM v[244:247],v[40:43],a[116:119]
TR v[36:37],v4,20480
v_mov_b32 v79, 0
MM v[244:247],v[44:47],a[124:127]
TR v[38:39],v4,22528
s_waitcnt lgkmcnt(8)
v_mov_b32 v80, 0
MM v[248:251],v[48:51],a[96:99]
TR v[40:41],v4,24576
buffer_load_dwordx4 a[44:47], v2, s[36:39], s73 offen offset:3072 sc1
v_mov_b32 v81, 0
MM v[248:251],v[52:55],a[104:107]
TR v[42:43],v4,26624
MM v[252:255],v[48:51],a[100:103]
TR v[44:45],v4,28672
v_mov_b32 v82, 0
MM v[252:255],v[52:55],a[108:111]
TR v[46:47],v4,30720
s_waitcnt lgkmcnt(8)
s_add_u32 s73, s98, 233472
v_mov_b32 v83, 0
MM v[248:251],v[56:59],a[112:115]
TR v[48:49],v5,16384
buffer_load_dwordx4 a[48:51], v2, s[36:39], s73 offen offset:0 sc1
v_mov_b32 v84, 0
MM v[248:251],v[60:63],a[120:123]
TR v[50:51],v5,18432
v_mov_b32 v85, 0
MM v[252:255],v[56:59],a[116:119]
TR v[52:53],v5,20480
MM v[252:255],v[60:63],a[124:127]
TR v[54:55],v5,22528
s_waitcnt lgkmcnt(8)
buffer_load_dwordx4 a[52:55], v2, s[36:39], s73 offen offset:1024 sc1
v_mov_b32 v86, 0
MM v[224:227],v[32:35],a[0:3]
TR v[56:57],v5,24576
v_mov_b32 v87, 0
MM v[224:227],v[36:39],a[8:11]
TR v[58:59],v5,26624
v_mov_b32 v88, 0
MM v[228:231],v[32:35],a[4:7]
TR v[60:61],v5,28672
MM v[228:231],v[36:39],a[12:15]
TR v[62:63],v5,30720
s_waitcnt lgkmcnt(8)
buffer_load_dwordx4 a[56:59], v2, s[36:39], s73 offen offset:2048 sc1
v_mov_b32 v89, 0
MM v[224:227],v[40:43],a[16:19]
TR v[32:33],v6,16384
v_mov_b32 v90, 0
MM v[224:227],v[44:47],a[24:27]
TR v[34:35],v6,18432
v_mov_b32 v91, 0
MM v[228:231],v[40:43],a[20:23]
TR v[36:37],v6,20480
v_mov_b32 v92, 0
MM v[228:231],v[44:47],a[28:31]
TR v[38:39],v6,22528
s_waitcnt lgkmcnt(8)
buffer_load_dwordx4 a[60:63], v2, s[36:39], s73 offen offset:3072 sc1
MM v[232:235],v[48:51],a[0:3]
TR v[40:41],v6,24576
v_mov_b32 v93, 0
MM v[232:235],v[52:55],a[8:11]
TR v[42:43],v6,26624
s_add_u32 s73, s98, 237568
v_mov_b32 v94, 0
MM v[236:239],v[48:51],a[4:7]
TR v[44:45],v6,28672
buffer_load_dwordx4 a[64:67], v2, s[36:39], s73 offen offset:0 sc1
v_mov_b32 v95, 0
MM v[236:239],v[52:55],a[12:15]
TR v[46:47],v6,30720
s_waitcnt lgkmcnt(8)
MM v[232:235],v[56:59],a[16:19]
TR v[48:49],v7,16384
MM v[232:235],v[60:63],a[24:27]
TR v[50:51],v7,18432
MM v[236:239],v[56:59],a[20:23]
TR v[52:53],v7,20480
buffer_load_dwordx4 a[68:71], v2, s[36:39], s73 offen offset:1024 sc1
v_cvt_pk_bf16_f32 v224, v224, v225
MM v[236:239],v[60:63],a[28:31]
TR v[54:55],v7,22528
s_waitcnt lgkmcnt(8)
v_cvt_pk_bf16_f32 v225, v226, v227
MM v[240:243],v[32:35],a[0:3]
TR v[56:57],v7,24576
v_cvt_pk_bf16_f32 v226, v228, v229
MM v[240:243],v[36:39],a[8:11]
TR v[58:59],v7,26624
buffer_load_dwordx4 a[72:75], v2, s[36:39], s73 offen offset:2048 sc1
v_cvt_pk_bf16_f32 v227, v230, v231
MM v[244:247],v[32:35],a[4:7]
TR v[60:61],v7,28672
buffer_store_dwordx4 v[224:227], v2, s[40:43], s74 offen offset:0 sc0 sc1
MM v[244:247],v[36:39],a[12:15]
TR v[62:63],v7,30720
s_waitcnt lgkmcnt(8)
MM v[240:243],v[40:43],a[16:19]
TR v[32:33],v10,32768
MM v[240:243],v[44:47],a[24:27]
TR v[34:35],v10,34816
buffer_load_dwordx4 a[76:79], v2, s[36:39], s73 offen offset:3072 sc1
MM v[244:247],v[40:43],a[20:23]
TR v[36:37],v10,36864
v_cvt_pk_bf16_f32 v232, v232, v233
MM v[244:247],v[44:47],a[28:31]
TR v[38:39],v10,38912
s_waitcnt lgkmcnt(8)
v_cvt_pk_bf16_f32 v233, v234, v235
MM v[248:251],v[48:51],a[0:3]
TR v[40:41],v10,40960
s_add_u32 s73, s98, 241664
v_cvt_pk_bf16_f32 v234, v236, v237
MM v[248:251],v[52:55],a[8:11]
TR v[42:43],v10,43008
buffer_load_dwordx4 a[80:83], v2, s[36:39], s73 offen offset:0 sc1
v_cvt_pk_bf16_f32 v235, v238, v239
MM v[252:255],v[48:51],a[4:7]
TR v[44:45],v10,45056
buffer_store_dwordx4 v[232:235], v2, s[40:43], s74 offen offset:1024 sc0 sc1
MM v[252:255],v[52:55],a[12:15]
TR v[46:47],v10,47104
s_waitcnt lgkmcnt(8)
MM v[248:251],v[56:59],a[16:19]
TR v[48:49],v11,32768
buffer_load_dwordx4 a[84:87], v2, s[36:39], s73 offen offset:1024 sc1
MM v[248:251],v[60:63],a[24:27]
TR v[50:51],v11,34816
MM v[252:255],v[56:59],a[20:23]
TR v[52:53],v11,36864
v_cvt_pk_bf16_f32 v240, v240, v241
MM v[252:255],v[60:63],a[28:31]
TR v[54:55],v11,38912
s_waitcnt lgkmcnt(8)
v_cvt_pk_bf16_f32 v241, v242, v243
MM v[208:211],v[32:35],a[96:99]
TR v[56:57],v11,40960
buffer_load_dwordx4 a[88:91], v2, s[36:39], s73 offen offset:2048 sc1
v_cvt_pk_bf16_f32 v242, v244, v245
MM v[208:211],v[36:39],a[104:107]
TR v[58:59],v11,43008
v_cvt_pk_bf16_f32 v243, v246, v247
MM v[212:215],v[32:35],a[100:103]
TR v[60:61],v11,45056
buffer_store_dwordx4 v[240:243], v2, s[40:43], s74 offen offset:2048 sc0 sc1
MM v[212:215],v[36:39],a[108:111]
TR v[62:63],v11,47104
s_waitcnt lgkmcnt(8)
buffer_load_dwordx4 a[92:95], v2, s[36:39], s73 offen offset:3072 sc1
MM v[208:211],v[40:43],a[112:115]
TR v[32:33],v4,0
MM v[208:211],v[44:47],a[120:123]
TR v[34:35],v4,2048
MM v[212:215],v[40:43],a[116:119]
TR v[36:37],v4,4096
s_add_u32 s98, s75, 1
s_and_b32 s98, s98, 3
s_lshl_b32 s97, s98, 19
s_add_u32 s97, s97, s72
s_lshl_b32 s98, s98, 14
s_add_u32 m0, s78, 65536
s_add_u32 s96, s97, 0
v_cvt_pk_bf16_f32 v248, v248, v249
MM v[212:215],v[44:47],a[124:127]
TR v[38:39],v4,6144
s_waitcnt lgkmcnt(8)
buffer_load_dwordx4 v28, s[32:35], s96 offen lds
v_cvt_pk_bf16_f32 v249, v250, v251
MM v[216:219],v[48:51],a[96:99]
TR v[40:41],v4,8192
v_cvt_pk_bf16_f32 v250, v252, v253
MM v[216:219],v[52:55],a[104:107]
TR v[42:43],v4,10240
s_add_u32 m0, s78, 66560
s_add_u32 s96, s97, 16384
v_cvt_pk_bf16_f32 v251, v254, v255
MM v[220:223],v[48:51],a[100:103]
TR v[44:45],v4,12288
buffer_load_dwordx4 v28, s[32:35], s96 offen lds
buffer_store_dwordx4 v[248:251], v2, s[40:43], s74 offen offset:3072 sc0 sc1
MM v[220:223],v[52:55],a[108:111]
TR v[46:47],v4,14336
s_waitcnt lgkmcnt(8)
MM v[216:219],v[56:59],a[112:115]
TR v[48:49],v5,0
MM v[216:219],v[60:63],a[120:123]
TR v[50:51],v5,2048
s_add_u32 m0, s78, 67584
s_add_u32 s96, s97, 32768
MM v[220:223],v[56:59],a[116:119]
TR v[52:53],v5,4096
buffer_load_dwordx4 v28, s[32:35], s96 offen lds
MM v[220:223],v[60:63],a[124:127]
TR v[54:55],v5,6144
s_waitcnt lgkmcnt(8)
MM v[192:195],v[32:35],a[0:3]
TR v[56:57],v5,8192
MM v[192:195],v[36:39],a[8:11]
TR v[58:59],v5,10240
s_add_u32 m0, s78, 68608
s_add_u32 s96, s97, 49152
MM v[196:199],v[32:35],a[4:7]
TR v[60:61],v5,12288
buffer_load_dwordx4 v28, s[32:35], s96 offen lds
MM v[196:199],v[36:39],a[12:15]
TR v[62:63],v5,14336
s_waitcnt lgkmcnt(8)
MM v[192:195],v[40:43],a[16:19]
TR v[32:33],v6,0
s_add_u32 m0, s78, 81920
s_add_u32 s96, s97, 262144
MM v[192:195],v[44:47],a[24:27]
TR v[34:35],v6,2048
buffer_load_dwordx4 v28, s[32:35], s96 offen lds
MM v[196:199],v[40:43],a[20:23]
TR v[36:37],v6,4096
MM v[196:199],v[44:47],a[28:31]
TR v[38:39],v6,6144
s_waitcnt lgkmcnt(8)
MM v[200:203],v[48:51],a[0:3]
TR v[40:41],v6,8192
s_add_u32 m0, s78, 82944
s_add_u32 s96, s97, 278528
MM v[200:203],v[52:55],a[8:11]
TR v[42:43],v6,10240
buffer_load_dwordx4 v28, s[32:35], s96 offen lds
MM v[204:207],v[48:51],a[4:7]
TR v[44:45],v6,12288
MM v[204:207],v[52:55],a[12:15]
TR v[46:47],v6,14336
s_waitcnt lgkmcnt(8)
s_add_u32 m0, s78, 83968
s_add_u32 s96, s97, 294912
MM v[200:203],v[56:59],a[16:19]
TR v[48:49],v7,0
buffer_load_dwordx4 v28, s[32:35], s96 offen lds
MM v[200:203],v[60:63],a[24:27]
TR v[50:51],v7,2048
MM v[204:207],v[56:59],a[20:23]
TR v[52:53],v7,4096
MM v[204:207],v[60:63],a[28:31]
TR v[54:55],v7,6144
s_waitcnt lgkmcnt(8)
s_add_u32 m0, s78, 84992
s_add_u32 s96, s97, 311296
MM v[208:211],v[32:35],a[0:3]
TR v[56:57],v7,8192
buffer_load_dwordx4 v28, s[32:35], s96 offen lds
MM v[208:211],v[36:39],a[8:11]
TR v[58:59],v7,10240
MM v[212:215],v[32:35],a[4:7]
TR v[60:61],v7,12288
MM v[212:215],v[36:39],a[12:15]
TR v[62:63],v7,14336
s_waitcnt lgkmcnt(8)
s_waitcnt vmcnt(28)
s_barrier
s_add_u32 s73, s98, 229376
MM v[208:211],v[40:43],a[16:19]
TR v[32:33],v4,32768
buffer_load_dwordx4 a[144:147], v2, s[36:39], s73 offen offset:0 sc1
MM v[208:211],v[44:47],a[24:27]
TR v[34:35],v4,34816
MM v[212:215],v[40:43],a[20:23]
TR v[36:37],v4,36864
MM v[212:215],v[44:47],a[28:31]
TR v[38:39],v4,38912
s_waitcnt lgkmcnt(8)
buffer_load_dwordx4 a[148:151], v2, s[36:39], s73 offen offset:1024 sc1
MM v[216:219],v[48:51],a[0:3]
TR v[40:41],v4,40960
MM v[216:219],v[52:55],a[8:11]
TR v[42:43],v4,43008
MM v[220:223],v[48:51],a[4:7]
TR v[44:45],v4,45056
MM v[220:223],v[52:55],a[12:15]
TR v[46:47],v4,47104
s_waitcnt lgkmcnt(8)
buffer_load_dwordx4 a[152:155], v2, s[36:39], s73 offen offset:2048 sc1
MM v[216:219],v[56:59],a[16:19]
TR v[48:49],v5,32768
MM v[216:219],v[60:63],a[24:27]
TR v[50:51],v5,34816
MM v[220:223],v[56:59],a[20:23]
TR v[52:53],v5,36864
buffer_load_dwordx4 a[156:159], v2, s[36:39], s73 offen offset:3072 sc1
MM v[220:223],v[60:63],a[28:31]
TR v[54:55],v5,38912
s_waitcnt lgkmcnt(8)
s_waitcnt vmcnt(24)
MM v[64:67],v[32:35],a[32:35]
TR v[56:57],v5,40960
MM v[64:67],v[36:39],a[40:43]
TR v[58:59],v5,43008
s_add_u32 s73, s98, 233472
MM v[68:71],v[32:35],a[36:39]
TR v[60:61],v5,45056
buffer_load_dwordx4 a[160:163], v2, s[36:39], s73 offen offset:0 sc1
MM v[68:71],v[36:39],a[44:47]
TR v[62:63],v5,47104
s_waitcnt lgkmcnt(8)
MM v[64:67],v[40:43],a[48:51]
TR v[32:33],v6,32768
MM v[64:67],v[44:47],a[56:59]
TR v[34:35],v6,34816
buffer_load_dwordx4 a[164:167], v2, s[36:39], s73 offen offset:1024 sc1
MM v[68:71],v[40:43],a[52:55]
TR v[36:37],v6,36864
MM v[68:71],v[44:47],a[60:63]
TR v[38:39],v6,38912
s_waitcnt lgkmcnt(8)
MM v[72:75],v[48:51],a[32:35]
TR v[40:41],v6,40960
buffer_load_dwordx4 a[168:171], v2, s[36:39], s73 offen offset:2048 sc1
MM v[72:75],v[52:55],a[40:43]
TR v[42:43],v6,43008
MM v[76:79],v[48:51],a[36:39]
TR v[44:45],v6,45056
MM v[76:79],v[52:55],a[44:47]
TR v[46:47],v6,47104
s_waitcnt lgkmcnt(8)
buffer_load_dwordx4 a[172:175], v2, s[36:39], s73 offen offset:3072 sc1
MM v[72:75],v[56:59],a[48:51]
TR v[48:49],v7,32768
MM v[72:75],v[60:63],a[56:59]
TR v[50:51],v7,34816
s_add_u32 s73, s98, 237568
MM v[76:79],v[56:59],a[52:55]
TR v[52:53],v7,36864
buffer_load_dwordx4 a[176:179], v2, s[36:39], s73 offen offset:0 sc1
MM v[76:79],v[60:63],a[60:63]
TR v[54:55],v7,38912
s_waitcnt lgkmcnt(8)
MM v[80:83],v[32:35],a[32:35]
TR v[56:57],v7,40960
MM v[80:83],v[36:39],a[40:43]
TR v[58:59],v7,43008
buffer_load_dwordx4 a[180:183], v2, s[36:39], s73 offen offset:1024 sc1
MM v[84:87],v[32:35],a[36:39]
TR v[60:61],v7,45056
MM v[84:87],v[36:39],a[44:47]
TR v[62:63],v7,47104
s_waitcnt lgkmcnt(8)
s_waitcnt vmcnt(16)
s_barrier
s_cmp_lg_u32 s24, 0
s_cbranch_scc1 Lf42
v_mov_b32 v25, 1
s_mov_b64 exec, 1
global_store_dword v27, v25, s[22:23] sc0 sc1
s_mov_b64 exec, -1
Lf42:
MM v[80:83],v[40:43],a[48:51]
TR v[32:33],v4,49152
buffer_load_dwordx4 a[184:187], v2, s[36:39], s73 offen offset:2048 sc1
MM v[80:83],v[44:47],a[56:59]
TR v[34:35],v4,51200
MM v[84:87],v[40:43],a[52:55]
TR v[36:37],v4,53248
MM v[84:87],v[44:47],a[60:63]
TR v[38:39],v4,55296
s_waitcnt lgkmcnt(8)
buffer_load_dwordx4 a[188:191], v2, s[36:39], s73 offen offset:3072 sc1
MM v[88:91],v[48:51],a[32:35]
TR v[40:41],v4,57344
MM v[88:91],v[52:55],a[40:43]
TR v[42:43],v4,59392
s_add_u32 s73, s98, 241664
MM v[92:95],v[48:51],a[36:39]
TR v[44:45],v4,61440
buffer_load_dwordx4 a[192:195], v2, s[36:39], s73 offen offset:0 sc1
MM v[92:95],v[52:55],a[44:47]
TR v[46:47],v4,63488
s_waitcnt lgkmcnt(8)
MM v[88:91],v[56:59],a[48:51]
TR v[48:49],v5,49152
MM v[88:91],v[60:63],a[56:59]
TR v[50:51],v5,51200
buffer_load_dwordx4 a[196:199], v2, s[36:39], s73 offen offset:1024 sc1
MM v[92:95],v[56:59],a[52:55]
TR v[52:53],v5,53248
MM v[92:95],v[60:63],a[60:63]
TR v[54:55],v5,55296
s_waitcnt lgkmcnt(8)
s_waitcnt vmcnt(23)
MM v[64:67],v[32:35],a[64:67]
TR v[56:57],v5,57344
buffer_load_dwordx4 a[200:203], v2, s[36:39], s73 offen offset:2048 sc1
MM v[64:67],v[36:39],a[72:75]
TR v[58:59],v5,59392
MM v[68:71],v[32:35],a[68:71]
TR v[60:61],v5,61440
MM v[68:71],v[36:39],a[76:79]
TR v[62:63],v5,63488
s_waitcnt lgkmcnt(8)
buffer_load_dwordx4 a[204:207], v2, s[36:39], s73 offen offset:3072 sc1
MM v[64:67],v[40:43],a[80:83]
TR v[32:33],v6,49152
MM v[64:67],v[44:47],a[88:91]
TR v[34:35],v6,51200
s_add_u32 s98, s75, 2
s_and_b32 s98, s98, 3
s_lshl_b32 s97, s98, 19
s_add_u32 s97, s97, s72
s_lshl_b32 s98, s98, 14
s_add_u32 m0, s78, 131072
s_add_u32 s96, s97, 0
MM v[68:71],v[40:43],a[84:87]
TR v[36:37],v6,53248
buffer_load_dwordx4 v28, s[32:35], s96 offen lds
MM v[68:71],v[44:47],a[92:95]
TR v[38:39],v6,55296
s_waitcnt lgkmcnt(8)
MM v[72:75],v[48:51],a[64:67]
TR v[40:41],v6,57344
s_add_u32 m0, s78, 132096
s_add_u32 s96, s97, 16384
MM v[72:75],v[52:55],a[72:75]
TR v[42:43],v6,59392
buffer_load_dwordx4 v28, s[32:35], s96 offen lds
MM v[76:79],v[48:51],a[68:71]
TR v[44:45],v6,61440
MM v[76:79],v[52:55],a[76:79]
TR v[46:47],v6,63488
s_waitcnt lgkmcnt(8)
s_add_u32 m0, s78, 133120
s_add_u32 s96, s97, 32768
MM v[72:75],v[56:59],a[80:83]
TR v[48:49],v7,49152
buffer_load_dwordx4 v28, s[32:35], s96 offen lds
MM v[72:75],v[60:63],a[88:91]
TR v[50:51],v7,51200
MM v[76:79],v[56:59],a[84:87]
TR v[52:53],v7,53248
s_add_u32 m0, s78, 134144
s_add_u32 s96, s97, 49152
MM v[76:79],v[60:63],a[92:95]
TR v[54:55],v7,55296
s_waitcnt lgkmcnt(8)
buffer_load_dwordx4 v28, s[32:35], s96 offen lds
MM v[80:83],v[32:35],a[64:67]
TR v[56:57],v7,57344
MM v[80:83],v[36:39],a[72:75]
TR v[58:59],v7,59392
s_add_u32 m0, s78, 147456
s_add_u32 s96, s97, 262144
MM v[84:87],v[32:35],a[68:71]
TR v[60:61],v7,61440
buffer_load_dwordx4 v28, s[32:35], s96 offen lds
MM v[84:87],v[36:39],a[76:79]
TR v[62:63],v7,63488
s_waitcnt lgkmcnt(8)
s_waitcnt vmcnt(21)
s_barrier
MM v[80:83],v[40:43],a[80:83]
TR v[32:33],v8,0
s_add_u32 m0, s78, 148480
s_add_u32 s96, s97, 278528
MM v[80:83],v[44:47],a[88:91]
TR v[34:35],v8,2048
buffer_load_dwordx4 v28, s[32:35], s96 offen lds
MM v[84:87],v[40:43],a[84:87]
TR v[36:37],v8,4096
MM v[84:87],v[44:47],a[92:95]
TR v[38:39],v8,6144
s_waitcnt lgkmcnt(8)
s_add_u32 m0, s78, 149504
s_add_u32 s96, s97, 294912
MM v[88:91],v[48:51],a[64:67]
TR v[40:41],v8,8192
buffer_load_dwordx4 v28, s[32:35], s96 offen lds
MM v[88:91],v[52:55],a[72:75]
TR v[42:43],v8,10240
MM v[92:95],v[48:51],a[68:71]
TR v[44:45],v8,12288
s_add_u32 m0, s78, 150528
s_add_u32 s96, s97, 311296
MM v[92:95],v[52:55],a[76:79]
TR v[46:47],v8,14336
s_waitcnt lgkmcnt(8)
buffer_load_dwordx4 v28, s[32:35], s96 offen lds
MM v[88:91],v[56:59],a[80:83]
TR v[48:49],v9,0
MM v[88:91],v[60:63],a[88:91]
TR v[50:51],v9,2048
s_add_u32 s73, s98, 229376
MM v[92:95],v[56:59],a[84:87]
TR v[52:53],v9,4096
buffer_load_dwordx4 a[208:211], v2, s[36:39], s73 offen offset:0 sc1
MM v[92:95],v[60:63],a[92:95]
TR v[54:55],v9,6144
s_waitcnt lgkmcnt(8)
s_waitcnt vmcnt(17)
MM v[64:67],v[32:35],a[144:147]
TR v[56:57],v9,8192
global_load_dword v25, v26, s[22:23] sc1
MM v[64:67],v[36:39],a[152:155]
TR v[58:59],v9,10240
buffer_load_dwordx4 a[212:215], v2, s[36:39], s73 offen offset:1024 sc1
MM v[68:71],v[32:35],a[148:151]
TR v[60:61],v9,12288
v_accvgpr_read_b32 v12, a128
MM v[68:71],v[36:39],a[156:159]
TR v[62:63],v9,14336
s_waitcnt lgkmcnt(8)
v_accvgpr_read_b32 v13, a129
MM v[64:67],v[40:43],a[160:163]
TR v[32:33],v10,0
buffer_load_dwordx4 a[216:219], v2, s[36:39], s73 offen offset:2048 sc1
v_accvgpr_read_b32 v14, a130
MM v[64:67],v[44:47],a[168:171]
TR v[34:35],v10,2048
v_accvgpr_read_b32 v15, a131
MM v[68:71],v[40:43],a[164:167]
TR v[36:37],v10,4096
v_permlane16_swap_b32 v12, v14
MM v[68:71],v[44:47],a[172:175]
TR v[38:39],v10,6144
s_waitcnt lgkmcnt(8)
buffer_load_dwordx4 a[220:223], v2, s[36:39], s73 offen offset:3072 sc1
v_permlane16_swap_b32 v13, v15
MM v[72:75],v[48:51],a[144:147]
TR v[40:41],v10,8192
v_lshlrev_b32 v96, 16, v12
MM v[72:75],v[52:55],a[152:155]
TR v[42:43],v10,10240
s_add_u32 s73, s98, 233472
v_and_b32 v97, s3, v12
MM v[76:79],v[48:51],a[148:151]
TR v[44:45],v10,12288
buffer_load_dwordx4 a[224:227], v2, s[36:39], s73 offen offset:0 sc1
v_lshlrev_b32 v98, 16, v13
MM v[76:79],v[52:55],a[156:159]
TR v[46:47],v10,14336
s_waitcnt lgkmcnt(8)
v_and_b32 v99, s3, v13
MM v[72:75],v[56:59],a[160:163]
TR v[48:49],v11,0
v_lshlrev_b32 v104, 16, v14
MM v[72:75],v[60:63],a[168:171]
TR v[50:51],v11,2048
buffer_load_dwordx4 a[228:231], v2, s[36:39], s73 offen offset:1024 sc1
v_and_b32 v105, s3, v14
MM v[76:79],v[56:59],a[164:167]
TR v[52:53],v11,4096
v_lshlrev_b32 v106, 16, v15
MM v[76:79],v[60:63],a[172:175]
TR v[54:55],v11,6144
s_waitcnt lgkmcnt(8)
v_and_b32 v107, s3, v15
MM v[80:83],v[32:35],a[144:147]
TR v[56:57],v11,8192
buffer_load_dwordx4 a[232:235], v2, s[36:39], s73 offen offset:2048 sc1
v_accvgpr_read_b32 v12, a132
MM v[80:83],v[36:39],a[152:155]
TR v[58:59],v11,10240
v_accvgpr_read_b32 v13, a133
MM v[84:87],v[32:35],a[148:151]
TR v[60:61],v11,12288
v_accvgpr_read_b32 v14, a134
MM v[84:87],v[36:39],a[156:159]
TR v[62:63],v11,14336
s_waitcnt lgkmcnt(8)
buffer_load_dwordx4 a[236:239], v2, s[36:39], s73 offen offset:3072 sc1
v_accvgpr_read_b32 v15, a135
MM v[80:83],v[40:43],a[160:163]
TR v[32:33],v8,16384
v_permlane16_swap_b32 v12, v14
MM v[80:83],v[44:47],a[168:171]
TR v[34:35],v8,18432
s_add_u32 s73, s98, 237568
v_permlane16_swap_b32 v13, v15
MM v[84:87],v[40:43],a[164:167]
TR v[36:37],v8,20480
buffer_load_dwordx4 a[96:99], v2, s[36:39], s73 offen offset:0 sc1
v_lshlrev_b32 v100, 16, v12
MM v[84:87],v[44:47],a[172:175]
TR v[38:39],v8,22528
s_waitcnt lgkmcnt(8)
v_and_b32 v101, s3, v12
MM v[88:91],v[48:51],a[144:147]
TR v[40:41],v8,24576
v_lshlrev_b32 v102, 16, v13
MM v[88:91],v[52:55],a[152:155]
TR v[42:43],v8,26624
buffer_load_dwordx4 a[100:103], v2, s[36:39], s73 offen offset:1024 sc1
v_and_b32 v103, s3, v13
MM v[92:95],v[48:51],a[148:151]
TR v[44:45],v8,28672
v_lshlrev_b32 v108, 16, v14
MM v[92:95],v[52:55],a[156:159]
TR v[46:47],v8,30720
s_waitcnt lgkmcnt(8)
v_and_b32 v109, s3, v14
MM v[88:91],v[56:59],a[160:163]
TR v[48:49],v9,16384
buffer_load_dwordx4 a[104:107], v2, s[36:39], s73 offen offset:2048 sc1
v_lshlrev_b32 v110, 16, v15
MM v[88:91],v[60:63],a[168:171]
TR v[50:51],v9,18432
v_and_b32 v111, s3, v15
MM v[92:95],v[56:59],a[164:167]
TR v[52:53],v9,20480
MM v[92:95],v[60:63],a[172:175]
TR v[54:55],v9,22528
s_waitcnt lgkmcnt(8)
s_waitcnt vmcnt(20)
buffer_load_dwordx4 a[108:111], v2, s[36:39], s73 offen offset:3072 sc1
MM v[64:67],v[32:35],a[176:179]
TR v[56:57],v9,24576
s_waitcnt vmcnt(11)
v_readfirstlane_b32 s30, v25
s_nop 0
s_cmp_ge_u32 s30, 1
s_cbranch_scc1 Ld44
s_mov_b32 s31, 262144
Lp43:
global_load_dword v25, v26, s[22:23] offset:0 sc1
s_waitcnt vmcnt(0)
v_readfirstlane_b32 s30, v25
s_nop 0
s_cmp_ge_u32 s30, 1
s_cbranch_scc1 Ld44
s_sleep 1
s_sub_u32 s31, s31, 1
s_cmp_lg_u32 s31, 0
s_cbranch_scc1 Lp43
Ld44:
MM v[64:67],v[36:39],a[184:187]
TR v[58:59],v9,26624
s_add_u32 s73, s98, 241664
MM v[68:71],v[32:35],a[180:183]
TR v[60:61],v9,28672
buffer_load_dwordx4 a[112:115], v2, s[36:39], s73 offen offset:0 sc1
MM v[68:71],v[36:39],a[188:191]
TR v[62:63],v9,30720
s_waitcnt lgkmcnt(8)
MM v[64:67],v[40:43],a[192:195]
TR v[32:33],v10,16384
buffer_load_dwordx4 v[128:131], v2, s[40:43], s77 offen offset:0 sc1
MM v[64:67],v[44:47],a[200:203]
TR v[34:35],v10,18432
buffer_load_dwordx4 a[116:119], v2, s[36:39], s73 offen offset:1024 sc1
buffer_load_dwordx4 v[132:135], v2, s[40:43], s77 offen offset:1024 sc1
MM v[68:71],v[40:43],a[196:199]
TR v[36:37],v10,20480
buffer_load_dwordx4 v[136:139], v2, s[40:43], s77 offen offset:2048 sc1
MM v[68:71],v[44:47],a[204:207]
TR v[38:39],v10,22528
s_waitcnt lgkmcnt(8)
buffer_load_dwordx4 v[140:143], v2, s[40:43], s77 offen offset:3072 sc1
MM v[72:75],v[48:51],a[176:179]
TR v[40:41],v10,24576
buffer_load_dwordx4 a[120:123], v2, s[36:39], s73 offen offset:2048 sc1
MM v[72:75],v[52:55],a[184:187]
TR v[42:43],v10,26624
v_accvgpr_read_b32 v12, a136
v_accvgpr_read_b32 v13, a137
MM v[76:79],v[48:51],a[180:183]
TR v[44:45],v10,28672
v_accvgpr_read_b32 v14, a138
MM v[76:79],v[52:55],a[188:191]
TR v[46:47],v10,30720
s_waitcnt lgkmcnt(8)
buffer_load_dwordx4 a[124:127], v2, s[36:39], s73 offen offset:3072 sc1
v_accvgpr_read_b32 v15, a139
MM v[72:75],v[56:59],a[192:195]
TR v[48:49],v11,16384
v_permlane16_swap_b32 v12, v14
MM v[72:75],v[60:63],a[200:203]
TR v[50:51],v11,18432
s_add_u32 s98, s75, 3
s_and_b32 s98, s98, 3
s_lshl_b32 s97, s98, 19
s_add_u32 s97, s97, s72
s_lshl_b32 s98, s98, 14
s_add_u32 m0, s78, 98304
s_add_u32 s96, s97, 0
v_permlane16_swap_b32 v13, v15
MM v[76:79],v[56:59],a[196:199]
TR v[52:53],v11,20480
buffer_load_dwordx4 v28, s[32:35], s96 offen lds
v_lshlrev_b32 v112, 16, v12
MM v[76:79],v[60:63],a[204:207]
TR v[54:55],v11,22528
s_waitcnt lgkmcnt(8)
v_and_b32 v113, s3, v12
MM v[80:83],v[32:35],a[176:179]
TR v[56:57],v11,24576
s_add_u32 m0, s78, 99328
s_add_u32 s96, s97, 16384
v_lshlrev_b32 v114, 16, v13
MM v[80:83],v[36:39],a[184:187]
TR v[58:59],v11,26624
buffer_load_dwordx4 v28, s[32:35], s96 offen lds
v_and_b32 v115, s3, v13
MM v[84:87],v[32:35],a[180:183]
TR v[60:61],v11,28672
v_lshlrev_b32 v120, 16, v14
MM v[84:87],v[36:39],a[188:191]
TR v[62:63],v11,30720
s_waitcnt lgkmcnt(8)
s_waitcnt vmcnt(23)
s_barrier
s_add_u32 m0, s78, 100352
s_add_u32 s96, s97, 32768
v_and_b32 v121, s3, v14
MM v[80:83],v[40:43],a[192:195]
TR v[32:33],v160,0
buffer_load_dwordx4 v28, s[32:35], s96 offen lds
v_lshlrev_b32 v122, 16, v15
MM v[80:83],v[44:47],a[200:203]
TR v[34:35],v160,2048
v_and_b32 v123, s3, v15
MM v[84:87],v[40:43],a[196:199]
TR v[36:37],v160,4096
s_add_u32 m0, s78, 101376
s_add_u32 s96, s97, 49152
v_accvgpr_read_b32 v12, a140
v_accvgpr_read_b32 v13, a141
MM v[84:87],v[44:47],a[204:207]
TR v[38:39],v160,6144
s_waitcnt lgkmcnt(8)
buffer_load_dwordx4 v28, s[32:35], s96 offen lds
v_accvgpr_read_b32 v14, a142
MM v[88:91],v[48:51],a[176:179]
TR v[40:41],v160,8192
v_accvgpr_read_b32 v15, a143
MM v[88:91],v[52:55],a[184:187]
TR v[42:43],v160,10240
s_add_u32 m0, s78, 114688
s_add_u32 s96, s97, 262144
v_permlane16_swap_b32 v12, v14
MM v[92:95],v[48:51],a[180:183]
TR v[44:45],v160,12288
buffer_load_dwordx4 v28, s[32:35], s96 offen lds
v_permlane16_swap_b32 v13, v15
MM v[92:95],v[52:55],a[188:191]
TR v[46:47],v160,14336
s_waitcnt lgkmcnt(8)
v_lshlrev_b32 v116, 16, v12
MM v[88:91],v[56:59],a[192:195]
TR v[48:49],v161,0
s_add_u32 m0, s78, 115712
s_add_u32 s96, s97, 278528
v_and_b32 v117, s3, v12
MM v[88:91],v[60:63],a[200:203]
TR v[50:51],v161,2048
buffer_load_dwordx4 v28, s[32:35], s96 offen lds
v_lshlrev_b32 v118, 16, v13
MM v[92:95],v[56:59],a[196:199]
TR v[52:53],v161,4096
v_and_b32 v119, s3, v13
MM v[92:95],v[60:63],a[204:207]
TR v[54:55],v161,6144
s_waitcnt lgkmcnt(8)
s_waitcnt vmcnt(18)
s_add_u32 m0, s78, 116736
s_add_u32 s96, s97, 294912
v_lshlrev_b32 v124, 16, v14
MM v[64:67],v[32:35],a[208:211]
TR v[56:57],v161,8192
buffer_load_dwordx4 v28, s[32:35], s96 offen lds
v_and_b32 v125, s3, v14
MM v[64:67],v[36:39],a[216:219]
TR v[58:59],v161,10240
v_lshlrev_b32 v126, 16, v15
MM v[68:71],v[32:35],a[212:215]
TR v[60:61],v161,12288
s_add_u32 m0, s78, 117760
s_add_u32 s96, s97, 311296
v_and_b32 v127, s3, v15
MM v[68:71],v[36:39],a[220:223]
TR v[62:63],v161,14336
s_waitcnt lgkmcnt(8)
buffer_load_dwordx4 v28, s[32:35], s96 offen lds
MM v[64:67],v[40:43],a[224:227]
TR v[32:33],v162,0
s_waitcnt vmcnt(14)
v_lshlrev_b32 v20, 16, v128
v_and_b32 v21, s3, v128
MM v[64:67],v[44:47],a[232:235]
TR v[34:35],v162,2048
s_add_u32 s73, s98, 229376
v_lshlrev_b32 v22, 16, v129
v_and_b32 v23, s3, v129
MM v[68:71],v[40:43],a[228:231]
TR v[36:37],v162,4096
buffer_load_dwordx4 a[0:3], v2, s[36:39], s73 offen offset:0 sc1
v_add_f32 v192, v192, v20
v_add_f32 v193, v193, v21
MM v[68:71],v[44:47],a[236:239]
TR v[38:39],v162,6144
s_waitcnt lgkmcnt(8)
v_add_f32 v194, v194, v22
v_add_f32 v195, v195, v23
v_mul_f32 v20, s87, v192
MM v[72:75],v[48:51],a[208:211]
TR v[40:41],v162,8192
v_mul_f32 v21, s87, v193
v_mul_f32 v22, s87, v194
MM v[72:75],v[52:55],a[216:219]
TR v[42:43],v162,10240
buffer_load_dwordx4 a[4:7], v2, s[36:39], s73 offen offset:1024 sc1
v_mul_f32 v23, s87, v195
v_exp_f32 v20, v20
MM v[76:79],v[48:51],a[212:215]
TR v[44:45],v162,12288
v_exp_f32 v21, v21
v_exp_f32 v22, v22
v_exp_f32 v23, v23
MM v[76:79],v[52:55],a[220:223]
TR v[46:47],v162,14336
s_waitcnt lgkmcnt(8)
v_add_f32 v20, 1.0, v20
v_add_f32 v21, 1.0, v21
MM v[72:75],v[56:59],a[224:227]
TR v[48:49],v163,0
buffer_load_dwordx4 a[8:11], v2, s[36:39], s73 offen offset:2048 sc1
v_add_f32 v22, 1.0, v22
v_add_f32 v23, 1.0, v23
MM v[72:75],v[60:63],a[232:235]
TR v[50:51],v163,2048
v_rcp_f32 v20, v20
v_rcp_f32 v21, v21
MM v[76:79],v[56:59],a[228:231]
TR v[52:53],v163,4096
v_rcp_f32 v22, v22
MM v[76:79],v[60:63],a[236:239]
TR v[54:55],v163,6144
s_waitcnt lgkmcnt(8)
buffer_load_dwordx4 a[12:15], v2, s[36:39], s73 offen offset:3072 sc1
v_rcp_f32 v23, v23
MM v[80:83],v[32:35],a[208:211]
TR v[56:57],v163,8192
v_mul_f32 v192, v192, v20
v_mul_f32 v193, v193, v21
MM v[80:83],v[36:39],a[216:219]
TR v[58:59],v163,10240
s_add_u32 s73, s98, 233472
v_mul_f32 v194, v194, v22
v_mul_f32 v195, v195, v23
MM v[84:87],v[32:35],a[212:215]
TR v[60:61],v163,12288
buffer_load_dwordx4 a[16:19], v2, s[36:39], s73 offen offset:0 sc1
v_lshlrev_b32 v20, 16, v130
v_and_b32 v21, s3, v130
MM v[84:87],v[36:39],a[220:223]
TR v[62:63],v163,14336
s_waitcnt lgkmcnt(8)
v_lshlrev_b32 v22, 16, v131
v_and_b32 v23, s3, v131
v_add_f32 v196, v196, v20
MM v[80:83],v[40:43],a[224:227]
TR v[32:33],v160,16384
v_add_f32 v197, v197, v21
v_add_f32 v198, v198, v22
MM v[80:83],v[44:47],a[232:235]
TR v[34:35],v160,18432
buffer_load_dwordx4 a[20:23], v2, s[36:39], s73 offen offset:1024 sc1
v_add_f32 v199, v199, v23
v_mul_f32 v20, s87, v196
MM v[84:87],v[40:43],a[228:231]
TR v[36:37],v160,20480
v_mul_f32 v21, s87, v197
v_mul_f32 v22, s87, v198
v_mul_f32 v23, s87, v199
MM v[84:87],v[44:47],a[236:239]
TR v[38:39],v160,22528
s_waitcnt lgkmcnt(8)
v_exp_f32 v20, v20
v_exp_f32 v21, v21
MM v[88:91],v[48:51],a[208:211]
TR v[40:41],v160,24576
buffer_load_dwordx4 a[24:27], v2, s[36:39], s73 offen offset:2048 sc1
v_exp_f32 v22, v22
v_exp_f32 v23, v23
MM v[88:91],v[52:55],a[216:219]
TR v[42:43],v160,26624
v_add_f32 v20, 1.0, v20
v_add_f32 v21, 1.0, v21
v_add_f32 v22, 1.0, v22
MM v[92:95],v[48:51],a[212:215]
TR v[44:45],v160,28672
v_add_f32 v23, 1.0, v23
v_rcp_f32 v20, v20
MM v[92:95],v[52:55],a[220:223]
TR v[46:47],v160,30720
s_waitcnt lgkmcnt(8)
buffer_load_dwordx4 a[28:31], v2, s[36:39], s73 offen offset:3072 sc1
v_rcp_f32 v21, v21
MM v[88:91],v[56:59],a[224:227]
TR v[48:49],v161,16384
v_rcp_f32 v22, v22
MM v[88:91],v[60:63],a[232:235]
TR v[50:51],v161,18432
s_add_u32 s73, s98, 237568
v_rcp_f32 v23, v23
MM v[92:95],v[56:59],a[228:231]
TR v[52:53],v161,20480
buffer_load_dwordx4 a[32:35], v2, s[36:39], s73 offen offset:0 sc1
v_mul_f32 v196, v196, v20
v_mul_f32 v197, v197, v21
MM v[92:95],v[60:63],a[236:239]
TR v[54:55],v161,22528
s_waitcnt lgkmcnt(8)
s_waitcnt vmcnt(17)
v_mul_f32 v198, v198, v22
v_mul_f32 v199, v199, v23
MM v[64:67],v[32:35],a[96:99]
TR v[56:57],v161,24576
s_waitcnt vmcnt(21)
v_lshlrev_b32 v20, 16, v132
v_and_b32 v21, s3, v132
MM v[64:67],v[36:39],a[104:107]
TR v[58:59],v161,26624
buffer_load_dwordx4 a[36:39], v2, s[36:39], s73 offen offset:1024 sc1
v_lshlrev_b32 v22, 16, v133
v_and_b32 v23, s3, v133
MM v[68:71],v[32:35],a[100:103]
TR v[60:61],v161,28672
v_add_f32 v200, v200, v20
v_add_f32 v201, v201, v21
MM v[68:71],v[36:39],a[108:111]
TR v[62:63],v161,30720
s_waitcnt lgkmcnt(8)
v_add_f32 v202, v202, v22
v_add_f32 v203, v203, v23
v_mul_f32 v20, s87, v200
MM v[64:67],v[40:43],a[112:115]
TR v[32:33],v162,16384
buffer_load_dwordx4 a[40:43], v2, s[36:39], s73 offen offset:2048 sc1
v_mul_f32 v21, s87, v201
v_mul_f32 v22, s87, v202
MM v[64:67],v[44:47],a[120:123]
TR v[34:35],v162,18432
v_mul_f32 v23, s87, v203
v_exp_f32 v20, v20
MM v[68:71],v[40:43],a[116:119]
TR v[36:37],v162,20480
v_exp_f32 v21, v21
v_exp_f32 v22, v22
v_exp_f32 v23, v23
MM v[68:71],v[44:47],a[124:127]
TR v[38:39],v162,22528
s_waitcnt lgkmcnt(8)
buffer_load_dwordx4 a[44:47], v2, s[36:39], s73 offen offset:3072 sc1
v_add_f32 v20, 1.0, v20
v_add_f32 v21, 1.0, v21
MM v[72:75],v[48:51],a[96:99]
TR v[40:41],v162,24576
v_add_f32 v22, 1.0, v22
v_add_f32 v23, 1.0, v23
MM v[72:75],v[52:55],a[104:107]
TR v[42:43],v162,26624
s_add_u32 s73, s98, 241664
v_rcp_f32 v20, v20
v_rcp_f32 v21, v21
MM v[76:79],v[48:51],a[100:103]
TR v[44:45],v162,28672
buffer_load_dwordx4 a[48:51], v2, s[36:39], s73 offen offset:0 sc1
v_rcp_f32 v22, v22
MM v[76:79],v[52:55],a[108:111]
TR v[46:47],v162,30720
s_waitcnt lgkmcnt(8)
v_rcp_f32 v23, v23
MM v[72:75],v[56:59],a[112:115]
TR v[48:49],v163,16384
v_mul_f32 v200, v200, v20
v_mul_f32 v201, v201, v21
MM v[72:75],v[60:63],a[120:123]
TR v[50:51],v163,18432
buffer_load_dwordx4 a[52:55], v2, s[36:39], s73 offen offset:1024 sc1
v_mul_f32 v202, v202, v22
v_mul_f32 v203, v203, v23
MM v[76:79],v[56:59],a[116:119]
TR v[52:53],v163,20480
v_lshlrev_b32 v20, 16, v134
v_and_b32 v21, s3, v134
MM v[76:79],v[60:63],a[124:127]
TR v[54:55],v163,22528
s_waitcnt lgkmcnt(8)
v_lshlrev_b32 v22, 16, v135
v_and_b32 v23, s3, v135
v_add_f32 v204, v204, v20
MM v[80:83],v[32:35],a[96:99]
TR v[56:57],v163,24576
buffer_load_dwordx4 a[56:59], v2, s[36:39], s73 offen offset:2048 sc1
v_add_f32 v205, v205, v21
v_add_f32 v206, v206, v22
MM v[80:83],v[36:39],a[104:107]
TR v[58:59],v163,26624
v_add_f32 v207, v207, v23
v_mul_f32 v20, s87, v204
MM v[84:87],v[32:35],a[100:103]
TR v[60:61],v163,28672
v_mul_f32 v21, s87, v205
v_mul_f32 v22, s87, v206
v_mul_f32 v23, s87, v207
MM v[84:87],v[36:39],a[108:111]
TR v[62:63],v163,30720
s_waitcnt lgkmcnt(8)
s_waitcnt vmcnt(15)
s_barrier
buffer_load_dwordx4 a[60:63], v2, s[36:39], s73 offen offset:3072 sc1
v_exp_f32 v20, v20
v_exp_f32 v21, v21
MM v[80:83],v[40:43],a[112:115]
TR v[32:33],v8,32768
v_exp_f32 v22, v22
v_exp_f32 v23, v23
MM v[80:83],v[44:47],a[120:123]
TR v[34:35],v8,34816
v_add_f32 v20, 1.0, v20
v_add_f32 v21, 1.0, v21
v_add_f32 v22, 1.0, v22
MM v[84:87],v[40:43],a[116:119]
TR v[36:37],v8,36864
v_add_f32 v23, 1.0, v23
v_rcp_f32 v20, v20
MM v[84:87],v[44:47],a[124:127]
TR v[38:39],v8,38912
s_waitcnt lgkmcnt(8)
v_rcp_f32 v21, v21
MM v[88:91],v[48:51],a[96:99]
TR v[40:41],v8,40960
v_rcp_f32 v22, v22
MM v[88:91],v[52:55],a[104:107]
TR v[42:43],v8,43008
v_rcp_f32 v23, v23
MM v[92:95],v[48:51],a[100:103]
TR v[44:45],v8,45056
v_mul_f32 v204, v204, v20
v_mul_f32 v205, v205, v21
MM v[92:95],v[52:55],a[108:111]
TR v[46:47],v8,47104
s_waitcnt lgkmcnt(8)
v_mul_f32 v206, v206, v22
v_mul_f32 v207, v207, v23
MM v[88:91],v[56:59],a[112:115]
TR v[48:49],v9,32768
s_waitcnt vmcnt(27)
v_lshlrev_b32 v20, 16, v136
v_and_b32 v21, s3, v136
MM v[88:91],v[60:63],a[120:123]
TR v[50:51],v9,34816
v_lshlrev_b32 v22, 16, v137
v_and_b32 v23, s3, v137
MM v[92:95],v[56:59],a[116:119]
TR v[52:53],v9,36864
v_add_f32 v208, v208, v20
v_add_f32 v209, v209, v21
MM v[92:95],v[60:63],a[124:127]
TR v[54:55],v9,38912
s_waitcnt lgkmcnt(8)
s_waitcnt vmcnt(8)
v_add_f32 v210, v210, v22
v_add_f32 v211, v211, v23
v_mul_f32 v20, s87, v208
MM v[64:67],v[32:35],a[0:3]
TR v[56:57],v9,40960
v_mul_f32 v21, s87, v209
v_mul_f32 v22, s87, v210
MM v[64:67],v[36:39],a[8:11]
TR v[58:59],v9,43008
v_mul_f32 v23, s87, v211
v_exp_f32 v20, v20
MM v[68:71],v[32:35],a[4:7]
TR v[60:61],v9,45056
v_exp_f32 v21, v21
v_exp_f32 v22, v22
v_exp_f32 v23, v23
MM v[68:71],v[36:39],a[12:15]
TR v[62:63],v9,47104
s_waitcnt lgkmcnt(8)
v_add_f32 v20, 1.0, v20
v_add_f32 v21, 1.0, v21
MM v[64:67],v[40:43],a[16:19]
TR v[32:33],v10,32768
v_add_f32 v22, 1.0, v22
v_add_f32 v23, 1.0, v23
MM v[64:67],v[44:47],a[24:27]
TR v[34:35],v10,34816
v_rcp_f32 v20, v20
v_rcp_f32 v21, v21
MM v[68:71],v[40:43],a[20:23]
TR v[36:37],v10,36864
v_rcp_f32 v22, v22
MM v[68:71],v[44:47],a[28:31]
TR v[38:39],v10,38912
s_waitcnt lgkmcnt(8)
v_rcp_f32 v23, v23
MM v[72:75],v[48:51],a[0:3]
TR v[40:41],v10,40960
v_mul_f32 v208, v208, v20
v_mul_f32 v209, v209, v21
MM v[72:75],v[52:55],a[8:11]
TR v[42:43],v10,43008
v_mul_f32 v210, v210, v22
v_mul_f32 v211, v211, v23
MM v[76:79],v[48:51],a[4:7]
TR v[44:45],v10,45056
v_lshlrev_b32 v20, 16, v138
v_and_b32 v21, s3, v138
MM v[76:79],v[52:55],a[12:15]
TR v[46:47],v10,47104
s_waitcnt lgkmcnt(8)
v_lshlrev_b32 v22, 16, v139
v_and_b32 v23, s3, v139
v_add_f32 v212, v212, v20
MM v[72:75],v[56:59],a[16:19]
TR v[48:49],v11,32768
v_add_f32 v213, v213, v21
v_add_f32 v214, v214, v22
MM v[72:75],v[60:63],a[24:27]
TR v[50:51],v11,34816
v_add_f32 v215, v215, v23
v_mul_f32 v20, s87, v212
MM v[76:79],v[56:59],a[20:23]
TR v[52:53],v11,36864
v_mul_f32 v21, s87, v213
v_mul_f32 v22, s87, v214
v_mul_f32 v23, s87, v215
MM v[76:79],v[60:63],a[28:31]
TR v[54:55],v11,38912
s_waitcnt lgkmcnt(8)
v_exp_f32 v20, v20
v_exp_f32 v21, v21
MM v[80:83],v[32:35],a[0:3]
TR v[56:57],v11,40960
v_exp_f32 v22, v22
v_exp_f32 v23, v23
MM v[80:83],v[36:39],a[8:11]
TR v[58:59],v11,43008
v_add_f32 v20, 1.0, v20
v_add_f32 v21, 1.0, v21
v_add_f32 v22, 1.0, v22
MM v[84:87],v[32:35],a[4:7]
TR v[60:61],v11,45056
v_add_f32 v23, 1.0, v23
v_rcp_f32 v20, v20
MM v[84:87],v[36:39],a[12:15]
TR v[62:63],v11,47104
s_waitcnt lgkmcnt(8)
v_rcp_f32 v21, v21
MM v[80:83],v[40:43],a[16:19]
TR v[32:33],v8,49152
v_rcp_f32 v22, v22
MM v[80:83],v[44:47],a[24:27]
TR v[34:35],v8,51200
v_rcp_f32 v23, v23
MM v[84:87],v[40:43],a[20:23]
TR v[36:37],v8,53248
v_mul_f32 v212, v212, v20
v_mul_f32 v213, v213, v21
MM v[84:87],v[44:47],a[28:31]
TR v[38:39],v8,55296
s_waitcnt lgkmcnt(8)
v_mul_f32 v214, v214, v22
v_mul_f32 v215, v215, v23
MM v[88:91],v[48:51],a[0:3]
TR v[40:41],v8,57344
s_waitcnt vmcnt(26)
v_lshlrev_b32 v20, 16, v140
v_and_b32 v21, s3, v140
MM v[88:91],v[52:55],a[8:11]
TR v[42:43],v8,59392
v_lshlrev_b32 v22, 16, v141
v_and_b32 v23, s3, v141
MM v[92:95],v[48:51],a[4:7]
TR v[44:45],v8,61440
v_add_f32 v216, v216, v20
v_add_f32 v217, v217, v21
MM v[92:95],v[52:55],a[12:15]
TR v[46:47],v8,63488
s_waitcnt lgkmcnt(8)
v_add_f32 v218, v218, v22
v_add_f32 v219, v219, v23
v_mul_f32 v20, s87, v216
MM v[88:91],v[56:59],a[16:19]
TR v[48:49],v9,49152
v_mul_f32 v21, s87, v217
v_mul_f32 v22, s87, v218
MM v[88:91],v[60:63],a[24:27]
TR v[50:51],v9,51200
v_mul_f32 v23, s87, v219
v_exp_f32 v20, v20
MM v[92:95],v[56:59],a[20:23]
TR v[52:53],v9,53248
v_exp_f32 v21, v21
v_exp_f32 v22, v22
v_exp_f32 v23, v23
MM v[92:95],v[60:63],a[28:31]
TR v[54:55],v9,55296
s_waitcnt lgkmcnt(8)
s_waitcnt vmcnt(0)
v_add_f32 v20, 1.0, v20
v_add_f32 v21, 1.0, v21
MM v[64:67],v[32:35],a[32:35]
TR v[56:57],v9,57344
v_add_f32 v22, 1.0, v22
v_add_f32 v23, 1.0, v23
MM v[64:67],v[36:39],a[40:43]
TR v[58:59],v9,59392
v_rcp_f32 v20, v20
v_rcp_f32 v21, v21
MM v[68:71],v[32:35],a[36:39]
TR v[60:61],v9,61440
v_rcp_f32 v22, v22
MM v[68:71],v[36:39],a[44:47]
TR v[62:63],v9,63488
s_waitcnt lgkmcnt(8)
v_rcp_f32 v23, v23
MM v[64:67],v[40:43],a[48:51]
TR v[32:33],v10,49152
v_mul_f32 v216, v216, v20
v_mul_f32 v217, v217, v21
MM v[64:67],v[44:47],a[56:59]
TR v[34:35],v10,51200
v_mul_f32 v218, v218, v22
v_mul_f32 v219, v219, v23
MM v[68:71],v[40:43],a[52:55]
TR v[36:37],v10,53248
v_lshlrev_b32 v20, 16, v142
v_and_b32 v21, s3, v142
MM v[68:71],v[44:47],a[60:63]
TR v[38:39],v10,55296
s_waitcnt lgkmcnt(8)
v_lshlrev_b32 v22, 16, v143
v_and_b32 v23, s3, v143
v_add_f32 v220, v220, v20
MM v[72:75],v[48:51],a[32:35]
TR v[40:41],v10,57344
v_add_f32 v221, v221, v21
v_add_f32 v222, v222, v22
MM v[72:75],v[52:55],a[40:43]
TR v[42:43],v10,59392
v_add_f32 v223, v223, v23
v_mul_f32 v20, s87, v220
MM v[76:79],v[48:51],a[36:39]
TR v[44:45],v10,61440
v_mul_f32 v21, s87, v221
v_mul_f32 v22, s87, v222
v_mul_f32 v23, s87, v223
MM v[76:79],v[52:55],a[44:47]
TR v[46:47],v10,63488
s_waitcnt lgkmcnt(8)
v_exp_f32 v20, v20
v_exp_f32 v21, v21
MM v[72:75],v[56:59],a[48:51]
TR v[48:49],v11,49152
v_exp_f32 v22, v22
v_exp_f32 v23, v23
MM v[72:75],v[60:63],a[56:59]
TR v[50:51],v11,51200
v_add_f32 v20, 1.0, v20
v_add_f32 v21, 1.0, v21
v_add_f32 v22, 1.0, v22
MM v[76:79],v[56:59],a[52:55]
TR v[52:53],v11,53248
v_add_f32 v23, 1.0, v23
v_rcp_f32 v20, v20
MM v[76:79],v[60:63],a[60:63]
TR v[54:55],v11,55296
s_waitcnt lgkmcnt(8)
v_rcp_f32 v21, v21
MM v[80:83],v[32:35],a[32:35]
TR v[56:57],v11,57344
v_rcp_f32 v22, v22
MM v[80:83],v[36:39],a[40:43]
TR v[58:59],v11,59392
v_rcp_f32 v23, v23
MM v[84:87],v[32:35],a[36:39]
TR v[60:61],v11,61440
v_mul_f32 v220, v220, v20
v_mul_f32 v221, v221, v21
MM v[84:87],v[36:39],a[44:47]
TR v[62:63],v11,63488
s_waitcnt lgkmcnt(8)
v_mul_f32 v222, v222, v22
v_mul_f32 v223, v223, v23
MM v[80:83],v[40:43],a[48:51]
MM v[80:83],v[44:47],a[56:59]
MM v[84:87],v[40:43],a[52:55]
v_fmac_f32 v96, v64, v192
v_fmac_f32 v97, v65, v193
v_fmac_f32 v98, v66, v194
MM v[84:87],v[44:47],a[60:63]
s_waitcnt lgkmcnt(4)
v_fmac_f32 v99, v67, v195
v_fmac_f32 v104, v72, v200
v_fmac_f32 v105, v73, v201
MM v[88:91],v[48:51],a[32:35]
v_fmac_f32 v106, v74, v202
v_fmac_f32 v107, v75, v203
v_cvt_pk_bf16_f32 v192, v96, v97
MM v[88:91],v[52:55],a[40:43]
v_cvt_pk_bf16_f32 v193, v98, v99
v_cvt_pk_bf16_f32 v194, v104, v105
v_cvt_pk_bf16_f32 v195, v106, v107
MM v[92:95],v[48:51],a[36:39]
v_permlane16_swap_b32 v192, v194
v_permlane16_swap_b32 v193, v195
global_store_dwordx4 v16, v[192:195], s[18:19] offset:0 nt
MM v[92:95],v[52:55],a[44:47]
s_waitcnt lgkmcnt(0)
v_fmac_f32 v100, v68, v196
v_fmac_f32 v101, v69, v197
v_fmac_f32 v102, v70, v198
MM v[88:91],v[56:59],a[48:51]
v_fmac_f32 v103, v71, v199
v_fmac_f32 v108, v76, v204
v_fmac_f32 v109, v77, v205
MM v[88:91],v[60:63],a[56:59]
v_fmac_f32 v110, v78, v206
v_fmac_f32 v111, v79, v207
v_cvt_pk_bf16_f32 v196, v100, v101
MM v[92:95],v[56:59],a[52:55]
v_cvt_pk_bf16_f32 v197, v102, v103
v_cvt_pk_bf16_f32 v198, v108, v109
v_cvt_pk_bf16_f32 v199, v110, v111
MM v[92:95],v[60:63],a[60:63]
v_permlane16_swap_b32 v196, v198
v_permlane16_swap_b32 v197, v199
global_store_dwordx4 v17, v[196:199], s[18:19] offset:0 nt
v_fmac_f32 v112, v80, v208
v_fmac_f32 v113, v81, v209
v_fmac_f32 v114, v82, v210
v_fmac_f32 v115, v83, v211
v_fmac_f32 v120, v88, v216
v_fmac_f32 v121, v89, v217
v_fmac_f32 v122, v90, v218
v_fmac_f32 v123, v91, v219
v_cvt_pk_bf16_f32 v208, v112, v113
v_cvt_pk_bf16_f32 v209, v114, v115
v_cvt_pk_bf16_f32 v210, v120, v121
v_cvt_pk_bf16_f32 v211, v122, v123
s_nop 0
v_permlane16_swap_b32 v208, v210
v_permlane16_swap_b32 v209, v211
global_store_dwordx4 v16, v[208:211], s[18:19] offset:64 nt
v_fmac_f32 v116, v84, v212
v_fmac_f32 v117, v85, v213
v_fmac_f32 v118, v86, v214
v_fmac_f32 v119, v87, v215
v_fmac_f32 v124, v92, v220
v_fmac_f32 v125, v93, v221
v_fmac_f32 v126, v94, v222
v_fmac_f32 v127, v95, v223
v_cvt_pk_bf16_f32 v212, v116, v117
v_cvt_pk_bf16_f32 v213, v118, v119
v_cvt_pk_bf16_f32 v214, v124, v125
v_cvt_pk_bf16_f32 v215, v126, v127
s_nop 0
v_permlane16_swap_b32 v212, v214
v_permlane16_swap_b32 v213, v215
global_store_dwordx4 v17, v[212:215], s[18:19] offset:64 nt
s_endpgm
L_end:
s_endpgm
.section .rodata,"a"
.p2align 6
.amdhsa_kernel recurrent_scan__linear_attn_block__glu_gated_swiglu__prompt_kernel
.amdhsa_next_free_vgpr 512
.amdhsa_next_free_sgpr 102
.amdhsa_accum_offset 256
.amdhsa_group_segment_fixed_size 0
.amdhsa_kernarg_size 80
.amdhsa_user_sgpr_count 2
.amdhsa_user_sgpr_kernarg_segment_ptr 1
.amdhsa_system_sgpr_workgroup_id_x 1
.amdhsa_float_denorm_mode_32 3
.end_amdhsa_kernel
```
